```python
import torch

def _softmax(x, axis=-1):
    return torch.softmax(x, dim=axis)

def _gelu(x):
    return torch.nn.functional.gelu(x, approximate='tanh')

def _silu(x):
    return torch.nn.functional.silu(x)

def _sigmoid(x):
    return torch.sigmoid(x)

def _layernorm(x, axis=-1, eps=1e-05):
    m = x.mean(dim=axis, keepdim=True)
    v = x.var(dim=axis, keepdim=True, unbiased=False)
    return (x - m) / torch.sqrt(v + eps)

def _scatter_add(tgt, idx, src, axis=0):
    return tgt.clone().index_add_(axis, idx, src)

def _segment_sum(src, seg, n):
    out = torch.zeros((n,) + src.shape[1:], dtype=src.dtype)
    return out.index_add_(0, seg, src)

def _pad(x, pw):
    flat = tuple((v for pair in reversed(pw) for v in pair))
    return torch.nn.functional.pad(x, flat)
kernel_name = 'adaLN_cond__sliding_block__dense_activation_silu__prompt'

def setup_inputs():

    _w = lambda a: (lambda t: t.to(torch.bfloat16) if t.is_floating_point() else t)(torch.as_tensor(a))

    def _A_setup():
        B, S, D = (1, 2048, 512)
        return {'x': _w((lambda *s: torch.randn(*s, dtype=torch.bfloat16) * 0.05)(B, S, D)), 'wqkv': _w((lambda *s: torch.randn(*s, dtype=torch.bfloat16) * 0.05)(D, 3 * D)), 'wo': _w((lambda *s: torch.randn(*s, dtype=torch.bfloat16) * 0.05)(D, D))}
    _A_in = _A_setup()

    def _B_setup():
        B, S, D, F = (1, 2048, 512, 1376)
        return {'x': _w((lambda *s: torch.randn(*s, dtype=torch.bfloat16) * 0.05)(B, S, D)), 'w1': _w((lambda *s: torch.randn(*s, dtype=torch.bfloat16) * 3.2)(D, F) * D ** (-0.5)), 'w2': _w((lambda *s: torch.randn(*s, dtype=torch.bfloat16) * 0.4)(F, D) * F ** (-0.5))}
    _B_in = _B_setup()
    return {'A_x': _A_in['x'], 'A_wqkv': _A_in['wqkv'], 'A_wo': _A_in['wo'], 'B_x': _B_in['x'], 'B_w1': _B_in['w1'], 'B_w2': _B_in['w2'], 'c': _w((lambda *s: torch.randn(*s, dtype=torch.bfloat16) * 0.1)(1, 512) * 8.0), 'w_mod': _w((lambda *s: torch.randn(*s, dtype=torch.bfloat16) * 0.1)(512, 6 * 512) * 512 ** (-0.5) * 8.0)}

def reference(A_x, A_wqkv, A_wo, B_x, B_w1, B_w2, c, w_mod):

    def _A_ref(x, wqkv, wo):
        B, S, D = x.shape
        H = 32
        Dh = D // H
        W = 256
        qkv = (lambda x, *d: x.permute(*d))((x @ wqkv).reshape(B, S, 3, H, Dh), 2, 0, 3, 1, 4)
        q, k, v = (qkv[0], qkv[1], qkv[2])
        scores = torch.einsum('bhqd,bhkd->bhqk', q, k) * Dh ** (-0.5)
        idx = torch.arange(S)
        mask = (idx[:, None] - idx[None, :] >= 0) & (idx[:, None] - idx[None, :] < W)
        scores = torch.where(mask[None, None], scores, -1000000000.0)
        p = _softmax(scores, axis=-1)
        o = torch.einsum('bhqk,bhkd->bhqd', p, v)
        return (lambda x, *d: x.permute(*d))(o, 0, 2, 1, 3).reshape(B, S, D) @ wo

    def _B_ref(x, w1, w2):
        h = torch.einsum('bsd,df->bsf', x, w1)
        h = _silu(h)
        out = torch.einsum('bsf,fd->bsd', h, w2)
        return out
    x = A_x
    mod = (_silu(c) @ w_mod).reshape(c.shape[0], 6, 1, -1)
    sa, ca, ga, sb, cb, gb = (mod[:, 0].clone(), mod[:, 1].clone(), mod[:, 2].clone(), mod[:, 3].clone(), mod[:, 4].clone(), mod[:, 5].clone())
    h = _layernorm(x, axis=-1) * (1 + ca) + sa
    x = x + ga * _A_ref(h, A_wqkv, A_wo)
    h = _layernorm(x, axis=-1) * (1 + cb) + sb
    x = x + gb * _B_ref(h, B_w1, B_w2)
    return x
```

```asm
; @launch grid=(256,1,1) block=(256,1,1) lds=163840
.amdgcn_target "amdgcn-amd-amdhsa--gfx950"
.text
.globl adaLN_cond__sliding_block__dense_activation_silu__prompt_kernel
.p2align 8
.type adaLN_cond__sliding_block__dense_activation_silu__prompt_kernel,@function
adaLN_cond__sliding_block__dense_activation_silu__prompt_kernel:
s_cmpk_ge_u32 s2, 256
s_cbranch_scc1 L_end
s_load_dwordx2 s[32:33], s[0:1], 56
s_load_dwordx2 s[36:37], s[0:1], 48
s_load_dwordx2 s[4:5], s[0:1], 0
s_load_dwordx2 s[8:9], s[0:1], 8
s_load_dwordx2 s[24:25], s[0:1], 80
s_load_dwordx2 s[12:13], s[0:1], 16
s_load_dwordx4 s[68:71], s[0:1], 32
s_load_dwordx2 s[28:29], s[0:1], 64
s_getpc_b64 s[82:83]
L_pc:
s_lshr_b32 s78, s2, 3
v_lshrrev_b32 v1, 6, v0
v_and_b32 v0, 63, v0
s_lshl_b32 s79, s78, 11
v_lshlrev_b32 v9, 7, v0
v_readfirstlane_b32 s73, v1
v_lshl_add_u32 v3, v1, 9, v9
v_add_u32 v3, s79, v3
v_min_u32 v3, L_fastend-L_pc, v3
s_mov_b64 exec, 15
global_load_dword a0, v3, s[82:83]
s_mov_b64 exec, -1
s_and_b32 s74, s78, 7
s_and_b32 s83, s2, 7
s_lshl_b32 s83, s83, 2
s_lshr_b32 s79, s2, 6
s_add_u32 s75, s83, s79
s_add_u32 s78, s83, s74
s_lshl_b32 s78, s78, 2
s_add_u32 s78, s78, s79
s_sub_u32 s78, s78, 16
s_cmp_ge_u32 s74, 4
s_cselect_b32 s77, s78, 64
v_lshlrev_b32 v2, 4, v0
v_lshrrev_b32 v3, 3, v0
v_and_b32 v4, 7, v0
s_mov_b32 s35, 0x20000
s_mov_b32 s34, 0x300000
s_mov_b32 s39, s35
s_movk_i32 s38, 1024
s_mov_b32 s7, s35
s_mov_b32 s6, 0x200000
s_mov_b32 s11, s35
s_mov_b32 s10, 0x180000
v_mul_u32_u24 v5, 0x3000, v3
s_movk_i32 s100, 3072
s_lshl_b32 s82, s75, 16
s_lshl_b32 s81, s74, 7
s_waitcnt lgkmcnt(0)
s_load_dword s72, s[24:25], 0
s_mov_b32 s85, 0xffff0000
s_mov_b32 s26, 0x2000000
s_mov_b32 s27, 0x20000
s_cmp_lt_u32 s77, 64
s_cbranch_scc0 L_np0
v_lshlrev_b32 v5, 1, v5
v_lshl_add_u32 v5, v4, 4, v5
s_and_b32 s79, s77, 3
s_lshl_b32 s79, s79, 2
s_add_u32 s79, s79, s73
s_mul_i32 s78, s79, 196608
s_lshr_b32 s80, s77, 2
s_lshl_b32 s80, s80, 7
s_add_u32 s78, s78, s80
s_lshl_b32 s79, s79, 6
v_and_b32 v6, 31, v0
v_lshlrev_b32 v6, 1, v6
buffer_load_ushort v248, v6, s[36:39], s79 offen
buffer_load_dwordx4 v[176:179], v5, s[32:35], s78 offen nt
s_addk_i32 s78, 6144
buffer_load_dwordx4 v[180:183], v5, s[32:35], s78 offen nt
s_addk_i32 s78, 6144
buffer_load_dwordx4 v[184:187], v5, s[32:35], s78 offen nt
s_addk_i32 s78, 6144
buffer_load_dwordx4 v[188:191], v5, s[32:35], s78 offen nt
s_branch L_prod
L_np0:
s_lshl_b32 s99, s73, 14
s_add_u32 s82, s82, s99
s_add_u32 s101, s74, 0
s_and_b32 s101, s101, 3
s_lshl_b32 s101, s101, 12
s_add_u32 s101, s101, s82
buffer_load_dwordx4 v[20:23], v2, s[4:7], s101 offen offset:0 nt
buffer_load_dwordx4 v[28:31], v2, s[4:7], s101 offen offset:1024 nt
buffer_load_dwordx4 v[36:39], v2, s[4:7], s101 offen offset:2048 nt
buffer_load_dwordx4 v[44:47], v2, s[4:7], s101 offen offset:3072 nt
s_mul_i32 s99, s2, 6144
s_cmp_eq_u32 s73, 1
s_cselect_b32 s99, s99, s6
v_bfe_u32 v10, v0, 4, 1
v_and_b32 v9, 0x780, v9
v_mad_u32_u24 v9, v10, s100, v9
buffer_load_dword a1, v9, s[8:11], s99 offen offset:1024
v_lshrrev_b32 v208, 3, v0
s_and_b32 s101, s2, 7
s_lshl_b32 s101, s101, 2
v_mul_u32_u24 v7, 0x3000, v208
v_lshl_add_u32 v7, v4, 4, v7
s_add_u32 s64, s101, s73
s_lshl_b32 s65, s64, 5
s_mul_i32 s64, s64, 98304
s_andn2_b32 s99, s2, 7
s_lshl_b32 s99, s99, 4
s_add_u32 s64, s64, s99
buffer_load_dwordx4 v[216:219], v7, s[32:35], s64 offen offset:2048 nt
s_addk_i32 s64, 6144
buffer_load_dwordx4 v[220:223], v7, s[32:35], s64 offen offset:2048 nt
v_lshlrev_b32 v7, 2, v208
buffer_load_dword v224, v7, s[36:39], s65 offen
s_cmp_eq_u32 s73, 1
s_cselect_b64 s[40:41], s[28:29], s[24:25]
s_cselect_b32 s42, 2, 32
s_lshl_b32 s42, s42, 20
s_cmp_eq_u32 s73, 2
s_cselect_b64 s[40:41], s[68:69], s[40:41]
s_cselect_b32 s42, 1409024, s42
s_cmp_eq_u32 s73, 3
s_cselect_b64 s[40:41], s[70:71], s[40:41]
s_cselect_b32 s42, 1409024, s42
s_mov_b32 s43, 0x20000
s_add_u32 s99, s42, -4
v_lshlrev_b32 v5, 20, v0
v_min_u32 v5, s99, v5
buffer_load_dword a3, v5, s[40:43], 0 offen
s_mov_b32 s14, 524288
s_mov_b32 s15, 0x20000
v_min_u32 v5, 524284, v5
buffer_load_dword a4, v5, s[12:15], 0 offen
s_lshl_b32 s76, s74, 2
s_add_u32 s76, s76, s73
v_bfe_u32 v5, v0, 4, 1
v_lshrrev_b32 v6, 1, v4
v_xor_b32 v5, v5, v6
v_lshlrev_b32 v5, 5, v5
v_and_b32 v6, 1, v0
v_lshl_add_u32 v5, v6, 4, v5
v_mul_u32_u24 v6, 3072, v3
v_add_u32 v8, v5, v6
v_xor_b32 v9, 64, v5
v_add_u32 v9, v9, v6
v_add_u32 v9, 23552, v9
v_add_u32 v10, 47104, v8
v_add_u32 v11, 47104, v9
s_mul_i32 s79, s73, 98304
s_add_u32 s81, s81, s79
s_lshl_b32 s80, s73, 12
s_mov_b32 s30, 0x200000
s_mov_b32 s31, 0x20000
s_mul_i32 s48, s74, 5
s_min_u32 s49, s74, 3
s_add_u32 s48, s48, s49
s_lshl_b32 s48, s48, 1
s_and_b32 s49, s75, 1
s_lshl_b32 s49, s49, 1
s_add_u32 s49, s49, s73
s_sub_u32 s49, s49, 2
s_lshr_b32 s50, s75, 1
s_mul_i32 s51, s49, 3
s_add_u32 s48, s48, s51
s_lshl_b32 s48, s48, 5
s_mul_i32 s51, s50, 88064
s_add_u32 s48, s48, s51
s_lshl_b32 s51, s74, 2
s_add_u32 s51, s51, s49
s_mul_i32 s51, s51, 48
s_add_u32 s51, s51, s50
s_lshl_b32 s51, s51, 10
s_add_u32 s51, s51, 24117248
s_mul_i32 s52, s75, 3
s_add_u32 s53, s52, s73
s_add_u32 s53, s53, s73
s_add_u32 s52, s52, 1
s_lshl_b32 s54, s74, 7
s_cmp_eq_u32 s73, 0
s_cselect_b32 s55, s75, s52
s_lshl_b32 s56, s55, 14
s_add_u32 s56, s56, s54
s_lshl_b32 s57, s53, 14
s_add_u32 s57, s57, s54
s_cmp_eq_u32 s73, 0
s_cselect_b64 s[40:41], s[12:13], s[70:71]
s_mov_b32 s42, 1409024
s_mov_b32 s43, 0x20000
s_mov_b32 s46, 1409024
s_mov_b32 s47, 0x20000
s_cmp_ge_u32 s73, 2
s_cselect_b64 s[40:41], s[68:69], s[40:41]
s_cselect_b64 s[44:45], s[68:69], s[70:71]
s_cselect_b32 s58, 43, 16
s_mulk_i32 s58, 64
s_cselect_b32 s56, s48, s56
s_cselect_b64 vcc, -1, 0
s_add_u32 s48, s48, 44032
s_cmp_ge_u32 s73, 2
s_cselect_b32 s57, s48, s57
v_lshrrev_b32 v5, 4, v0
v_lshlrev_b32 v6, 1, v5
v_and_b32 v5, 1, v5
v_lshlrev_b32 v5, 2, v5
v_cndmask_b32 v5, v5, v6, vcc
v_xor_b32 v5, v5, v4
v_mul_u32_u24 v6, s58, v3
v_lshl_add_u32 v5, v5, 4, v6
s_lshl_b32 s58, s58, 3
s_lshl_b32 s59, s73, 12
s_add_u32 s59, s59, 139264
v_mov_b32 v1, v5
s_mul_i32 s60, s52, 745
s_lshr_b32 s60, s60, 14
s_mul_i32 s61, s53, 745
s_lshr_b32 s61, s61, 14
s_lshr_b32 s62, s75, 3
s_cmp_eq_u32 s73, 0
s_cselect_b32 s60, s62, s60
s_lshl_b32 s60, s60, 5
s_lshl_b32 s61, s61, 5
s_cmp_ge_u32 s73, 2
s_cselect_b32 s60, 0, s60
s_cselect_b32 s61, 64, s61
s_cselect_b32 s62, 32, 64
s_cselect_b32 s63, 0, 2048
s_cselect_b64 vcc, -1, 0
v_bfe_u32 v5, v0, 3, 1
v_bfe_u32 v6, v0, 4, 1
v_lshlrev_b32 v7, 6, v5
v_lshl_add_u32 v7, v6, 5, v7
v_bfe_u32 v5, v0, 3, 2
v_lshlrev_b32 v5, 5, v5
v_cndmask_b32 v7, v7, v5, vcc
v_lshrrev_b32 v5, 5, v0
v_lshlrev_b32 v208, 10, v5
v_lshlrev_b32 v209, 11, v5
v_lshl_add_u32 v209, v6, 9, v209
v_cndmask_b32 v210, v208, v209, vcc
s_cmp_eq_u32 s73, 0
s_cselect_b64 vcc, -1, 0
v_lshlrev_b32 v209, 9, v5
v_cndmask_b32 v208, v210, v209, vcc
v_bfe_u32 v5, v0, 2, 2
v_and_b32 v6, 3, v0
v_lshlrev_b32 v6, 3, v6
v_lshl_add_u32 v5, v5, 7, v6
v_add_u32 v5, s59, v5
v_add_u32 v208, v208, v5
v_add3_u32 v210, v210, v5, s63
v_xor_b32 v5, s60, v7
v_xor_b32 v6, s61, v7
v_xor_b32 v209, s62, v5
v_xor_b32 v211, s62, v6
v_add_u32 v209, v209, v208
v_add_u32 v208, v5, v208
v_add_u32 v211, v211, v210
v_add_u32 v210, v6, v210
s_cmp_eq_u32 s73, 1
s_cselect_b32 s60, 1, 2
s_cmp_ge_u32 s73, 2
s_cselect_b32 s61, 2, 1
s_lshl_b32 s60, s60, 9
s_lshl_b32 s61, s61, 9
v_add_u32 v212, s60, v208
v_add_u32 v213, s60, v209
v_add_u32 v214, s61, v210
v_add_u32 v215, s61, v211
s_mul_i32 s48, s74, 88
s_add_u32 s49, s48, s52
s_lshl_b32 s49, s49, 11
s_add_u32 s49, s49, 26214400
s_cmp_lt_u32 s52, 86
s_cselect_b32 s60, s49, 0x2000000
s_add_u32 s49, s48, s53
s_lshl_b32 s49, s49, 11
s_add_u32 s49, s49, 26214400
s_cmp_lt_u32 s53, 86
s_cselect_b32 s62, s49, 0x2000000
s_lshl_b32 s48, s74, 5
s_add_u32 s48, s48, s75
s_lshl_b32 s48, s48, 11
s_add_u32 s48, s48, 23068672
s_cmp_eq_u32 s73, 0
s_cselect_b32 s60, s48, s60
s_add_u32 s63, s62, 1024
s_add_u32 s61, s60, 1024
s_add_u32 s48, s51, 32768
s_add_u32 s49, s51, 16384
s_cmp_ge_u32 s73, 2
s_cselect_b32 s60, s51, s60
s_cselect_b32 s61, s49, s61
s_cselect_b32 s62, s48, s62
s_cselect_b32 s63, 0x2000000, s63
v_accvgpr_write_b32 a241, v208
v_accvgpr_write_b32 a242, v209
v_accvgpr_write_b32 a243, v210
v_accvgpr_write_b32 a244, v211
v_accvgpr_write_b32 a245, v212
v_accvgpr_write_b32 a246, v213
v_accvgpr_write_b32 a247, v214
v_accvgpr_write_b32 a248, v215
v_bfe_u32 v5, v0, 3, 1
v_mul_u32_u24 v5, 3072, v5
v_lshl_add_u32 v5, v4, 7, v5
v_accvgpr_write_b32 a252, v5
s_mul_i32 s69, s2, 6144
s_cmp_eq_u32 s73, 2
s_cselect_b32 s69, s69, 0x2000000
v_and_b32 v5, 7, v0
v_lshlrev_b32 v5, 7, v5
s_lshl_b32 s48, s75, 10
s_add_u32 s48, s48, 32768
v_add_u32 v6, s48, v5
s_lshl_b32 s48, s75, 3
s_add_u32 s48, s48, s74
s_lshl_b32 s48, s48, 10
s_add_u32 s48, s48, 65536
v_add_u32 v5, s48, v5
v_cmp_gt_u32 vcc, 8, v0
s_nop 1
v_cndmask_b32 v3, v5, v6, vcc
s_cmp_eq_u32 s73, 3
s_cselect_b32 s66, 0, 0x2000000
s_lshr_b32 s49, s2, 6
s_mul_i32 s49, s49, 1
s_add_u32 s48, s49, 0
s_and_b32 s48, s48, 3
s_mul_i32 s48, s48, 393216
s_add_u32 s50, s48, s81
s_add_u32 s48, s49, 1
s_and_b32 s48, s48, 3
s_mul_i32 s48, s48, 393216
s_add_u32 s51, s48, s81
s_add_u32 s48, s49, 2
s_and_b32 s48, s48, 3
s_mul_i32 s48, s48, 393216
s_add_u32 s52, s48, s81
s_add_u32 s48, s49, 3
s_and_b32 s48, s48, 3
s_mul_i32 s48, s48, 393216
s_add_u32 s53, s48, s81
s_add_u32 s101, s74, 1
s_and_b32 s101, s101, 3
s_lshl_b32 s101, s101, 12
s_add_u32 s101, s101, s82
buffer_load_dwordx4 v[52:55], v2, s[4:7], s101 offen offset:0 nt
buffer_load_dwordx4 v[60:63], v2, s[4:7], s101 offen offset:1024 nt
buffer_load_dwordx4 v[68:71], v2, s[4:7], s101 offen offset:2048 nt
buffer_load_dwordx4 v[76:79], v2, s[4:7], s101 offen offset:3072 nt
L_join:
s_lshl_b32 s83, s73, 11
s_add_u32 s83, s83, 327680
s_add_u32 s67, s83, 8192
s_add_u32 s54, s83, 16384
s_add_u32 s55, s83, 24576
s_mov_b32 s79, 0x3f803f80
s_waitcnt vmcnt(13)
v_dot2_f32_bf16 v144, v20, s79, 0
v_dot2_f32_bf16 v144, v21, s79, v144
v_dot2_f32_bf16 v144, v22, s79, v144
v_dot2_f32_bf16 v144, v23, s79, v144
s_add_u32 s101, s74, 2
s_and_b32 s101, s101, 3
s_lshl_b32 s101, s101, 12
s_add_u32 s101, s101, s82
buffer_load_dwordx4 v[84:87], v2, s[4:7], s101 offen offset:0 nt
v_dot2_f32_bf16 v160, v20, v20, 0
v_dot2_f32_bf16 v160, v21, v21, v160
v_dot2_f32_bf16 v160, v22, v22, v160
v_dot2_f32_bf16 v160, v23, v23, v160
v_lshlrev_b32 v16, 16, v20
v_and_b32 v17, s85, v20
v_lshlrev_b32 v18, 16, v21
v_and_b32 v19, s85, v21
v_lshlrev_b32 v20, 16, v22
v_and_b32 v21, s85, v22
buffer_load_dwordx4 v[92:95], v2, s[4:7], s101 offen offset:1024 nt
v_lshlrev_b32 v22, 16, v23
v_and_b32 v23, s85, v23
s_waitcnt vmcnt(14)
v_dot2_f32_bf16 v145, v28, s79, 0
v_dot2_f32_bf16 v145, v29, s79, v145
v_dot2_f32_bf16 v145, v30, s79, v145
v_dot2_f32_bf16 v145, v31, s79, v145
v_dot2_f32_bf16 v161, v28, v28, 0
v_dot2_f32_bf16 v161, v29, v29, v161
v_dot2_f32_bf16 v161, v30, v30, v161
v_dot2_f32_bf16 v161, v31, v31, v161
buffer_load_dwordx4 v[100:103], v2, s[4:7], s101 offen offset:2048 nt
v_lshlrev_b32 v24, 16, v28
v_and_b32 v25, s85, v28
v_lshlrev_b32 v26, 16, v29
v_and_b32 v27, s85, v29
v_lshlrev_b32 v28, 16, v30
v_and_b32 v29, s85, v30
v_lshlrev_b32 v30, 16, v31
v_and_b32 v31, s85, v31
s_waitcnt vmcnt(14)
v_dot2_f32_bf16 v146, v36, s79, 0
v_dot2_f32_bf16 v146, v37, s79, v146
buffer_load_dwordx4 v[108:111], v2, s[4:7], s101 offen offset:3072 nt
v_dot2_f32_bf16 v146, v38, s79, v146
v_dot2_f32_bf16 v146, v39, s79, v146
v_dot2_f32_bf16 v162, v36, v36, 0
v_dot2_f32_bf16 v162, v37, v37, v162
v_dot2_f32_bf16 v162, v38, v38, v162
v_dot2_f32_bf16 v162, v39, v39, v162
v_lshlrev_b32 v32, 16, v36
v_and_b32 v33, s85, v36
v_lshlrev_b32 v34, 16, v37
v_and_b32 v35, s85, v37
v_lshlrev_b32 v36, 16, v38
v_and_b32 v37, s85, v38
v_lshlrev_b32 v38, 16, v39
v_and_b32 v39, s85, v39
s_waitcnt vmcnt(14)
v_dot2_f32_bf16 v147, v44, s79, 0
v_dot2_f32_bf16 v147, v45, s79, v147
v_dot2_f32_bf16 v147, v46, s79, v147
v_dot2_f32_bf16 v147, v47, s79, v147
v_dot2_f32_bf16 v163, v44, v44, 0
v_dot2_f32_bf16 v163, v45, v45, v163
v_dot2_f32_bf16 v163, v46, v46, v163
v_dot2_f32_bf16 v163, v47, v47, v163
v_lshlrev_b32 v40, 16, v44
v_and_b32 v41, s85, v44
v_lshlrev_b32 v42, 16, v45
v_and_b32 v43, s85, v45
v_lshlrev_b32 v44, 16, v46
v_and_b32 v45, s85, v46
v_lshlrev_b32 v46, 16, v47
v_and_b32 v47, s85, v47
s_add_u32 s101, s74, 3
s_and_b32 s101, s101, 3
s_lshl_b32 s101, s101, 12
s_add_u32 s101, s101, s82
buffer_load_dwordx4 v[116:119], v2, s[4:7], s101 offen offset:0 nt
buffer_load_dwordx4 v[124:127], v2, s[4:7], s101 offen offset:1024 nt
s_waitcnt vmcnt(9)
v_dot2_f32_bf16 v148, v52, s79, 0
v_dot2_f32_bf16 v148, v53, s79, v148
v_dot2_f32_bf16 v148, v54, s79, v148
v_dot2_f32_bf16 v148, v55, s79, v148
v_dot2_f32_bf16 v164, v52, v52, 0
v_dot2_f32_bf16 v164, v53, v53, v164
v_dot2_f32_bf16 v164, v54, v54, v164
v_dot2_f32_bf16 v164, v55, v55, v164
v_lshlrev_b32 v48, 16, v52
v_and_b32 v49, s85, v52
v_lshlrev_b32 v50, 16, v53
v_and_b32 v51, s85, v53
v_lshlrev_b32 v52, 16, v54
v_and_b32 v53, s85, v54
v_lshlrev_b32 v54, 16, v55
v_and_b32 v55, s85, v55
s_waitcnt vmcnt(8)
v_dot2_f32_bf16 v149, v60, s79, 0
v_dot2_f32_bf16 v149, v61, s79, v149
v_dot2_f32_bf16 v149, v62, s79, v149
v_dot2_f32_bf16 v149, v63, s79, v149
v_dot2_f32_bf16 v165, v60, v60, 0
v_dot2_f32_bf16 v165, v61, v61, v165
v_dot2_f32_bf16 v165, v62, v62, v165
v_dot2_f32_bf16 v165, v63, v63, v165
v_lshlrev_b32 v56, 16, v60
v_and_b32 v57, s85, v60
v_lshlrev_b32 v58, 16, v61
v_and_b32 v59, s85, v61
v_lshlrev_b32 v60, 16, v62
v_and_b32 v61, s85, v62
v_lshlrev_b32 v62, 16, v63
v_and_b32 v63, s85, v63
s_waitcnt vmcnt(7)
v_dot2_f32_bf16 v150, v68, s79, 0
buffer_load_dwordx4 v[132:135], v2, s[4:7], s101 offen offset:2048 nt
v_dot2_f32_bf16 v150, v69, s79, v150
v_dot2_f32_bf16 v150, v70, s79, v150
v_dot2_f32_bf16 v150, v71, s79, v150
v_dot2_f32_bf16 v166, v68, v68, 0
v_dot2_f32_bf16 v166, v69, v69, v166
v_dot2_f32_bf16 v166, v70, v70, v166
v_dot2_f32_bf16 v166, v71, v71, v166
v_lshlrev_b32 v64, 16, v68
v_and_b32 v65, s85, v68
v_lshlrev_b32 v66, 16, v69
v_and_b32 v67, s85, v69
v_lshlrev_b32 v68, 16, v70
v_and_b32 v69, s85, v70
v_lshlrev_b32 v70, 16, v71
buffer_load_dwordx4 v[140:143], v2, s[4:7], s101 offen offset:3072 nt
v_and_b32 v71, s85, v71
s_waitcnt vmcnt(8)
v_dot2_f32_bf16 v151, v76, s79, 0
v_dot2_f32_bf16 v151, v77, s79, v151
v_dot2_f32_bf16 v151, v78, s79, v151
v_dot2_f32_bf16 v151, v79, s79, v151
v_dot2_f32_bf16 v167, v76, v76, 0
v_dot2_f32_bf16 v167, v77, v77, v167
v_dot2_f32_bf16 v167, v78, v78, v167
v_dot2_f32_bf16 v167, v79, v79, v167
v_lshlrev_b32 v72, 16, v76
v_and_b32 v73, s85, v76
v_lshlrev_b32 v74, 16, v77
v_and_b32 v75, s85, v77
v_lshlrev_b32 v76, 16, v78
v_and_b32 v77, s85, v78
v_lshlrev_b32 v78, 16, v79
v_and_b32 v79, s85, v79
s_waitcnt vmcnt(7)
v_dot2_f32_bf16 v152, v84, s79, 0
v_dot2_f32_bf16 v152, v85, s79, v152
v_dot2_f32_bf16 v152, v86, s79, v152
v_dot2_f32_bf16 v152, v87, s79, v152
v_dot2_f32_bf16 v168, v84, v84, 0
v_dot2_f32_bf16 v168, v85, v85, v168
v_dot2_f32_bf16 v168, v86, v86, v168
v_dot2_f32_bf16 v168, v87, v87, v168
v_lshlrev_b32 v80, 16, v84
v_and_b32 v81, s85, v84
v_lshlrev_b32 v82, 16, v85
v_and_b32 v83, s85, v85
v_lshlrev_b32 v84, 16, v86
v_and_b32 v85, s85, v86
v_lshlrev_b32 v86, 16, v87
v_and_b32 v87, s85, v87
s_waitcnt vmcnt(6)
v_dot2_f32_bf16 v153, v92, s79, 0
s_add_u32 m0, s80, 8192
s_add_u32 s98, s50, 1024
buffer_load_dwordx4 v8, s[8:11], s98 offen offset:0 lds
v_dot2_f32_bf16 v153, v93, s79, v153
v_dot2_f32_bf16 v153, v94, s79, v153
v_dot2_f32_bf16 v153, v95, s79, v153
v_dot2_f32_bf16 v169, v92, v92, 0
v_dot2_f32_bf16 v169, v93, v93, v169
v_dot2_f32_bf16 v169, v94, v94, v169
v_dot2_f32_bf16 v169, v95, v95, v169
v_lshlrev_b32 v88, 16, v92
v_and_b32 v89, s85, v92
v_lshlrev_b32 v90, 16, v93
v_and_b32 v91, s85, v93
v_lshlrev_b32 v92, 16, v94
buffer_load_dwordx4 v9, s[8:11], s98 offen offset:1024 lds
v_and_b32 v93, s85, v94
v_lshlrev_b32 v94, 16, v95
v_and_b32 v95, s85, v95
s_waitcnt vmcnt(7)
v_dot2_f32_bf16 v154, v100, s79, 0
v_dot2_f32_bf16 v154, v101, s79, v154
v_dot2_f32_bf16 v154, v102, s79, v154
v_dot2_f32_bf16 v154, v103, s79, v154
v_dot2_f32_bf16 v170, v100, v100, 0
v_dot2_f32_bf16 v170, v101, v101, v170
v_dot2_f32_bf16 v170, v102, v102, v170
v_dot2_f32_bf16 v170, v103, v103, v170
v_lshlrev_b32 v96, 16, v100
v_and_b32 v97, s85, v100
v_lshlrev_b32 v98, 16, v101
v_and_b32 v99, s85, v101
buffer_load_dwordx4 v10, s[8:11], s98 offen offset:2048 lds
v_lshlrev_b32 v100, 16, v102
v_and_b32 v101, s85, v102
v_lshlrev_b32 v102, 16, v103
v_and_b32 v103, s85, v103
s_waitcnt vmcnt(7)
v_dot2_f32_bf16 v155, v108, s79, 0
v_dot2_f32_bf16 v155, v109, s79, v155
v_dot2_f32_bf16 v155, v110, s79, v155
v_dot2_f32_bf16 v155, v111, s79, v155
v_dot2_f32_bf16 v171, v108, v108, 0
v_dot2_f32_bf16 v171, v109, v109, v171
v_dot2_f32_bf16 v171, v110, v110, v171
v_dot2_f32_bf16 v171, v111, v111, v171
v_lshlrev_b32 v104, 16, v108
v_and_b32 v105, s85, v108
v_lshlrev_b32 v106, 16, v109
buffer_load_dwordx4 v11, s[8:11], s98 offen offset:3072 lds
v_and_b32 v107, s85, v109
v_lshlrev_b32 v108, 16, v110
v_and_b32 v109, s85, v110
v_lshlrev_b32 v110, 16, v111
v_and_b32 v111, s85, v111
s_waitcnt vmcnt(7)
v_dot2_f32_bf16 v156, v116, s79, 0
v_dot2_f32_bf16 v156, v117, s79, v156
v_dot2_f32_bf16 v156, v118, s79, v156
v_dot2_f32_bf16 v156, v119, s79, v156
v_dot2_f32_bf16 v172, v116, v116, 0
v_dot2_f32_bf16 v172, v117, v117, v172
v_dot2_f32_bf16 v172, v118, v118, v172
v_dot2_f32_bf16 v172, v119, v119, v172
v_lshlrev_b32 v112, 16, v116
v_and_b32 v113, s85, v116
s_add_u32 m0, s80, 24576
s_add_u32 s98, s51, 1024
buffer_load_dwordx4 v8, s[8:11], s98 offen offset:0 lds
v_lshlrev_b32 v114, 16, v117
v_and_b32 v115, s85, v117
v_lshlrev_b32 v116, 16, v118
v_and_b32 v117, s85, v118
v_lshlrev_b32 v118, 16, v119
v_and_b32 v119, s85, v119
s_waitcnt vmcnt(7)
v_dot2_f32_bf16 v157, v124, s79, 0
v_dot2_f32_bf16 v157, v125, s79, v157
v_dot2_f32_bf16 v157, v126, s79, v157
v_dot2_f32_bf16 v157, v127, s79, v157
v_dot2_f32_bf16 v173, v124, v124, 0
v_dot2_f32_bf16 v173, v125, v125, v173
v_dot2_f32_bf16 v173, v126, v126, v173
v_dot2_f32_bf16 v173, v127, v127, v173
v_lshlrev_b32 v120, 16, v124
v_and_b32 v121, s85, v124
v_lshlrev_b32 v122, 16, v125
v_and_b32 v123, s85, v125
v_lshlrev_b32 v124, 16, v126
buffer_load_dwordx4 v9, s[8:11], s98 offen offset:1024 lds
v_and_b32 v125, s85, v126
v_lshlrev_b32 v126, 16, v127
v_and_b32 v127, s85, v127
s_waitcnt vmcnt(7)
v_dot2_f32_bf16 v158, v132, s79, 0
v_dot2_f32_bf16 v158, v133, s79, v158
v_dot2_f32_bf16 v158, v134, s79, v158
v_dot2_f32_bf16 v158, v135, s79, v158
v_dot2_f32_bf16 v174, v132, v132, 0
v_dot2_f32_bf16 v174, v133, v133, v174
v_dot2_f32_bf16 v174, v134, v134, v174
v_dot2_f32_bf16 v174, v135, v135, v174
v_lshlrev_b32 v128, 16, v132
v_and_b32 v129, s85, v132
v_lshlrev_b32 v130, 16, v133
v_and_b32 v131, s85, v133
buffer_load_dwordx4 v10, s[8:11], s98 offen offset:2048 lds
v_lshlrev_b32 v132, 16, v134
v_and_b32 v133, s85, v134
v_lshlrev_b32 v134, 16, v135
v_and_b32 v135, s85, v135
s_waitcnt vmcnt(7)
v_dot2_f32_bf16 v159, v140, s79, 0
v_dot2_f32_bf16 v159, v141, s79, v159
v_dot2_f32_bf16 v159, v142, s79, v159
v_dot2_f32_bf16 v159, v143, s79, v159
v_dot2_f32_bf16 v175, v140, v140, 0
v_dot2_f32_bf16 v175, v141, v141, v175
v_dot2_f32_bf16 v175, v142, v142, v175
v_dot2_f32_bf16 v175, v143, v143, v175
v_lshlrev_b32 v136, 16, v140
v_and_b32 v137, s85, v140
v_lshlrev_b32 v138, 16, v141
v_and_b32 v139, s85, v141
v_lshlrev_b32 v140, 16, v142
v_and_b32 v141, s85, v142
v_lshlrev_b32 v142, 16, v143
v_and_b32 v143, s85, v143
v_permlane32_swap_b32 v144, v152
v_permlane32_swap_b32 v145, v153
v_permlane32_swap_b32 v146, v154
v_permlane32_swap_b32 v147, v155
v_permlane32_swap_b32 v148, v156
v_permlane32_swap_b32 v149, v157
v_permlane32_swap_b32 v150, v158
v_permlane32_swap_b32 v151, v159
v_permlane32_swap_b32 v160, v168
v_permlane32_swap_b32 v161, v169
v_permlane32_swap_b32 v162, v170
v_permlane32_swap_b32 v163, v171
v_permlane32_swap_b32 v164, v172
v_permlane32_swap_b32 v165, v173
v_permlane32_swap_b32 v166, v174
v_permlane32_swap_b32 v167, v175
v_add_f32 v144, v144, v152
buffer_load_dwordx4 v11, s[8:11], s98 offen offset:3072 lds
v_add_f32 v145, v145, v153
v_add_f32 v146, v146, v154
v_add_f32 v147, v147, v155
v_add_f32 v148, v148, v156
v_add_f32 v149, v149, v157
v_add_f32 v150, v150, v158
v_add_f32 v151, v151, v159
v_add_f32 v160, v160, v168
v_add_f32 v161, v161, v169
v_add_f32 v162, v162, v170
v_add_f32 v163, v163, v171
v_add_f32 v164, v164, v172
v_add_f32 v165, v165, v173
v_add_f32 v166, v166, v174
v_add_f32 v167, v167, v175
v_permlane16_swap_b32 v144, v148
v_permlane16_swap_b32 v145, v149
v_permlane16_swap_b32 v146, v150
v_permlane16_swap_b32 v147, v151
s_add_u32 m0, s80, 40960
s_add_u32 s98, s52, 1024
buffer_load_dwordx4 v8, s[8:11], s98 offen offset:0 lds
v_permlane16_swap_b32 v160, v164
v_permlane16_swap_b32 v161, v165
v_permlane16_swap_b32 v162, v166
v_permlane16_swap_b32 v163, v167
v_add_f32 v144, v144, v148
v_add_f32 v145, v145, v149
v_add_f32 v146, v146, v150
v_add_f32 v147, v147, v151
v_add_f32 v160, v160, v164
v_add_f32 v161, v161, v165
v_add_f32 v162, v162, v166
v_add_f32 v163, v163, v167
v_add_f32_dpp v144, v144, v144 row_ror:8 row_mask:0xf bank_mask:0xf
v_add_f32_dpp v145, v145, v145 row_ror:8 row_mask:0xf bank_mask:0xf
v_add_f32_dpp v146, v146, v146 row_ror:8 row_mask:0xf bank_mask:0xf
v_add_f32_dpp v147, v147, v147 row_ror:8 row_mask:0xf bank_mask:0xf
v_add_f32_dpp v160, v160, v160 row_ror:8 row_mask:0xf bank_mask:0xf
v_add_f32_dpp v161, v161, v161 row_ror:8 row_mask:0xf bank_mask:0xf
buffer_load_dwordx4 v9, s[8:11], s98 offen offset:1024 lds
v_add_f32_dpp v162, v162, v162 row_ror:8 row_mask:0xf bank_mask:0xf
v_add_f32_dpp v163, v163, v163 row_ror:8 row_mask:0xf bank_mask:0xf
v_add_f32_dpp v144, v144, v144 row_ror:4 row_mask:0xf bank_mask:0xf
v_add_f32_dpp v145, v145, v145 row_ror:4 row_mask:0xf bank_mask:0xf
v_add_f32_dpp v146, v146, v146 row_ror:4 row_mask:0xf bank_mask:0xf
v_add_f32_dpp v147, v147, v147 row_ror:4 row_mask:0xf bank_mask:0xf
v_add_f32_dpp v160, v160, v160 row_ror:4 row_mask:0xf bank_mask:0xf
v_add_f32_dpp v161, v161, v161 row_ror:4 row_mask:0xf bank_mask:0xf
v_add_f32_dpp v162, v162, v162 row_ror:4 row_mask:0xf bank_mask:0xf
v_add_f32_dpp v163, v163, v163 row_ror:4 row_mask:0xf bank_mask:0xf
v_add_f32_dpp v144, v144, v144 row_ror:2 row_mask:0xf bank_mask:0xf
v_add_f32_dpp v145, v145, v145 row_ror:2 row_mask:0xf bank_mask:0xf
v_add_f32_dpp v146, v146, v146 row_ror:2 row_mask:0xf bank_mask:0xf
v_add_f32_dpp v147, v147, v147 row_ror:2 row_mask:0xf bank_mask:0xf
v_add_f32_dpp v160, v160, v160 row_ror:2 row_mask:0xf bank_mask:0xf
v_add_f32_dpp v161, v161, v161 row_ror:2 row_mask:0xf bank_mask:0xf
v_add_f32_dpp v162, v162, v162 row_ror:2 row_mask:0xf bank_mask:0xf
v_add_f32_dpp v163, v163, v163 row_ror:2 row_mask:0xf bank_mask:0xf
v_add_f32_dpp v144, v144, v144 row_ror:1 row_mask:0xf bank_mask:0xf
v_add_f32_dpp v145, v145, v145 row_ror:1 row_mask:0xf bank_mask:0xf
buffer_load_dwordx4 v10, s[8:11], s98 offen offset:2048 lds
v_add_f32_dpp v146, v146, v146 row_ror:1 row_mask:0xf bank_mask:0xf
v_add_f32_dpp v147, v147, v147 row_ror:1 row_mask:0xf bank_mask:0xf
v_add_f32_dpp v160, v160, v160 row_ror:1 row_mask:0xf bank_mask:0xf
v_add_f32_dpp v161, v161, v161 row_ror:1 row_mask:0xf bank_mask:0xf
v_add_f32_dpp v162, v162, v162 row_ror:1 row_mask:0xf bank_mask:0xf
v_add_f32_dpp v163, v163, v163 row_ror:1 row_mask:0xf bank_mask:0xf
s_mov_b32 s78, 0x3b000000
v_mul_f32 v144, s78, v144
v_mul_f32 v145, s78, v145
v_mul_f32 v146, s78, v146
v_mul_f32 v147, s78, v147
v_mul_f32 v176, v144, v144
v_mul_f32 v177, v145, v145
v_mul_f32 v178, v146, v146
v_mul_f32 v179, v147, v147
v_fma_f32 v160, v160, s78, -v176
v_fma_f32 v161, v161, s78, -v177
v_fma_f32 v162, v162, s78, -v178
v_fma_f32 v163, v163, s78, -v179
v_max_f32 v160, 0, v160
buffer_load_dwordx4 v11, s[8:11], s98 offen offset:3072 lds
v_max_f32 v161, 0, v161
v_max_f32 v162, 0, v162
v_max_f32 v163, 0, v163
v_add_f32 v160, 0x3727c5ac, v160
v_add_f32 v161, 0x3727c5ac, v161
v_add_f32 v162, 0x3727c5ac, v162
v_add_f32 v163, 0x3727c5ac, v163
v_rsq_f32 v176, v160
v_rsq_f32 v177, v161
v_rsq_f32 v178, v162
v_rsq_f32 v179, v163
v_mul_f32_e64 v180, -v144, v176
v_mul_f32_e64 v181, -v145, v177
v_mul_f32_e64 v182, -v146, v178
v_mul_f32_e64 v183, -v147, v179
s_add_u32 m0, s80, 57344
s_add_u32 s98, s53, 1024
buffer_load_dwordx4 v8, s[8:11], s98 offen offset:0 lds
v_mov_b32 v144, v176
v_mov_b32 v152, v176
v_mov_b32 v146, v177
v_mov_b32 v154, v177
v_mov_b32 v148, v178
v_mov_b32 v156, v178
v_mov_b32 v150, v179
v_mov_b32 v158, v179
v_mov_b32 v145, v180
v_mov_b32 v153, v180
v_mov_b32 v147, v181
v_mov_b32 v155, v181
v_mov_b32 v149, v182
v_mov_b32 v157, v182
v_mov_b32 v151, v183
v_mov_b32 v159, v183
v_permlane16_swap_b32 v144, v152
v_permlane16_swap_b32 v146, v154
buffer_load_dwordx4 v9, s[8:11], s98 offen offset:1024 lds
v_permlane16_swap_b32 v148, v156
v_permlane16_swap_b32 v150, v158
v_permlane16_swap_b32 v145, v153
v_permlane16_swap_b32 v147, v155
v_permlane16_swap_b32 v149, v157
v_permlane16_swap_b32 v151, v159
v_mov_b32 v160, v144
v_mov_b32 v162, v146
v_mov_b32 v164, v148
v_mov_b32 v166, v150
v_mov_b32 v168, v152
v_mov_b32 v170, v154
v_mov_b32 v172, v156
v_mov_b32 v174, v158
v_mov_b32 v161, v145
v_mov_b32 v163, v147
v_mov_b32 v165, v149
v_mov_b32 v167, v151
v_mov_b32 v169, v153
v_mov_b32 v171, v155
buffer_load_dwordx4 v10, s[8:11], s98 offen offset:2048 lds
v_mov_b32 v173, v157
v_mov_b32 v175, v159
v_permlane32_swap_b32 v144, v160
v_permlane32_swap_b32 v146, v162
v_permlane32_swap_b32 v148, v164
v_permlane32_swap_b32 v150, v166
v_permlane32_swap_b32 v152, v168
v_permlane32_swap_b32 v154, v170
v_permlane32_swap_b32 v156, v172
v_permlane32_swap_b32 v158, v174
v_permlane32_swap_b32 v145, v161
v_permlane32_swap_b32 v147, v163
v_permlane32_swap_b32 v149, v165
v_permlane32_swap_b32 v151, v167
v_permlane32_swap_b32 v153, v169
v_permlane32_swap_b32 v155, v171
v_permlane32_swap_b32 v157, v173
v_permlane32_swap_b32 v159, v175
v_pk_fma_f32 v[16:17], v[16:17], v[144:145], v[144:145] op_sel:[0,0,1] op_sel_hi:[1,0,1]
v_pk_fma_f32 v[18:19], v[18:19], v[144:145], v[144:145] op_sel:[0,0,1] op_sel_hi:[1,0,1]
buffer_load_dwordx4 v11, s[8:11], s98 offen offset:3072 lds
v_pk_fma_f32 v[20:21], v[20:21], v[144:145], v[144:145] op_sel:[0,0,1] op_sel_hi:[1,0,1]
v_pk_fma_f32 v[22:23], v[22:23], v[144:145], v[144:145] op_sel:[0,0,1] op_sel_hi:[1,0,1]
v_pk_fma_f32 v[24:25], v[24:25], v[146:147], v[146:147] op_sel:[0,0,1] op_sel_hi:[1,0,1]
v_pk_fma_f32 v[26:27], v[26:27], v[146:147], v[146:147] op_sel:[0,0,1] op_sel_hi:[1,0,1]
v_pk_fma_f32 v[28:29], v[28:29], v[146:147], v[146:147] op_sel:[0,0,1] op_sel_hi:[1,0,1]
v_pk_fma_f32 v[30:31], v[30:31], v[146:147], v[146:147] op_sel:[0,0,1] op_sel_hi:[1,0,1]
v_pk_fma_f32 v[32:33], v[32:33], v[148:149], v[148:149] op_sel:[0,0,1] op_sel_hi:[1,0,1]
v_pk_fma_f32 v[34:35], v[34:35], v[148:149], v[148:149] op_sel:[0,0,1] op_sel_hi:[1,0,1]
v_pk_fma_f32 v[36:37], v[36:37], v[148:149], v[148:149] op_sel:[0,0,1] op_sel_hi:[1,0,1]
v_pk_fma_f32 v[38:39], v[38:39], v[148:149], v[148:149] op_sel:[0,0,1] op_sel_hi:[1,0,1]
v_pk_fma_f32 v[40:41], v[40:41], v[150:151], v[150:151] op_sel:[0,0,1] op_sel_hi:[1,0,1]
v_pk_fma_f32 v[42:43], v[42:43], v[150:151], v[150:151] op_sel:[0,0,1] op_sel_hi:[1,0,1]
v_pk_fma_f32 v[44:45], v[44:45], v[150:151], v[150:151] op_sel:[0,0,1] op_sel_hi:[1,0,1]
v_pk_fma_f32 v[46:47], v[46:47], v[150:151], v[150:151] op_sel:[0,0,1] op_sel_hi:[1,0,1]
v_pk_fma_f32 v[48:49], v[48:49], v[152:153], v[152:153] op_sel:[0,0,1] op_sel_hi:[1,0,1]
v_pk_fma_f32 v[50:51], v[50:51], v[152:153], v[152:153] op_sel:[0,0,1] op_sel_hi:[1,0,1]
v_pk_fma_f32 v[52:53], v[52:53], v[152:153], v[152:153] op_sel:[0,0,1] op_sel_hi:[1,0,1]
v_pk_fma_f32 v[54:55], v[54:55], v[152:153], v[152:153] op_sel:[0,0,1] op_sel_hi:[1,0,1]
v_pk_fma_f32 v[56:57], v[56:57], v[154:155], v[154:155] op_sel:[0,0,1] op_sel_hi:[1,0,1]
s_add_u32 m0, s80, 73728
s_add_u32 s98, s50, 2048
buffer_load_dwordx4 v8, s[8:11], s98 offen offset:0 lds
v_pk_fma_f32 v[58:59], v[58:59], v[154:155], v[154:155] op_sel:[0,0,1] op_sel_hi:[1,0,1]
v_pk_fma_f32 v[60:61], v[60:61], v[154:155], v[154:155] op_sel:[0,0,1] op_sel_hi:[1,0,1]
v_pk_fma_f32 v[62:63], v[62:63], v[154:155], v[154:155] op_sel:[0,0,1] op_sel_hi:[1,0,1]
v_pk_fma_f32 v[64:65], v[64:65], v[156:157], v[156:157] op_sel:[0,0,1] op_sel_hi:[1,0,1]
v_pk_fma_f32 v[66:67], v[66:67], v[156:157], v[156:157] op_sel:[0,0,1] op_sel_hi:[1,0,1]
v_pk_fma_f32 v[68:69], v[68:69], v[156:157], v[156:157] op_sel:[0,0,1] op_sel_hi:[1,0,1]
v_pk_fma_f32 v[70:71], v[70:71], v[156:157], v[156:157] op_sel:[0,0,1] op_sel_hi:[1,0,1]
v_pk_fma_f32 v[72:73], v[72:73], v[158:159], v[158:159] op_sel:[0,0,1] op_sel_hi:[1,0,1]
v_pk_fma_f32 v[74:75], v[74:75], v[158:159], v[158:159] op_sel:[0,0,1] op_sel_hi:[1,0,1]
v_pk_fma_f32 v[76:77], v[76:77], v[158:159], v[158:159] op_sel:[0,0,1] op_sel_hi:[1,0,1]
v_pk_fma_f32 v[78:79], v[78:79], v[158:159], v[158:159] op_sel:[0,0,1] op_sel_hi:[1,0,1]
v_pk_fma_f32 v[80:81], v[80:81], v[160:161], v[160:161] op_sel:[0,0,1] op_sel_hi:[1,0,1]
v_pk_fma_f32 v[82:83], v[82:83], v[160:161], v[160:161] op_sel:[0,0,1] op_sel_hi:[1,0,1]
v_pk_fma_f32 v[84:85], v[84:85], v[160:161], v[160:161] op_sel:[0,0,1] op_sel_hi:[1,0,1]
v_pk_fma_f32 v[86:87], v[86:87], v[160:161], v[160:161] op_sel:[0,0,1] op_sel_hi:[1,0,1]
v_pk_fma_f32 v[88:89], v[88:89], v[162:163], v[162:163] op_sel:[0,0,1] op_sel_hi:[1,0,1]
v_pk_fma_f32 v[90:91], v[90:91], v[162:163], v[162:163] op_sel:[0,0,1] op_sel_hi:[1,0,1]
v_pk_fma_f32 v[92:93], v[92:93], v[162:163], v[162:163] op_sel:[0,0,1] op_sel_hi:[1,0,1]
buffer_load_dwordx4 v9, s[8:11], s98 offen offset:1024 lds
v_pk_fma_f32 v[94:95], v[94:95], v[162:163], v[162:163] op_sel:[0,0,1] op_sel_hi:[1,0,1]
v_pk_fma_f32 v[96:97], v[96:97], v[164:165], v[164:165] op_sel:[0,0,1] op_sel_hi:[1,0,1]
v_pk_fma_f32 v[98:99], v[98:99], v[164:165], v[164:165] op_sel:[0,0,1] op_sel_hi:[1,0,1]
v_pk_fma_f32 v[100:101], v[100:101], v[164:165], v[164:165] op_sel:[0,0,1] op_sel_hi:[1,0,1]
v_pk_fma_f32 v[102:103], v[102:103], v[164:165], v[164:165] op_sel:[0,0,1] op_sel_hi:[1,0,1]
v_pk_fma_f32 v[104:105], v[104:105], v[166:167], v[166:167] op_sel:[0,0,1] op_sel_hi:[1,0,1]
v_pk_fma_f32 v[106:107], v[106:107], v[166:167], v[166:167] op_sel:[0,0,1] op_sel_hi:[1,0,1]
v_pk_fma_f32 v[108:109], v[108:109], v[166:167], v[166:167] op_sel:[0,0,1] op_sel_hi:[1,0,1]
v_pk_fma_f32 v[110:111], v[110:111], v[166:167], v[166:167] op_sel:[0,0,1] op_sel_hi:[1,0,1]
v_pk_fma_f32 v[112:113], v[112:113], v[168:169], v[168:169] op_sel:[0,0,1] op_sel_hi:[1,0,1]
v_pk_fma_f32 v[114:115], v[114:115], v[168:169], v[168:169] op_sel:[0,0,1] op_sel_hi:[1,0,1]
v_pk_fma_f32 v[116:117], v[116:117], v[168:169], v[168:169] op_sel:[0,0,1] op_sel_hi:[1,0,1]
v_pk_fma_f32 v[118:119], v[118:119], v[168:169], v[168:169] op_sel:[0,0,1] op_sel_hi:[1,0,1]
v_pk_fma_f32 v[120:121], v[120:121], v[170:171], v[170:171] op_sel:[0,0,1] op_sel_hi:[1,0,1]
v_pk_fma_f32 v[122:123], v[122:123], v[170:171], v[170:171] op_sel:[0,0,1] op_sel_hi:[1,0,1]
v_pk_fma_f32 v[124:125], v[124:125], v[170:171], v[170:171] op_sel:[0,0,1] op_sel_hi:[1,0,1]
v_pk_fma_f32 v[126:127], v[126:127], v[170:171], v[170:171] op_sel:[0,0,1] op_sel_hi:[1,0,1]
v_pk_fma_f32 v[128:129], v[128:129], v[172:173], v[172:173] op_sel:[0,0,1] op_sel_hi:[1,0,1]
v_pk_fma_f32 v[130:131], v[130:131], v[172:173], v[172:173] op_sel:[0,0,1] op_sel_hi:[1,0,1]
v_pk_fma_f32 v[132:133], v[132:133], v[172:173], v[172:173] op_sel:[0,0,1] op_sel_hi:[1,0,1]
buffer_load_dwordx4 v10, s[8:11], s98 offen offset:2048 lds
v_pk_fma_f32 v[134:135], v[134:135], v[172:173], v[172:173] op_sel:[0,0,1] op_sel_hi:[1,0,1]
v_pk_fma_f32 v[136:137], v[136:137], v[174:175], v[174:175] op_sel:[0,0,1] op_sel_hi:[1,0,1]
v_pk_fma_f32 v[138:139], v[138:139], v[174:175], v[174:175] op_sel:[0,0,1] op_sel_hi:[1,0,1]
v_pk_fma_f32 v[140:141], v[140:141], v[174:175], v[174:175] op_sel:[0,0,1] op_sel_hi:[1,0,1]
v_pk_fma_f32 v[142:143], v[142:143], v[174:175], v[174:175] op_sel:[0,0,1] op_sel_hi:[1,0,1]
buffer_load_dwordx4 v[144:147], v2, s[24:27], s83 offen offset:0 sc1
buffer_load_dwordx4 v[148:151], v2, s[24:27], s83 offen offset:1024 sc1
buffer_load_dwordx4 v[152:155], v2, s[24:27], s67 offen offset:0 sc1
buffer_load_dwordx4 v[156:159], v2, s[24:27], s67 offen offset:1024 sc1
buffer_load_dwordx4 v[160:163], v2, s[24:27], s54 offen offset:0 sc1
buffer_load_dwordx4 v[164:167], v2, s[24:27], s54 offen offset:1024 sc1
buffer_load_dwordx4 v[168:171], v2, s[24:27], s55 offen offset:0 sc1
buffer_load_dwordx4 v[172:175], v2, s[24:27], s55 offen offset:1024 sc1
s_waitcnt lgkmcnt(0)
s_add_u32 s72, s72, 0x9e3779b9
v_bfe_u32 v5, v0, 3, 2
v_xor_b32 v5, s73, v5
v_lshlrev_b32 v5, 5, v5
v_and_b32 v6, 3, v0
v_lshl_add_u32 v5, v6, 3, v5
v_lshrrev_b32 v6, 4, v0
v_lshl_add_u32 v5, v6, 10, v5
v_bfe_u32 v6, v0, 2, 2
v_lshl_add_u32 v12, v6, 7, v5
v_add_u32 v13, 73728, v12
v_add_u32 v12, 8192, v12
v_mov_b32 v15, s72
v_cmp_eq_u32 vcc, 0, v0
v_mov_b32 v14, 0x2000000
s_nop 0
v_cndmask_b32 v14, v14, 0, vcc
v_lshlrev_b32 v226, 16, v224
v_and_b32 v227, s85, v224
v_mul_f32 v228, 0xbfb8aa3b, v226
v_mul_f32 v229, 0xbfb8aa3b, v227
v_exp_f32 v228, v228
v_exp_f32 v229, v229
v_add_f32 v228, 1.0, v228
v_add_f32 v229, 1.0, v229
v_rcp_f32 v228, v228
v_rcp_f32 v229, v229
v_mul_f32 v226, v226, v228
v_mul_f32 v227, v227, v229
v_cvt_pk_bf16_f32 v224, v226, v227
v_lshlrev_b32 v226, 16, v224
v_and_b32 v227, s85, v224
v_lshlrev_b32 v232, 16, v216
v_and_b32 v233, s85, v216
v_lshlrev_b32 v234, 16, v217
v_and_b32 v235, s85, v217
v_lshlrev_b32 v236, 16, v218
v_and_b32 v237, s85, v218
v_lshlrev_b32 v238, 16, v219
v_and_b32 v239, s85, v219
v_mul_f32 v232, v226, v232
v_mul_f32 v233, v226, v233
v_mul_f32 v234, v226, v234
v_mul_f32 v235, v226, v235
v_mul_f32 v236, v226, v236
v_mul_f32 v237, v226, v237
v_mul_f32 v238, v226, v238
v_mul_f32 v239, v226, v239
v_lshlrev_b32 v216, 16, v220
v_and_b32 v217, s85, v220
v_fmac_f32 v232, v227, v216
v_fmac_f32 v233, v227, v217
v_lshlrev_b32 v216, 16, v221
v_and_b32 v217, s85, v221
v_fmac_f32 v234, v227, v216
v_fmac_f32 v235, v227, v217
v_lshlrev_b32 v216, 16, v222
v_and_b32 v217, s85, v222
v_fmac_f32 v236, v227, v216
v_fmac_f32 v237, v227, v217
v_lshlrev_b32 v216, 16, v223
v_and_b32 v217, s85, v223
v_fmac_f32 v238, v227, v216
v_fmac_f32 v239, v227, v217
v_permlane32_swap_b32 v232, v236
v_permlane32_swap_b32 v233, v237
v_permlane32_swap_b32 v234, v238
v_permlane32_swap_b32 v235, v239
v_add_f32 v232, v232, v236
v_add_f32 v233, v233, v237
v_add_f32 v234, v234, v238
v_add_f32 v235, v235, v239
s_nop 0
v_permlane16_swap_b32 v232, v234
v_permlane16_swap_b32 v233, v235
v_add_f32 v232, v232, v234
v_add_f32 v233, v233, v235
s_lshl_b32 s99, s73, 9
s_add_u32 s99, s99, 155648
v_lshl_add_u32 v216, v0, 3, s99
v_add_f32_dpp v232, v232, v232 row_ror:8 row_mask:0xf bank_mask:0xf
v_add_f32_dpp v233, v233, v233 row_ror:8 row_mask:0xf bank_mask:0xf
ds_write_b64 v216, v[232:233]
s_waitcnt vmcnt(11)
s_barrier
ds_read_b64_tr_b16 v[176:177], v12 offset:0
ds_read_b64_tr_b16 v[178:179], v12 offset:512
ds_read_b64_tr_b16 v[180:181], v12 offset:4096
buffer_load_dwordx4 v11, s[8:11], s98 offen offset:3072 lds
ds_read_b64_tr_b16 v[182:183], v12 offset:4608
ds_read_b64_tr_b16 v[184:185], v12 offset:8192
ds_read_b64_tr_b16 v[186:187], v12 offset:8704
ds_read_b64_tr_b16 v[188:189], v12 offset:12288
ds_read_b64_tr_b16 v[190:191], v12 offset:12800
s_add_u32 m0, s59, 0
s_nop 0
buffer_load_dwordx4 v1, s[40:43], s56 offen nt lds
ds_read_b64_tr_b16 v[192:193], v12 offset:16384
ds_read_b64_tr_b16 v[194:195], v12 offset:16896
ds_read_b64_tr_b16 v[196:197], v12 offset:20480
ds_read_b64_tr_b16 v[198:199], v12 offset:20992
s_add_u32 m0, s59, 1024
s_add_u32 s56, s56, s58
buffer_load_dwordx4 v1, s[40:43], s56 offen nt lds
ds_read_b64_tr_b16 v[200:201], v12 offset:24576
ds_read_b64_tr_b16 v[202:203], v12 offset:25088
ds_read_b64_tr_b16 v[204:205], v12 offset:28672
ds_read_b64_tr_b16 v[206:207], v12 offset:29184
ds_read_b64_tr_b16 v[208:209], v12 offset:32768
s_add_u32 m0, s59, 2048
s_nop 0
buffer_load_dwordx4 v1, s[44:47], s57 offen nt lds
ds_read_b64_tr_b16 v[210:211], v12 offset:33280
ds_read_b64_tr_b16 v[212:213], v12 offset:36864
ds_read_b64_tr_b16 v[214:215], v12 offset:37376
ds_read_b64_tr_b16 v[216:217], v12 offset:40960
s_add_u32 m0, s59, 3072
s_add_u32 s57, s57, s58
buffer_load_dwordx4 v1, s[44:47], s57 offen nt lds
ds_read_b64_tr_b16 v[218:219], v12 offset:41472
ds_read_b64_tr_b16 v[220:221], v12 offset:45056
ds_read_b64_tr_b16 v[222:223], v12 offset:45568
ds_read_b64_tr_b16 v[224:225], v12 offset:49152
v_accvgpr_read_b32 v1, a252
buffer_load_dword a254, v1, s[8:11], s69 offen
ds_read_b64_tr_b16 v[226:227], v12 offset:49664
ds_read_b64_tr_b16 v[228:229], v12 offset:53248
ds_read_b64_tr_b16 v[230:231], v12 offset:53760
ds_read_b64_tr_b16 v[232:233], v12 offset:57344
ds_read_b64_tr_b16 v[234:235], v12 offset:57856
buffer_load_dword a255, v3, s[24:27], s66 offen
ds_read_b64_tr_b16 v[236:237], v12 offset:61440
ds_read_b64_tr_b16 v[238:239], v12 offset:61952
s_lshl_b32 s78, s73, 9
v_lshl_add_u32 v5, v0, 2, s78
s_cmp_ge_u32 s73, 2
s_cselect_b32 s79, 1.0, 0
s_waitcnt vmcnt(13)
v_min3_u32 v6, v145, v147, v149
v_max3_u32 v7, v145, v147, v149
s_waitcnt vmcnt(12)
v_min3_u32 v6, v6, v151, v153
v_max3_u32 v7, v7, v151, v153
s_waitcnt vmcnt(11)
v_min3_u32 v6, v6, v155, v157
v_max3_u32 v7, v7, v155, v157
s_waitcnt vmcnt(10)
v_min3_u32 v6, v6, v159, v161
v_max3_u32 v7, v7, v159, v161
s_waitcnt vmcnt(9)
v_min3_u32 v6, v6, v163, v165
v_max3_u32 v7, v7, v163, v165
s_waitcnt vmcnt(8)
v_min3_u32 v6, v6, v167, v169
v_max3_u32 v7, v7, v167, v169
s_waitcnt vmcnt(7)
v_min3_u32 v6, v6, v171, v173
v_max3_u32 v7, v7, v171, v173
v_min3_u32 v6, v6, v175, v175
v_max3_u32 v7, v7, v175, v175
v_cmp_ne_u32 vcc, s72, v6
v_cmp_ne_u32 s[86:87], s72, v7
s_nop 0
s_or_b64 vcc, vcc, s[86:87]
s_cbranch_vccnz L_poll_2
L_ret_3:
v_add_f32 v144, v144, v160
v_add_f32 v146, v146, v162
v_add_f32 v148, v148, v164
v_add_f32 v150, v150, v166
v_add_f32 v152, v152, v168
v_add_f32 v154, v154, v170
v_add_f32 v156, v156, v172
v_add_f32 v158, v158, v174
v_add_f32 v144, v144, v152
v_add_f32 v146, v146, v154
v_add_f32 v148, v148, v156
v_add_f32 v150, v150, v158
v_cvt_pk_bf16_f32 v152, v144, v146
v_cvt_pk_bf16_f32 v153, v148, v150
v_lshlrev_b32 v144, 16, v152
v_and_b32 v145, s85, v152
v_lshlrev_b32 v146, 16, v153
v_and_b32 v147, s85, v153
v_add_f32 v144, s79, v144
v_add_f32 v145, s79, v145
v_add_f32 v146, s79, v146
v_add_f32 v147, s79, v147
v_cvt_pk_bf16_f32 v152, v144, v145
v_cvt_pk_bf16_f32 v153, v146, v147
ds_write2st64_b32 v5, v152, v153 offset0:0 offset1:1
s_lshl_b32 s78, s49, 8
v_subrev_u32 v160, s78, v2
v_and_b32 v160, 0x3f0, v160
s_lshl_b32 s78, s73, 14
s_add_u32 s78, s78, 8192
v_add_u32 v174, s78, v160
s_add_u32 s78, s74, 0
s_and_b32 s78, s78, 3
s_lshl_b32 s78, s78, 6
v_xor_b32 v154, s78, v174
s_lshl_b32 s78, s78, 6
v_add_u32 v154, s78, v154
s_add_u32 s78, s74, 1
s_and_b32 s78, s78, 3
s_lshl_b32 s78, s78, 6
v_xor_b32 v155, s78, v174
s_lshl_b32 s78, s78, 6
v_add_u32 v155, s78, v155
s_add_u32 s78, s74, 2
s_and_b32 s78, s78, 3
s_lshl_b32 s78, s78, 6
v_xor_b32 v156, s78, v174
s_lshl_b32 s78, s78, 6
v_add_u32 v156, s78, v156
s_add_u32 s78, s74, 3
s_and_b32 s78, s78, 3
s_lshl_b32 s78, s78, 6
v_xor_b32 v157, s78, v174
s_lshl_b32 s78, s78, 6
v_add_u32 v157, s78, v157
v_and_b32 v6, 15, v0
v_lshrrev_b32 v7, 4, v0
v_xor_b32 v7, v7, v6
v_lshlrev_b32 v6, 10, v6
v_lshl_add_u32 v4, v7, 4, v6
v_add_u32 v4, 8192, v4
s_waitcnt lgkmcnt(0)
s_barrier
ds_read_b128 v[144:147], v2 offset:0
ds_read_b128 v[148:151], v2 offset:1024
v_xor_b32 v5, 64, v4
v_xor_b32 v6, 128, v4
v_xor_b32 v7, 192, v4
v_lshlrev_b32 v160, 3, v0
v_add_u32 v160, 155648, v160
ds_read_b64 v[164:165], v160 offset:0
ds_read_b64 v[166:167], v160 offset:512
ds_read_b64 v[168:169], v160 offset:1024
ds_read_b64 v[170:171], v160 offset:1536
v_and_b32 v161, 7, v0
v_lshlrev_b32 v161, 2, v161
v_lshrrev_b32 v162, 5, v0
v_lshl_add_u32 v161, v162, 1, v161
v_bfe_u32 v162, v0, 4, 1
v_add_u32 v161, v161, v162
v_lshlrev_b32 v161, 4, v161
v_and_b32 v162, 8, v0
v_lshl_add_u32 v161, v162, 22, v161
s_lshl_b32 s71, s2, 9
s_add_u32 s71, s71, 917504
s_cmp_eq_u32 s73, 0
s_cselect_b32 s71, s71, 0x2000000
s_waitcnt lgkmcnt(2)
v_pk_add_f32 v[164:165], v[164:165], v[166:167]
s_waitcnt lgkmcnt(0)
v_pk_add_f32 v[168:169], v[168:169], v[170:171]
v_pk_add_f32 v[164:165], v[164:165], v[168:169]
v_mov_b32 v166, v165
v_mov_b32 v165, v15
v_mov_b32 v167, v15
s_getreg_b32 s99, hwreg(HW_REG_XCC_ID, 0, 4)
v_mov_b32 v172, s99
v_mov_b32 v173, s72
s_lshl_b32 s99, s2, 3
s_add_u32 s99, s99, 4096
s_cmp_eq_u32 s73, 0
s_cselect_b32 s70, s99, 0x2000000
v_lshlrev_b32 v240, 16, v144
v_and_b32 v241, s85, v144
v_lshlrev_b32 v242, 16, v145
v_and_b32 v243, s85, v145
v_lshlrev_b32 v244, 16, v146
v_and_b32 v245, s85, v146
v_lshlrev_b32 v246, 16, v147
v_and_b32 v247, s85, v147
v_lshlrev_b32 v248, 16, v148
v_and_b32 v249, s85, v148
v_lshlrev_b32 v250, 16, v149
v_and_b32 v251, s85, v149
v_lshlrev_b32 v252, 16, v150
v_and_b32 v253, s85, v150
v_lshlrev_b32 v254, 16, v151
v_and_b32 v255, s85, v151
v_pk_fma_f32 v[16:17], v[16:17], v[248:249], v[240:241]
v_pk_fma_f32 v[18:19], v[18:19], v[250:251], v[242:243]
v_pk_fma_f32 v[20:21], v[20:21], v[252:253], v[244:245]
v_pk_fma_f32 v[22:23], v[22:23], v[254:255], v[246:247]
v_xor_b32 v152, 0, v154
v_cvt_pk_bf16_f32 v16, v16, v17
v_cvt_pk_bf16_f32 v17, v18, v19
v_cvt_pk_bf16_f32 v18, v20, v21
v_cvt_pk_bf16_f32 v19, v22, v23
ds_write_b128 v152, v[16:19] offset:0
v_pk_fma_f32 v[24:25], v[24:25], v[248:249], v[240:241]
v_pk_fma_f32 v[26:27], v[26:27], v[250:251], v[242:243]
v_pk_fma_f32 v[28:29], v[28:29], v[252:253], v[244:245]
v_pk_fma_f32 v[30:31], v[30:31], v[254:255], v[246:247]
v_xor_b32 v153, 16, v154
v_cvt_pk_bf16_f32 v24, v24, v25
v_cvt_pk_bf16_f32 v25, v26, v27
v_cvt_pk_bf16_f32 v26, v28, v29
v_cvt_pk_bf16_f32 v27, v30, v31
ds_write_b128 v153, v[24:27] offset:1024
v_pk_fma_f32 v[32:33], v[32:33], v[248:249], v[240:241]
v_pk_fma_f32 v[34:35], v[34:35], v[250:251], v[242:243]
v_pk_fma_f32 v[36:37], v[36:37], v[252:253], v[244:245]
v_pk_fma_f32 v[38:39], v[38:39], v[254:255], v[246:247]
v_xor_b32 v152, 32, v154
v_cvt_pk_bf16_f32 v32, v32, v33
v_cvt_pk_bf16_f32 v33, v34, v35
v_cvt_pk_bf16_f32 v34, v36, v37
v_cvt_pk_bf16_f32 v35, v38, v39
ds_write_b128 v152, v[32:35] offset:2048
v_pk_fma_f32 v[40:41], v[40:41], v[248:249], v[240:241]
v_pk_fma_f32 v[42:43], v[42:43], v[250:251], v[242:243]
v_pk_fma_f32 v[44:45], v[44:45], v[252:253], v[244:245]
v_pk_fma_f32 v[46:47], v[46:47], v[254:255], v[246:247]
v_xor_b32 v153, 48, v154
v_cvt_pk_bf16_f32 v40, v40, v41
v_cvt_pk_bf16_f32 v41, v42, v43
v_cvt_pk_bf16_f32 v42, v44, v45
v_cvt_pk_bf16_f32 v43, v46, v47
ds_write_b128 v153, v[40:43] offset:3072
v_pk_fma_f32 v[48:49], v[48:49], v[248:249], v[240:241]
v_pk_fma_f32 v[50:51], v[50:51], v[250:251], v[242:243]
v_pk_fma_f32 v[52:53], v[52:53], v[252:253], v[244:245]
v_pk_fma_f32 v[54:55], v[54:55], v[254:255], v[246:247]
v_xor_b32 v152, 0, v155
v_cvt_pk_bf16_f32 v48, v48, v49
v_cvt_pk_bf16_f32 v49, v50, v51
v_cvt_pk_bf16_f32 v50, v52, v53
v_cvt_pk_bf16_f32 v51, v54, v55
ds_write_b128 v152, v[48:51] offset:0
v_pk_fma_f32 v[56:57], v[56:57], v[248:249], v[240:241]
v_pk_fma_f32 v[58:59], v[58:59], v[250:251], v[242:243]
v_pk_fma_f32 v[60:61], v[60:61], v[252:253], v[244:245]
v_pk_fma_f32 v[62:63], v[62:63], v[254:255], v[246:247]
v_xor_b32 v153, 16, v155
v_cvt_pk_bf16_f32 v56, v56, v57
v_cvt_pk_bf16_f32 v57, v58, v59
v_cvt_pk_bf16_f32 v58, v60, v61
v_cvt_pk_bf16_f32 v59, v62, v63
ds_write_b128 v153, v[56:59] offset:1024
v_pk_fma_f32 v[64:65], v[64:65], v[248:249], v[240:241]
v_pk_fma_f32 v[66:67], v[66:67], v[250:251], v[242:243]
v_pk_fma_f32 v[68:69], v[68:69], v[252:253], v[244:245]
v_pk_fma_f32 v[70:71], v[70:71], v[254:255], v[246:247]
v_xor_b32 v152, 32, v155
v_cvt_pk_bf16_f32 v64, v64, v65
v_cvt_pk_bf16_f32 v65, v66, v67
v_cvt_pk_bf16_f32 v66, v68, v69
v_cvt_pk_bf16_f32 v67, v70, v71
ds_write_b128 v152, v[64:67] offset:2048
v_pk_fma_f32 v[72:73], v[72:73], v[248:249], v[240:241]
v_pk_fma_f32 v[74:75], v[74:75], v[250:251], v[242:243]
v_pk_fma_f32 v[76:77], v[76:77], v[252:253], v[244:245]
v_pk_fma_f32 v[78:79], v[78:79], v[254:255], v[246:247]
v_xor_b32 v153, 48, v155
v_cvt_pk_bf16_f32 v72, v72, v73
v_cvt_pk_bf16_f32 v73, v74, v75
v_cvt_pk_bf16_f32 v74, v76, v77
v_cvt_pk_bf16_f32 v75, v78, v79
ds_write_b128 v153, v[72:75] offset:3072
v_pk_fma_f32 v[80:81], v[80:81], v[248:249], v[240:241]
v_pk_fma_f32 v[82:83], v[82:83], v[250:251], v[242:243]
v_pk_fma_f32 v[84:85], v[84:85], v[252:253], v[244:245]
v_pk_fma_f32 v[86:87], v[86:87], v[254:255], v[246:247]
v_xor_b32 v152, 0, v156
v_cvt_pk_bf16_f32 v80, v80, v81
v_cvt_pk_bf16_f32 v81, v82, v83
v_cvt_pk_bf16_f32 v82, v84, v85
v_cvt_pk_bf16_f32 v83, v86, v87
ds_write_b128 v152, v[80:83] offset:0
v_pk_fma_f32 v[88:89], v[88:89], v[248:249], v[240:241]
v_pk_fma_f32 v[90:91], v[90:91], v[250:251], v[242:243]
v_pk_fma_f32 v[92:93], v[92:93], v[252:253], v[244:245]
v_pk_fma_f32 v[94:95], v[94:95], v[254:255], v[246:247]
v_xor_b32 v153, 16, v156
v_cvt_pk_bf16_f32 v88, v88, v89
v_cvt_pk_bf16_f32 v89, v90, v91
v_cvt_pk_bf16_f32 v90, v92, v93
v_cvt_pk_bf16_f32 v91, v94, v95
ds_write_b128 v153, v[88:91] offset:1024
v_pk_fma_f32 v[96:97], v[96:97], v[248:249], v[240:241]
v_pk_fma_f32 v[98:99], v[98:99], v[250:251], v[242:243]
v_pk_fma_f32 v[100:101], v[100:101], v[252:253], v[244:245]
v_pk_fma_f32 v[102:103], v[102:103], v[254:255], v[246:247]
v_xor_b32 v152, 32, v156
v_cvt_pk_bf16_f32 v96, v96, v97
v_cvt_pk_bf16_f32 v97, v98, v99
v_cvt_pk_bf16_f32 v98, v100, v101
v_cvt_pk_bf16_f32 v99, v102, v103
ds_write_b128 v152, v[96:99] offset:2048
v_pk_fma_f32 v[104:105], v[104:105], v[248:249], v[240:241]
v_pk_fma_f32 v[106:107], v[106:107], v[250:251], v[242:243]
v_pk_fma_f32 v[108:109], v[108:109], v[252:253], v[244:245]
v_pk_fma_f32 v[110:111], v[110:111], v[254:255], v[246:247]
v_xor_b32 v153, 48, v156
v_cvt_pk_bf16_f32 v104, v104, v105
v_cvt_pk_bf16_f32 v105, v106, v107
v_cvt_pk_bf16_f32 v106, v108, v109
v_cvt_pk_bf16_f32 v107, v110, v111
ds_write_b128 v153, v[104:107] offset:3072
v_pk_fma_f32 v[112:113], v[112:113], v[248:249], v[240:241]
v_pk_fma_f32 v[114:115], v[114:115], v[250:251], v[242:243]
v_pk_fma_f32 v[116:117], v[116:117], v[252:253], v[244:245]
v_pk_fma_f32 v[118:119], v[118:119], v[254:255], v[246:247]
v_xor_b32 v152, 0, v157
v_cvt_pk_bf16_f32 v112, v112, v113
v_cvt_pk_bf16_f32 v113, v114, v115
v_cvt_pk_bf16_f32 v114, v116, v117
v_cvt_pk_bf16_f32 v115, v118, v119
ds_write_b128 v152, v[112:115] offset:0
v_pk_fma_f32 v[120:121], v[120:121], v[248:249], v[240:241]
v_pk_fma_f32 v[122:123], v[122:123], v[250:251], v[242:243]
v_pk_fma_f32 v[124:125], v[124:125], v[252:253], v[244:245]
v_pk_fma_f32 v[126:127], v[126:127], v[254:255], v[246:247]
v_xor_b32 v153, 16, v157
v_cvt_pk_bf16_f32 v120, v120, v121
v_cvt_pk_bf16_f32 v121, v122, v123
v_cvt_pk_bf16_f32 v122, v124, v125
v_cvt_pk_bf16_f32 v123, v126, v127
ds_write_b128 v153, v[120:123] offset:1024
v_pk_fma_f32 v[128:129], v[128:129], v[248:249], v[240:241]
v_pk_fma_f32 v[130:131], v[130:131], v[250:251], v[242:243]
v_pk_fma_f32 v[132:133], v[132:133], v[252:253], v[244:245]
v_pk_fma_f32 v[134:135], v[134:135], v[254:255], v[246:247]
v_xor_b32 v152, 32, v157
v_cvt_pk_bf16_f32 v128, v128, v129
v_cvt_pk_bf16_f32 v129, v130, v131
v_cvt_pk_bf16_f32 v130, v132, v133
v_cvt_pk_bf16_f32 v131, v134, v135
ds_write_b128 v152, v[128:131] offset:2048
v_pk_fma_f32 v[136:137], v[136:137], v[248:249], v[240:241]
v_pk_fma_f32 v[138:139], v[138:139], v[250:251], v[242:243]
v_pk_fma_f32 v[140:141], v[140:141], v[252:253], v[244:245]
v_pk_fma_f32 v[142:143], v[142:143], v[254:255], v[246:247]
v_xor_b32 v153, 48, v157
v_cvt_pk_bf16_f32 v136, v136, v137
v_cvt_pk_bf16_f32 v137, v138, v139
v_cvt_pk_bf16_f32 v138, v140, v141
v_cvt_pk_bf16_f32 v139, v142, v143
ds_write_b128 v153, v[136:139] offset:3072
s_waitcnt lgkmcnt(0)
s_barrier
s_add_u32 m0, s80, 90112
s_add_u32 s98, s51, 2048
buffer_load_dwordx4 v8, s[8:11], s98 offen offset:0 lds
ds_read_b128 a[0:3], v4 offset:0
ds_read_b128 a[4:7], v4 offset:16384
ds_read_b128 a[8:11], v4 offset:32768
ds_read_b128 a[12:15], v4 offset:49152
buffer_load_dwordx4 v9, s[8:11], s98 offen offset:1024 lds
ds_read_b128 a[16:19], v5 offset:0
ds_read_b128 a[20:23], v5 offset:16384
s_waitcnt lgkmcnt(5)
v_mfma_f32_16x16x32_bf16 v[144:147], v[176:179], a[0:3], 0
buffer_load_dwordx4 v10, s[8:11], s98 offen offset:2048 lds
ds_read_b128 a[24:27], v5 offset:32768
s_waitcnt lgkmcnt(5)
v_mfma_f32_16x16x32_bf16 v[148:151], v[176:179], a[4:7], 0
ds_read_b128 a[28:31], v5 offset:49152
s_waitcnt lgkmcnt(5)
v_mfma_f32_16x16x32_bf16 v[152:155], v[176:179], a[8:11], 0
ds_read_b128 a[32:35], v6 offset:0
buffer_load_dwordx4 v11, s[8:11], s98 offen offset:3072 lds
s_waitcnt lgkmcnt(5)
v_mfma_f32_16x16x32_bf16 v[156:159], v[176:179], a[12:15], 0
ds_read_b128 a[36:39], v6 offset:16384
s_waitcnt lgkmcnt(5)
v_mfma_f32_16x16x32_bf16 v[144:147], v[180:183], a[16:19], v[144:147]
ds_read_b128 a[40:43], v6 offset:32768
s_waitcnt lgkmcnt(5)
v_mfma_f32_16x16x32_bf16 v[148:151], v[180:183], a[20:23], v[148:151]
s_add_u32 m0, s80, 106496
s_add_u32 s98, s52, 2048
buffer_load_dwordx4 v8, s[8:11], s98 offen offset:0 lds
ds_read_b128 a[44:47], v6 offset:49152
s_waitcnt lgkmcnt(5)
v_mfma_f32_16x16x32_bf16 v[152:155], v[180:183], a[24:27], v[152:155]
ds_read_b128 a[48:51], v7 offset:0
s_waitcnt lgkmcnt(5)
v_mfma_f32_16x16x32_bf16 v[156:159], v[180:183], a[28:31], v[156:159]
ds_read_b128 a[52:55], v7 offset:16384
buffer_load_dwordx4 v9, s[8:11], s98 offen offset:1024 lds
s_waitcnt lgkmcnt(5)
v_mfma_f32_16x16x32_bf16 v[144:147], v[184:187], a[32:35], v[144:147]
ds_read_b128 a[56:59], v7 offset:32768
s_waitcnt lgkmcnt(5)
v_mfma_f32_16x16x32_bf16 v[148:151], v[184:187], a[36:39], v[148:151]
ds_read_b128 a[60:63], v7 offset:49152
s_waitcnt lgkmcnt(5)
v_mfma_f32_16x16x32_bf16 v[152:155], v[184:187], a[40:43], v[152:155]
buffer_load_dwordx4 v10, s[8:11], s98 offen offset:2048 lds
ds_read_b128 a[64:67], v4 offset:256
s_waitcnt lgkmcnt(5)
v_mfma_f32_16x16x32_bf16 v[156:159], v[184:187], a[44:47], v[156:159]
ds_read_b128 a[68:71], v4 offset:16640
v_accvgpr_read_b32 v96, a241
v_accvgpr_read_b32 v97, a242
v_accvgpr_read_b32 v98, a243
v_accvgpr_read_b32 v99, a244
buffer_load_dwordx4 v11, s[8:11], s98 offen offset:3072 lds
v_accvgpr_read_b32 v100, a245
v_accvgpr_read_b32 v101, a246
v_accvgpr_read_b32 v102, a247
v_accvgpr_read_b32 v103, a248
s_waitcnt vmcnt(10)
ds_read_b64_tr_b16 v[80:81], v96
ds_read_b64_tr_b16 v[82:83], v100
s_add_u32 m0, s80, 122880
s_add_u32 s98, s53, 2048
buffer_load_dwordx4 v8, s[8:11], s98 offen offset:0 lds
ds_read_b64_tr_b16 v[84:85], v97
ds_read_b64_tr_b16 v[86:87], v101
ds_read_b64_tr_b16 v[88:89], v98
ds_read_b64_tr_b16 v[90:91], v102
buffer_load_dwordx4 v9, s[8:11], s98 offen offset:1024 lds
ds_read_b64_tr_b16 v[92:93], v99
ds_read_b64_tr_b16 v[94:95], v103
s_waitcnt lgkmcnt(13)
v_mfma_f32_16x16x32_bf16 v[144:147], v[188:191], a[48:51], v[144:147]
ds_read_b128 a[72:75], v4 offset:33024
s_waitcnt lgkmcnt(13)
v_mfma_f32_16x16x32_bf16 v[148:151], v[188:191], a[52:55], v[148:151]
ds_read_b128 a[76:79], v4 offset:49408
s_waitcnt lgkmcnt(13)
v_mfma_f32_16x16x32_bf16 v[152:155], v[188:191], a[56:59], v[152:155]
buffer_load_dwordx4 v10, s[8:11], s98 offen offset:2048 lds
ds_read_b128 a[80:83], v5 offset:256
s_waitcnt lgkmcnt(13)
v_mfma_f32_16x16x32_bf16 v[156:159], v[188:191], a[60:63], v[156:159]
ds_read_b128 a[84:87], v5 offset:16640
s_waitcnt lgkmcnt(13)
v_mfma_f32_16x16x32_bf16 v[144:147], v[192:195], a[64:67], v[144:147]
ds_read_b128 a[88:91], v5 offset:33024
s_waitcnt lgkmcnt(13)
v_mfma_f32_16x16x32_bf16 v[148:151], v[192:195], a[68:71], v[148:151]
ds_read_b128 a[92:95], v5 offset:49408
s_waitcnt lgkmcnt(5)
v_mfma_f32_16x16x32_bf16 v[152:155], v[192:195], a[72:75], v[152:155]
ds_read_b128 a[96:99], v6 offset:256
buffer_load_dwordx4 v11, s[8:11], s98 offen offset:3072 lds
s_waitcnt lgkmcnt(5)
v_mfma_f32_16x16x32_bf16 v[156:159], v[192:195], a[76:79], v[156:159]
ds_read_b128 a[100:103], v6 offset:16640
s_waitcnt lgkmcnt(5)
v_mfma_f32_16x16x32_bf16 v[144:147], v[196:199], a[80:83], v[144:147]
ds_read_b128 a[104:107], v6 offset:33024
s_waitcnt lgkmcnt(5)
v_mfma_f32_16x16x32_bf16 v[148:151], v[196:199], a[84:87], v[148:151]
ds_read_b128 a[108:111], v6 offset:49408
s_waitcnt lgkmcnt(5)
v_mfma_f32_16x16x32_bf16 v[152:155], v[196:199], a[88:91], v[152:155]
ds_read_b128 a[112:115], v7 offset:256
s_waitcnt lgkmcnt(5)
v_mfma_f32_16x16x32_bf16 v[156:159], v[196:199], a[92:95], v[156:159]
ds_read_b128 a[116:119], v7 offset:16640
buffer_store_dwordx4 v[164:167], v161, s[24:27], s71 offen sc1
s_waitcnt lgkmcnt(5)
v_mfma_f32_16x16x32_bf16 v[144:147], v[200:203], a[96:99], v[144:147]
ds_read_b128 a[120:123], v7 offset:33024
s_waitcnt lgkmcnt(5)
v_mfma_f32_16x16x32_bf16 v[148:151], v[200:203], a[100:103], v[148:151]
ds_read_b128 a[124:127], v7 offset:49408
s_waitcnt lgkmcnt(5)
v_mfma_f32_16x16x32_bf16 v[152:155], v[200:203], a[104:107], v[152:155]
ds_read_b128 a[128:131], v4 offset:512
s_waitcnt lgkmcnt(5)
v_mfma_f32_16x16x32_bf16 v[156:159], v[200:203], a[108:111], v[156:159]
ds_read_b128 a[132:135], v4 offset:16896
s_waitcnt lgkmcnt(5)
v_mfma_f32_16x16x32_bf16 v[144:147], v[204:207], a[112:115], v[144:147]
ds_read_b128 a[136:139], v4 offset:33280
buffer_store_dwordx2 v[172:173], v14, s[24:27], s70 offen sc1
s_waitcnt lgkmcnt(5)
v_mfma_f32_16x16x32_bf16 v[148:151], v[204:207], a[116:119], v[148:151]
ds_read_b128 a[140:143], v4 offset:49664
s_waitcnt lgkmcnt(5)
v_mfma_f32_16x16x32_bf16 v[152:155], v[204:207], a[120:123], v[152:155]
ds_read_b128 a[144:147], v5 offset:512
s_waitcnt lgkmcnt(5)
v_mfma_f32_16x16x32_bf16 v[156:159], v[204:207], a[124:127], v[156:159]
ds_read_b128 a[148:151], v5 offset:16896
s_waitcnt lgkmcnt(5)
v_mfma_f32_16x16x32_bf16 v[144:147], v[208:211], a[128:131], v[144:147]
ds_read_b128 a[152:155], v5 offset:33280
s_waitcnt lgkmcnt(5)
v_mfma_f32_16x16x32_bf16 v[148:151], v[208:211], a[132:135], v[148:151]
buffer_store_dwordx4 v[80:83], v2, s[24:27], s60 offen sc1
ds_read_b128 a[156:159], v5 offset:49664
s_waitcnt lgkmcnt(5)
v_mfma_f32_16x16x32_bf16 v[152:155], v[208:211], a[136:139], v[152:155]
ds_read_b128 a[160:163], v6 offset:512
s_waitcnt lgkmcnt(5)
v_mfma_f32_16x16x32_bf16 v[156:159], v[208:211], a[140:143], v[156:159]
ds_read_b128 a[164:167], v6 offset:16896
s_waitcnt lgkmcnt(5)
v_mfma_f32_16x16x32_bf16 v[144:147], v[212:215], a[144:147], v[144:147]
ds_read_b128 a[168:171], v6 offset:33280
s_waitcnt lgkmcnt(5)
v_mfma_f32_16x16x32_bf16 v[148:151], v[212:215], a[148:151], v[148:151]
ds_read_b128 a[172:175], v6 offset:49664
s_waitcnt lgkmcnt(5)
v_mfma_f32_16x16x32_bf16 v[152:155], v[212:215], a[152:155], v[152:155]
buffer_store_dwordx4 v[84:87], v2, s[24:27], s61 offen sc1
ds_read_b128 a[176:179], v7 offset:512
s_waitcnt lgkmcnt(5)
v_mfma_f32_16x16x32_bf16 v[156:159], v[212:215], a[156:159], v[156:159]
ds_read_b128 a[180:183], v7 offset:16896
s_waitcnt lgkmcnt(5)
v_mfma_f32_16x16x32_bf16 v[144:147], v[216:219], a[160:163], v[144:147]
ds_read_b128 a[184:187], v7 offset:33280
s_waitcnt lgkmcnt(5)
v_mfma_f32_16x16x32_bf16 v[148:151], v[216:219], a[164:167], v[148:151]
ds_read_b128 a[188:191], v7 offset:49664
s_waitcnt lgkmcnt(5)
v_mfma_f32_16x16x32_bf16 v[152:155], v[216:219], a[168:171], v[152:155]
ds_read_b128 a[192:195], v4 offset:768
s_waitcnt lgkmcnt(5)
v_mfma_f32_16x16x32_bf16 v[156:159], v[216:219], a[172:175], v[156:159]
buffer_store_dwordx4 v[88:91], v2, s[24:27], s62 offen sc1
ds_read_b128 a[196:199], v4 offset:17152
s_waitcnt lgkmcnt(5)
v_mfma_f32_16x16x32_bf16 v[144:147], v[220:223], a[176:179], v[144:147]
ds_read_b128 a[200:203], v4 offset:33536
s_waitcnt lgkmcnt(5)
v_mfma_f32_16x16x32_bf16 v[148:151], v[220:223], a[180:183], v[148:151]
ds_read_b128 a[204:207], v4 offset:49920
s_waitcnt lgkmcnt(5)
v_mfma_f32_16x16x32_bf16 v[152:155], v[220:223], a[184:187], v[152:155]
ds_read_b128 a[208:211], v5 offset:768
s_waitcnt lgkmcnt(5)
v_mfma_f32_16x16x32_bf16 v[156:159], v[220:223], a[188:191], v[156:159]
ds_read_b128 a[212:215], v5 offset:17152
buffer_store_dwordx4 v[92:95], v2, s[24:27], s63 offen sc1
s_waitcnt lgkmcnt(5)
v_mfma_f32_16x16x32_bf16 v[144:147], v[224:227], a[192:195], v[144:147]
ds_read_b128 a[216:219], v5 offset:33536
s_waitcnt lgkmcnt(5)
v_mfma_f32_16x16x32_bf16 v[148:151], v[224:227], a[196:199], v[148:151]
ds_read_b128 a[220:223], v5 offset:49920
s_waitcnt lgkmcnt(5)
v_mfma_f32_16x16x32_bf16 v[152:155], v[224:227], a[200:203], v[152:155]
ds_read_b128 a[224:227], v6 offset:768
s_waitcnt lgkmcnt(5)
v_mfma_f32_16x16x32_bf16 v[156:159], v[224:227], a[204:207], v[156:159]
ds_read_b128 a[228:231], v6 offset:17152
s_waitcnt lgkmcnt(5)
v_mfma_f32_16x16x32_bf16 v[144:147], v[228:231], a[208:211], v[144:147]
ds_read_b128 a[232:235], v6 offset:33536
s_add_u32 m0, s80, 139264
s_add_u32 s98, s53, 0
buffer_load_dwordx4 v8, s[8:11], s98 offen offset:0 lds
s_waitcnt lgkmcnt(5)
v_mfma_f32_16x16x32_bf16 v[148:151], v[228:231], a[212:215], v[148:151]
ds_read_b128 a[236:239], v6 offset:49920
s_waitcnt lgkmcnt(5)
v_mfma_f32_16x16x32_bf16 v[152:155], v[228:231], a[216:219], v[152:155]
ds_read_b128 a[240:243], v7 offset:768
s_waitcnt lgkmcnt(5)
v_mfma_f32_16x16x32_bf16 v[156:159], v[228:231], a[220:223], v[156:159]
ds_read_b128 a[244:247], v7 offset:17152
s_waitcnt lgkmcnt(5)
v_mfma_f32_16x16x32_bf16 v[144:147], v[232:235], a[224:227], v[144:147]
ds_read_b128 a[248:251], v7 offset:33536
s_waitcnt lgkmcnt(5)
v_mfma_f32_16x16x32_bf16 v[148:151], v[232:235], a[228:231], v[148:151]
buffer_load_dwordx4 v9, s[8:11], s98 offen offset:1024 lds
s_waitcnt vmcnt(20)
ds_read_b128 a[252:255], v7 offset:49920
s_waitcnt lgkmcnt(5)
v_mfma_f32_16x16x32_bf16 v[152:155], v[232:235], a[232:235], v[152:155]
s_waitcnt lgkmcnt(4)
v_mfma_f32_16x16x32_bf16 v[156:159], v[232:235], a[236:239], v[156:159]
s_waitcnt lgkmcnt(3)
v_mfma_f32_16x16x32_bf16 v[144:147], v[236:239], a[240:243], v[144:147]
s_waitcnt lgkmcnt(2)
v_mfma_f32_16x16x32_bf16 v[148:151], v[236:239], a[244:247], v[148:151]
s_waitcnt lgkmcnt(1)
v_mfma_f32_16x16x32_bf16 v[152:155], v[236:239], a[248:251], v[152:155]
buffer_load_dwordx4 v10, s[8:11], s98 offen offset:2048 lds
s_waitcnt lgkmcnt(0)
v_mfma_f32_16x16x32_bf16 v[156:159], v[236:239], a[252:255], v[156:159]
s_lshl_b32 s78, s74, 5
s_add_u32 s78, s78, s75
s_lshl_b32 s78, s78, 2
s_add_u32 s78, s78, s73
s_lshl_b32 s78, s78, 2
s_add_u32 s67, s78, 24576
buffer_load_dwordx4 v11, s[8:11], s98 offen offset:3072 lds
s_waitcnt vmcnt(10)
s_barrier
ds_read_b64_tr_b16 v[16:17], v13 offset:0
ds_read_b64_tr_b16 v[18:19], v13 offset:512
ds_read_b64_tr_b16 v[20:21], v13 offset:4096
ds_read_b64_tr_b16 v[22:23], v13 offset:4608
ds_read_b64_tr_b16 v[24:25], v13 offset:8192
ds_read_b64_tr_b16 v[26:27], v13 offset:8704
s_waitcnt lgkmcnt(4)
v_mfma_f32_16x16x32_bf16 v[240:243], a[0:3], v[16:19], 0
ds_read_b64_tr_b16 v[28:29], v13 offset:12288
v_mfma_f32_16x16x32_bf16 v[244:247], a[4:7], v[16:19], 0
v_mfma_f32_16x16x32_bf16 v[248:251], a[8:11], v[16:19], 0
ds_read_b64_tr_b16 v[30:31], v13 offset:12800
v_cvt_pk_bf16_f32 v176, v144, v145
v_cvt_pk_bf16_f32 v177, v146, v147
v_mfma_f32_16x16x32_bf16 v[252:255], a[12:15], v[16:19], 0
v_cvt_pk_bf16_f32 v178, v148, v149
v_cvt_pk_bf16_f32 v179, v150, v151
s_waitcnt lgkmcnt(4)
v_mfma_f32_16x16x32_bf16 v[240:243], a[16:19], v[20:23], v[240:243]
ds_read_b64_tr_b16 v[32:33], v13 offset:16384
v_cvt_pk_bf16_f32 v180, v152, v153
v_cvt_pk_bf16_f32 v181, v154, v155
v_mfma_f32_16x16x32_bf16 v[244:247], a[20:23], v[20:23], v[244:247]
v_cvt_pk_bf16_f32 v182, v156, v157
v_cvt_pk_bf16_f32 v183, v158, v159
v_mfma_f32_16x16x32_bf16 v[248:251], a[24:27], v[20:23], v[248:251]
ds_read_b64_tr_b16 v[34:35], v13 offset:16896
s_lshl_b32 s78, s75, 5
s_add_u32 s83, s78, s76
v_mfma_f32_16x16x32_bf16 v[252:255], a[28:31], v[20:23], v[252:255]
s_lshl_b32 s82, s83, 11
s_add_u32 s78, s82, 1048576
s_waitcnt lgkmcnt(4)
v_mfma_f32_16x16x32_bf16 v[240:243], a[32:35], v[24:27], v[240:243]
ds_read_b64_tr_b16 v[36:37], v13 offset:20480
v_permlane16_swap_b32 v176, v178
v_permlane16_swap_b32 v177, v179
v_mfma_f32_16x16x32_bf16 v[244:247], a[36:39], v[24:27], v[244:247]
v_permlane16_swap_b32 v180, v182
v_permlane16_swap_b32 v181, v183
v_mfma_f32_16x16x32_bf16 v[248:251], a[40:43], v[24:27], v[248:251]
ds_read_b64_tr_b16 v[38:39], v13 offset:20992
buffer_store_dwordx4 v[176:179], v2, s[24:27], s78 offen offset:0 sc1
buffer_store_dwordx4 v[180:183], v2, s[24:27], s78 offen offset:1024 sc1
v_mfma_f32_16x16x32_bf16 v[252:255], a[44:47], v[24:27], v[252:255]
s_lshl_b32 s83, s83, 7
s_add_u32 s83, s83, 393216
v_and_b32 v1, 15, v0
s_waitcnt lgkmcnt(4)
v_mfma_f32_16x16x32_bf16 v[240:243], a[48:51], v[28:31], v[240:243]
ds_read_b64_tr_b16 v[40:41], v13 offset:24576
v_lshrrev_b32 v3, 5, v0
v_mfma_f32_16x16x32_bf16 v[244:247], a[52:55], v[28:31], v[244:247]
v_lshl_add_u32 v1, v3, 4, v1
v_lshlrev_b32 v1, 4, v1
v_and_b32 v3, 16, v0
v_mfma_f32_16x16x32_bf16 v[248:251], a[56:59], v[28:31], v[248:251]
ds_read_b64_tr_b16 v[42:43], v13 offset:25088
v_cmp_eq_u32 vcc, 0, v3
v_mfma_f32_16x16x32_bf16 v[252:255], a[60:63], v[28:31], v[252:255]
v_mov_b32 v3, 0x1000000
v_cndmask_b32 v1, v3, v1, vcc
v_cmp_lt_u32 vcc, 16, v0
s_waitcnt lgkmcnt(4)
v_mfma_f32_16x16x32_bf16 v[240:243], a[64:67], v[32:35], v[240:243]
ds_read_b64_tr_b16 v[44:45], v13 offset:28672
v_mfma_f32_16x16x32_bf16 v[244:247], a[68:71], v[32:35], v[244:247]
v_and_b32 v4, 16, v0
v_cndmask_b32 v4, 0, v4, vcc
v_lshl_add_u32 v4, v4, 21, v1
v_mfma_f32_16x16x32_bf16 v[248:251], a[72:75], v[32:35], v[248:251]
ds_read_b64_tr_b16 v[46:47], v13 offset:29184
s_add_u32 s79, s82, 3145728
v_mfma_f32_16x16x32_bf16 v[252:255], a[76:79], v[32:35], v[252:255]
v_mov_b32 v186, 0x3f803f80
v_mov_b32 v187, 0x3f803f80
v_mov_b32 v190, 0x3f803f80
s_waitcnt lgkmcnt(4)
v_mfma_f32_16x16x32_bf16 v[240:243], a[80:83], v[36:39], v[240:243]
ds_read_b64_tr_b16 v[48:49], v13 offset:32768
v_mov_b32 v191, 0x3f803f80
v_mfma_f32_16x16x32_bf16 v[244:247], a[84:87], v[36:39], v[244:247]
v_mov_b32 v194, 0x3f803f80
v_mov_b32 v195, 0x3f803f80
v_mov_b32 v198, 0x3f803f80
v_mfma_f32_16x16x32_bf16 v[248:251], a[88:91], v[36:39], v[248:251]
ds_read_b64_tr_b16 v[50:51], v13 offset:33280
v_mov_b32 v199, 0x3f803f80
v_mfma_f32_16x16x32_bf16 v[252:255], a[92:95], v[36:39], v[252:255]
v_and_b32 v3, 3, v0
v_sub_u32 v3, s75, v3
v_add_u32 v3, -1, v3
s_waitcnt lgkmcnt(4)
v_mfma_f32_16x16x32_bf16 v[240:243], a[96:99], v[40:43], v[240:243]
ds_read_b64_tr_b16 v[52:53], v13 offset:36864
v_cmp_gt_i32 vcc, 0, v3
v_mfma_f32_16x16x32_bf16 v[244:247], a[100:103], v[40:43], v[244:247]
v_mov_b32 v5, s75
v_cndmask_b32 v3, v3, v5, vcc
v_lshlrev_b32 v3, 12, v3
v_mfma_f32_16x16x32_bf16 v[248:251], a[104:107], v[40:43], v[248:251]
ds_read_b64_tr_b16 v[54:55], v13 offset:37376
s_lshl_b32 s99, s76, 7
v_mfma_f32_16x16x32_bf16 v[252:255], a[108:111], v[40:43], v[252:255]
s_add_u32 s66, s99, 393216
s_waitcnt lgkmcnt(4)
v_mfma_f32_16x16x32_bf16 v[240:243], a[112:115], v[44:47], v[240:243]
ds_read_b64_tr_b16 v[56:57], v13 offset:40960
v_mfma_f32_16x16x32_bf16 v[244:247], a[116:119], v[44:47], v[244:247]
v_mfma_f32_16x16x32_bf16 v[248:251], a[120:123], v[44:47], v[248:251]
ds_read_b64_tr_b16 v[58:59], v13 offset:41472
v_mfma_f32_16x16x32_bf16 v[252:255], a[124:127], v[44:47], v[252:255]
s_waitcnt lgkmcnt(4)
v_mfma_f32_16x16x32_bf16 v[240:243], a[128:131], v[48:51], v[240:243]
ds_read_b64_tr_b16 v[60:61], v13 offset:45056
v_mfma_f32_16x16x32_bf16 v[244:247], a[132:135], v[48:51], v[244:247]
v_mfma_f32_16x16x32_bf16 v[248:251], a[136:139], v[48:51], v[248:251]
s_add_u32 m0, s80, 40960
s_add_u32 s98, s52, 0
buffer_load_dwordx4 v8, s[8:11], s98 offen offset:0 lds
ds_read_b64_tr_b16 v[62:63], v13 offset:45568
v_mfma_f32_16x16x32_bf16 v[252:255], a[140:143], v[48:51], v[252:255]
s_waitcnt lgkmcnt(4)
v_mfma_f32_16x16x32_bf16 v[240:243], a[144:147], v[52:55], v[240:243]
ds_read_b64_tr_b16 v[64:65], v13 offset:49152
v_mfma_f32_16x16x32_bf16 v[244:247], a[148:151], v[52:55], v[244:247]
v_mfma_f32_16x16x32_bf16 v[248:251], a[152:155], v[52:55], v[248:251]
buffer_load_dwordx4 v9, s[8:11], s98 offen offset:1024 lds
ds_read_b64_tr_b16 v[66:67], v13 offset:49664
v_mfma_f32_16x16x32_bf16 v[252:255], a[156:159], v[52:55], v[252:255]
s_waitcnt lgkmcnt(4)
v_mfma_f32_16x16x32_bf16 v[240:243], a[160:163], v[56:59], v[240:243]
ds_read_b64_tr_b16 v[68:69], v13 offset:53248
v_mfma_f32_16x16x32_bf16 v[244:247], a[164:167], v[56:59], v[244:247]
v_mfma_f32_16x16x32_bf16 v[248:251], a[168:171], v[56:59], v[248:251]
ds_read_b64_tr_b16 v[70:71], v13 offset:53760
v_mfma_f32_16x16x32_bf16 v[252:255], a[172:175], v[56:59], v[252:255]
s_waitcnt lgkmcnt(4)
v_mfma_f32_16x16x32_bf16 v[240:243], a[176:179], v[60:63], v[240:243]
ds_read_b64_tr_b16 v[72:73], v13 offset:57344
v_mfma_f32_16x16x32_bf16 v[244:247], a[180:183], v[60:63], v[244:247]
v_mfma_f32_16x16x32_bf16 v[248:251], a[184:187], v[60:63], v[248:251]
ds_read_b64_tr_b16 v[74:75], v13 offset:57856
v_mfma_f32_16x16x32_bf16 v[252:255], a[188:191], v[60:63], v[252:255]
s_waitcnt lgkmcnt(4)
v_mfma_f32_16x16x32_bf16 v[240:243], a[192:195], v[64:67], v[240:243]
ds_read_b64_tr_b16 v[76:77], v13 offset:61440
v_mfma_f32_16x16x32_bf16 v[244:247], a[196:199], v[64:67], v[244:247]
s_waitcnt vmcnt(8)
buffer_store_dword v15, v14, s[24:27], s67 offen sc1
v_mfma_f32_16x16x32_bf16 v[248:251], a[200:203], v[64:67], v[248:251]
ds_read_b64_tr_b16 v[78:79], v13 offset:61952
v_mfma_f32_16x16x32_bf16 v[252:255], a[204:207], v[64:67], v[252:255]
s_waitcnt lgkmcnt(4)
v_mfma_f32_16x16x32_bf16 v[240:243], a[208:211], v[68:71], v[240:243]
v_mfma_f32_16x16x32_bf16 v[244:247], a[212:215], v[68:71], v[244:247]
v_mfma_f32_16x16x32_bf16 v[248:251], a[216:219], v[68:71], v[248:251]
v_mfma_f32_16x16x32_bf16 v[252:255], a[220:223], v[68:71], v[252:255]
s_waitcnt lgkmcnt(2)
v_mfma_f32_16x16x32_bf16 v[240:243], a[224:227], v[72:75], v[240:243]
v_mfma_f32_16x16x32_bf16 v[244:247], a[228:231], v[72:75], v[244:247]
v_mfma_f32_16x16x32_bf16 v[248:251], a[232:235], v[72:75], v[248:251]
v_mfma_f32_16x16x32_bf16 v[252:255], a[236:239], v[72:75], v[252:255]
s_waitcnt lgkmcnt(0)
v_mfma_f32_16x16x32_bf16 v[240:243], a[240:243], v[76:79], v[240:243]
v_mfma_f32_16x16x32_bf16 v[244:247], a[244:247], v[76:79], v[244:247]
v_mfma_f32_16x16x32_bf16 v[248:251], a[248:251], v[76:79], v[248:251]
v_mfma_f32_16x16x32_bf16 v[252:255], a[252:255], v[76:79], v[252:255]
s_nop 4
v_cvt_pk_bf16_f32 v184, v240, v241
v_cvt_pk_bf16_f32 v185, v242, v243
v_cvt_pk_bf16_f32 v188, v244, v245
v_cvt_pk_bf16_f32 v189, v246, v247
v_cvt_pk_bf16_f32 v192, v248, v249
v_cvt_pk_bf16_f32 v193, v250, v251
v_cvt_pk_bf16_f32 v196, v252, v253
v_cvt_pk_bf16_f32 v197, v254, v255
v_permlane16_swap_b32 v184, v186
v_permlane16_swap_b32 v185, v187
v_permlane16_swap_b32 v188, v190
v_permlane16_swap_b32 v189, v191
v_permlane16_swap_b32 v192, v194
v_permlane16_swap_b32 v193, v195
v_permlane16_swap_b32 v196, v198
v_permlane16_swap_b32 v197, v199
v_permlane32_swap_b32 v184, v186
v_permlane32_swap_b32 v185, v187
v_permlane32_swap_b32 v188, v190
v_permlane32_swap_b32 v189, v191
v_permlane32_swap_b32 v192, v194
v_permlane32_swap_b32 v193, v195
v_permlane32_swap_b32 v196, v198
v_permlane32_swap_b32 v197, v199
buffer_store_dwordx4 v[184:187], v4, s[24:27], s79 offen offset:0 sc1
buffer_store_dwordx4 v[188:191], v4, s[24:27], s79 offen offset:512 sc1
buffer_store_dwordx4 v[192:195], v4, s[24:27], s79 offen offset:1024 sc1
buffer_store_dwordx4 v[196:199], v4, s[24:27], s79 offen offset:1536 sc1
s_waitcnt vmcnt(9)
s_barrier
v_add_u32 v5, 131072, v12
ds_read_b64_tr_b16 v[140:141], v5 offset:12288
ds_read_b64_tr_b16 v[142:143], v5 offset:12800
ds_read_b64_tr_b16 v[136:137], v5 offset:8192
ds_read_b64_tr_b16 v[138:139], v5 offset:8704
ds_read_b64_tr_b16 v[132:133], v5 offset:4096
ds_read_b64_tr_b16 v[134:135], v5 offset:4608
s_mul_i32 s78, s74, 5
buffer_load_dwordx4 v10, s[8:11], s98 offen offset:2048 lds
s_min_u32 s79, s74, 3
s_add_u32 s78, s78, s79
s_lshl_b32 s37, s78, 1
s_lshl_b32 s35, s73, 14
s_lshl_b32 s34, s76, 14
s_add_u32 s34, s34, 23068672
s_mul_i32 s32, s76, 49152
s_add_u32 s32, s32, 24117248
s_cmp_ge_u32 s74, 3
s_cselect_b32 s79, s73, 0
s_cmp_eq_u32 s79, 3
s_cselect_b32 s33, 0x2000000, s32
s_mul_i32 s39, s76, 45056
s_add_u32 s39, s39, 26214400
s_lshl_b32 s36, s75, 1
s_lshl_b32 s38, s73, 12
s_cmp_lg_u32 s73, 1
s_cbranch_scc1 L_nos2_6
v_bfe_u32 v48, v0, 2, 3
v_lshlrev_b32 v48, 9, v48
v_and_b32 v44, 3, v0
v_lshl_add_u32 v48, v44, 4, v48
s_lshr_b32 s99, s2, 3
s_lshl_b32 s99, s99, 12
s_and_b32 s78, s2, 7
s_lshl_b32 s78, s78, 6
s_add_u32 s99, s99, s78
s_add_u32 s99, s99, 917504
buffer_load_dwordx4 v[40:43], v48, s[24:27], s99 offen sc1
s_lshr_b32 s78, s2, 6
s_cmp_eq_u32 s78, 2
s_cselect_b32 s78, 1.0, 0
v_cmp_gt_u32 vcc, 4, v0
v_lshlrev_b32 v44, 3, v44
v_mov_b32 v45, 0x2000000
v_cndmask_b32 v44, v45, v44, vcc
s_waitcnt vmcnt(0)
v_cmp_ne_u32 vcc, s72, v41
v_cmp_ne_u32 s[86:87], s72, v43
s_nop 0
s_or_b64 vcc, vcc, s[86:87]
s_cbranch_vccnz L_poll_7
L_ret_8:
v_add_f32_dpp v40, v40, v40 row_ror:4 row_mask:0xf bank_mask:0xf
v_add_f32_dpp v42, v42, v42 row_ror:4 row_mask:0xf bank_mask:0xf
s_nop 0
v_add_f32_dpp v40, v40, v40 row_ror:8 row_mask:0xf bank_mask:0xf
v_add_f32_dpp v42, v42, v42 row_ror:8 row_mask:0xf bank_mask:0xf
v_mov_b32 v41, v40
v_mov_b32 v43, v42
s_nop 0
v_permlane16_swap_b32 v40, v41
v_permlane16_swap_b32 v42, v43
v_add_f32 v40, v40, v41
v_add_f32 v42, v42, v43
v_cvt_pk_bf16_f32 v40, v40, v42
v_lshlrev_b32 v42, 16, v40
v_and_b32 v43, s85, v40
v_add_f32 v42, s78, v42
v_add_f32 v43, s78, v43
v_cvt_pk_bf16_f32 v40, v42, v43
v_mov_b32 v41, v15
s_lshl_b32 s99, s2, 5
s_add_u32 s99, s99, 12288
buffer_store_dwordx2 v[40:41], v44, s[24:27], s99 offen sc1
L_nos2_6:
s_waitcnt lgkmcnt(4)
v_mfma_f32_16x16x32_bf16 v[144:147], v[140:143], a[240:243], 0
ds_read_b64_tr_b16 v[128:129], v5 offset:0
v_mfma_f32_16x16x32_bf16 v[148:151], v[140:143], a[244:247], 0
ds_read_b64_tr_b16 v[130:131], v5 offset:512
v_mfma_f32_16x16x32_bf16 v[152:155], v[140:143], a[248:251], 0
v_mfma_f32_16x16x32_bf16 v[156:159], v[140:143], a[252:255], 0
buffer_load_dwordx4 v11, s[8:11], s98 offen offset:3072 lds
s_add_u32 m0, s80, 24576
s_add_u32 s98, s51, 0
buffer_load_dwordx4 v8, s[8:11], s98 offen offset:0 lds
buffer_load_dwordx4 v9, s[8:11], s98 offen offset:1024 lds
buffer_load_dwordx4 v10, s[8:11], s98 offen offset:2048 lds
buffer_load_dwordx4 v11, s[8:11], s98 offen offset:3072 lds
s_add_u32 m0, s80, 8192
s_add_u32 s98, s50, 0
buffer_load_dwordx4 v8, s[8:11], s98 offen offset:0 lds
buffer_load_dwordx4 v9, s[8:11], s98 offen offset:1024 lds
buffer_load_dwordx4 v10, s[8:11], s98 offen offset:2048 lds
buffer_load_dwordx4 v11, s[8:11], s98 offen offset:3072 lds
s_waitcnt vmcnt(10)
buffer_store_dword v15, v14, s[24:27], s83 offen sc1
s_waitcnt vmcnt(1)
s_barrier
s_mov_b32 s81, s66
v_and_b32 v33, 7, v0
v_lshlrev_b32 v13, 2, v33
v_lshlrev_b32 v33, 6, v33
s_andn2_b32 s80, s2, 0x38
s_lshl_b32 s80, s80, 3
s_add_u32 s80, s80, 4096
buffer_load_dwordx2 v[34:35], v33, s[24:27], s80 offen sc1
v_lshlrev_b32 v4, 3, v0
s_lshl_b32 s78, s74, 9
s_add_u32 s78, s78, 24576
buffer_load_dwordx2 v[6:7], v4, s[24:27], s78 offen sc1
s_waitcnt lgkmcnt(4)
v_mfma_f32_16x16x32_bf16 v[144:147], v[136:139], a[224:227], v[144:147]
ds_read_b64_tr_b16 v[140:141], v12 offset:45056
s_lshl_b32 s99, s75, 16
v_mfma_f32_16x16x32_bf16 v[148:151], v[136:139], a[228:231], v[148:151]
ds_read_b64_tr_b16 v[142:143], v12 offset:45568
s_lshl_b32 s79, s76, 10
v_mfma_f32_16x16x32_bf16 v[152:155], v[136:139], a[232:235], v[152:155]
buffer_load_dword v32, v3, s[24:27], s66 offen sc1
v_mfma_f32_16x16x32_bf16 v[156:159], v[136:139], a[236:239], v[156:159]
s_add_u32 s8, s99, s79
s_add_u32 s8, s8, 5242880
s_lshl_b32 s79, s73, 13
s_waitcnt lgkmcnt(4)
v_mfma_f32_16x16x32_bf16 v[144:147], v[132:135], a[208:211], v[144:147]
ds_read_b64_tr_b16 v[136:137], v12 offset:40960
s_add_u32 s9, s99, s79
v_mfma_f32_16x16x32_bf16 v[148:151], v[132:135], a[212:215], v[148:151]
ds_read_b64_tr_b16 v[138:139], v12 offset:41472
s_add_u32 s9, s9, 5242880
v_mfma_f32_16x16x32_bf16 v[152:155], v[132:135], a[216:219], v[152:155]
s_lshl_b32 s79, s76, 9
s_add_u32 s10, s99, s79
s_add_u32 s10, s10, 7340032
v_mfma_f32_16x16x32_bf16 v[156:159], v[132:135], a[220:223], v[156:159]
s_add_u32 s11, s99, s38
s_add_u32 s11, s11, 7340032
s_mul_i32 s99, s75, 180224
s_waitcnt lgkmcnt(4)
v_mfma_f32_16x16x32_bf16 v[144:147], v[128:131], a[192:195], v[144:147]
ds_read_b64_tr_b16 v[132:133], v12 offset:36864
s_add_u32 s99, s99, 9437184
v_mfma_f32_16x16x32_bf16 v[148:151], v[128:131], a[196:199], v[148:151]
ds_read_b64_tr_b16 v[134:135], v12 offset:37376
s_mul_i32 s79, s73, 3
v_mfma_f32_16x16x32_bf16 v[152:155], v[128:131], a[200:203], v[152:155]
s_add_u32 s79, s79, s37
s_lshl_b32 s79, s79, 10
s_add_u32 s16, s99, s79
v_mfma_f32_16x16x32_bf16 v[156:159], v[128:131], a[204:207], v[156:159]
s_waitcnt lgkmcnt(0)
s_barrier
v_lshrrev_b32 v44, 3, v0
v_lshrrev_b32 v45, 4, v0
v_and_b32 v46, 7, v0
v_xor_b32 v46, v46, v45
v_lshlrev_b32 v46, 4, v46
v_lshl_add_u32 v46, v44, 10, v46
v_xor_b32 v47, 64, v46
v_add_u32 v47, 7168, v47
s_lshl_b32 s98, s73, 11
s_add_u32 m0, s98, 139264
s_lshl_b32 s98, s75, 9
s_add_u32 s98, s98, s74
s_lshl_b32 s98, s98, 7
s_add_u32 s98, s98, s35
buffer_load_dwordx4 v46, s[4:7], s98 offen lds
v_mfma_f32_16x16x32_bf16 v[144:147], v[140:143], a[176:179], v[144:147]
ds_read_b64_tr_b16 v[128:129], v12 offset:32768
v_mfma_f32_16x16x32_bf16 v[148:151], v[140:143], a[180:183], v[148:151]
ds_read_b64_tr_b16 v[130:131], v12 offset:33280
v_mfma_f32_16x16x32_bf16 v[152:155], v[140:143], a[184:187], v[152:155]
buffer_load_dwordx4 v47, s[4:7], s98 offen offset:1024 lds
v_mfma_f32_16x16x32_bf16 v[156:159], v[140:143], a[188:191], v[156:159]
s_cmp_ge_u32 s74, 3
s_cselect_b32 s79, s73, 0
v_mfma_f32_16x16x32_bf16 v[144:147], v[136:139], a[160:163], v[144:147]
ds_read_b64_tr_b16 v[140:141], v12 offset:28672
v_mfma_f32_16x16x32_bf16 v[148:151], v[136:139], a[164:167], v[148:151]
ds_read_b64_tr_b16 v[142:143], v12 offset:29184
v_mfma_f32_16x16x32_bf16 v[152:155], v[136:139], a[168:171], v[152:155]
s_cmp_eq_u32 s79, 3
s_cselect_b32 s17, 0x2000000, s16
s_mul_i32 s79, s73, 22528
v_mfma_f32_16x16x32_bf16 v[156:159], v[136:139], a[172:175], v[156:159]
s_add_u32 s18, s99, s79
s_lshl_b32 s21, s75, 10
s_add_u32 s21, s21, 32768
v_mfma_f32_16x16x32_bf16 v[144:147], v[132:135], a[144:147], v[144:147]
ds_read_b64_tr_b16 v[136:137], v12 offset:24576
s_lshl_b32 s79, s76, 2
v_mfma_f32_16x16x32_bf16 v[148:151], v[132:135], a[148:151], v[148:151]
ds_read_b64_tr_b16 v[138:139], v12 offset:25088
s_add_u32 s19, s21, s79
v_mfma_f32_16x16x32_bf16 v[152:155], v[132:135], a[152:155], v[152:155]
s_lshl_b32 s79, s73, 5
s_add_u32 s20, s21, s79
s_lshl_b32 s23, s75, 13
v_mfma_f32_16x16x32_bf16 v[156:159], v[132:135], a[156:159], v[156:159]
s_add_u32 s23, s23, 65536
s_lshl_b32 s79, s74, 10
s_add_u32 s22, s23, s79
s_waitcnt lgkmcnt(4)
v_mfma_f32_16x16x32_bf16 v[144:147], v[128:131], a[128:131], v[144:147]
ds_read_b64_tr_b16 v[132:133], v12 offset:20480
v_mfma_f32_16x16x32_bf16 v[148:151], v[128:131], a[132:135], v[148:151]
ds_read_b64_tr_b16 v[134:135], v12 offset:20992
v_mfma_f32_16x16x32_bf16 v[152:155], v[128:131], a[136:139], v[152:155]
s_cmp_eq_u32 s73, 0
s_cselect_b32 s22, s22, 0x2000000
v_mfma_f32_16x16x32_bf16 v[156:159], v[128:131], a[140:143], v[156:159]
s_waitcnt lgkmcnt(4)
v_mfma_f32_16x16x32_bf16 v[144:147], v[140:143], a[112:115], v[144:147]
ds_read_b64_tr_b16 v[128:129], v12 offset:16384
v_mfma_f32_16x16x32_bf16 v[148:151], v[140:143], a[116:119], v[148:151]
ds_read_b64_tr_b16 v[130:131], v12 offset:16896
v_mfma_f32_16x16x32_bf16 v[152:155], v[140:143], a[120:123], v[152:155]
v_mfma_f32_16x16x32_bf16 v[156:159], v[140:143], a[124:127], v[156:159]
s_waitcnt lgkmcnt(4)
v_mfma_f32_16x16x32_bf16 v[144:147], v[136:139], a[96:99], v[144:147]
ds_read_b64_tr_b16 v[140:141], v12 offset:12288
v_mfma_f32_16x16x32_bf16 v[148:151], v[136:139], a[100:103], v[148:151]
ds_read_b64_tr_b16 v[142:143], v12 offset:12800
s_waitcnt vmcnt(3)
v_cmp_ne_u32 vcc, s72, v6
v_cmp_ne_u32 s[86:87], s72, v7
s_nop 0
s_or_b64 vcc, vcc, s[86:87]
s_cbranch_vccnz L_poll_9
L_ret_10:
s_add_u32 m0, s35, 73728
s_add_u32 s98, s34, 0
buffer_load_dwordx4 v2, s[24:27], s98 offen offset:0 sc1 lds
v_mfma_f32_16x16x32_bf16 v[152:155], v[136:139], a[104:107], v[152:155]
v_mfma_f32_16x16x32_bf16 v[156:159], v[136:139], a[108:111], v[156:159]
s_waitcnt vmcnt(3)
v_cmp_ne_u32 vcc, s72, v32
s_nop 0
s_cbranch_vccnz L_poll_4
L_ret_5:
s_waitcnt lgkmcnt(4)
v_mfma_f32_16x16x32_bf16 v[144:147], v[132:135], a[80:83], v[144:147]
s_add_u32 s101, s82, 983040
s_cmp_ge_u32 s75, 1
s_cselect_b32 s101, s101, 0x2000000
s_add_u32 s100, s101, 2097152
buffer_load_dwordx4 v[236:239], v2, s[24:27], s101 offen offset:1024 sc1
ds_read_b64_tr_b16 v[136:137], v12 offset:8192
v_mfma_f32_16x16x32_bf16 v[148:151], v[132:135], a[84:87], v[148:151]
ds_read_b64_tr_b16 v[138:139], v12 offset:8704
v_mfma_f32_16x16x32_bf16 v[152:155], v[132:135], a[88:91], v[152:155]
v_mfma_f32_16x16x32_bf16 v[156:159], v[132:135], a[92:95], v[156:159]
buffer_load_dwordx4 a[248:251], v1, s[24:27], s100 offen offset:1024 sc1
s_waitcnt lgkmcnt(4)
v_mfma_f32_16x16x32_bf16 v[144:147], v[128:131], a[64:67], v[144:147]
ds_read_b64_tr_b16 v[132:133], v12 offset:4096
v_mfma_f32_16x16x32_bf16 v[148:151], v[128:131], a[68:71], v[148:151]
ds_read_b64_tr_b16 v[134:135], v12 offset:4608
v_mfma_f32_16x16x32_bf16 v[152:155], v[128:131], a[72:75], v[152:155]
v_mfma_f32_16x16x32_bf16 v[156:159], v[128:131], a[76:79], v[156:159]
buffer_load_dwordx4 a[252:255], v1, s[24:27], s100 offen offset:1536 sc1
s_waitcnt lgkmcnt(4)
v_mfma_f32_16x16x32_bf16 v[144:147], v[140:143], a[48:51], v[144:147]
ds_read_b64_tr_b16 v[128:129], v12 offset:0
v_mfma_f32_16x16x32_bf16 v[148:151], v[140:143], a[52:55], v[148:151]
ds_read_b64_tr_b16 v[130:131], v12 offset:512
v_mfma_f32_16x16x32_bf16 v[152:155], v[140:143], a[56:59], v[152:155]
v_mfma_f32_16x16x32_bf16 v[156:159], v[140:143], a[60:63], v[156:159]
buffer_load_dwordx4 v[232:235], v2, s[24:27], s101 offen offset:0 sc1
s_waitcnt lgkmcnt(4)
v_mfma_f32_16x16x32_bf16 v[144:147], v[136:139], a[32:35], v[144:147]
v_mfma_f32_16x16x32_bf16 v[148:151], v[136:139], a[36:39], v[148:151]
v_mfma_f32_16x16x32_bf16 v[152:155], v[136:139], a[40:43], v[152:155]
v_mfma_f32_16x16x32_bf16 v[156:159], v[136:139], a[44:47], v[156:159]
buffer_load_dwordx4 a[240:243], v1, s[24:27], s100 offen offset:0 sc1
s_waitcnt lgkmcnt(2)
v_mfma_f32_16x16x32_bf16 v[144:147], v[132:135], a[16:19], v[144:147]
v_mfma_f32_16x16x32_bf16 v[148:151], v[132:135], a[20:23], v[148:151]
v_mfma_f32_16x16x32_bf16 v[152:155], v[132:135], a[24:27], v[152:155]
v_mfma_f32_16x16x32_bf16 v[156:159], v[132:135], a[28:31], v[156:159]
buffer_load_dwordx4 a[244:247], v1, s[24:27], s100 offen offset:512 sc1
s_waitcnt lgkmcnt(0)
v_mfma_f32_16x16x32_bf16 v[144:147], v[128:131], a[0:3], v[144:147]
v_mfma_f32_16x16x32_bf16 v[148:151], v[128:131], a[4:7], v[148:151]
v_mfma_f32_16x16x32_bf16 v[152:155], v[128:131], a[8:11], v[152:155]
v_mfma_f32_16x16x32_bf16 v[156:159], v[128:131], a[12:15], v[156:159]
s_add_u32 s101, s82, 917504
s_cmp_ge_u32 s75, 2
s_cselect_b32 s101, s101, 0x2000000
s_add_u32 s100, s101, 2097152
buffer_load_dwordx4 v[228:231], v2, s[24:27], s101 offen offset:1024 sc1
s_mov_b32 s78, 0x3eb8aa3b
s_mov_b32 s79, s78
v_pk_mul_f32 v[144:145], v[144:145], s[78:79]
v_pk_mul_f32 v[146:147], v[146:147], s[78:79]
v_pk_mul_f32 v[148:149], v[148:149], s[78:79]
v_pk_mul_f32 v[150:151], v[150:151], s[78:79]
v_pk_mul_f32 v[152:153], v[152:153], s[78:79]
v_pk_mul_f32 v[154:155], v[154:155], s[78:79]
v_pk_mul_f32 v[156:157], v[156:157], s[78:79]
v_pk_mul_f32 v[158:159], v[158:159], s[78:79]
buffer_load_dwordx4 a[232:235], v1, s[24:27], s100 offen offset:1024 sc1
v_cvt_pk_bf16_f32 v200, v144, v145
v_cvt_pk_bf16_f32 v201, v146, v147
v_cvt_pk_bf16_f32 v202, v148, v149
v_cvt_pk_bf16_f32 v203, v150, v151
v_cvt_pk_bf16_f32 v204, v152, v153
v_cvt_pk_bf16_f32 v205, v154, v155
v_cvt_pk_bf16_f32 v206, v156, v157
v_cvt_pk_bf16_f32 v207, v158, v159
v_permlane16_swap_b32 v200, v202
v_permlane16_swap_b32 v201, v203
buffer_load_dwordx4 a[236:239], v1, s[24:27], s100 offen offset:1536 sc1
v_permlane16_swap_b32 v204, v206
v_permlane16_swap_b32 v205, v207
s_waitcnt vmcnt(10)
s_barrier
v_and_b32 v136, 31, v0
v_bfe_u32 v137, v0, 1, 3
s_lshl_b32 s99, s73, 1
v_xor_b32 v137, s99, v137
v_lshlrev_b32 v136, 7, v136
v_lshl_add_u32 v136, v137, 4, v136
v_lshrrev_b32 v137, 5, v0
v_lshl_add_u32 v136, v137, 3, v136
v_add_u32 v136, 139264, v136
v_xor_b32 v137, 16, v136
ds_read_b64 v[20:21], v136 offset:0
ds_read_b64 v[22:23], v137 offset:0
ds_read_b64 v[28:29], v136 offset:4096
ds_read_b64 v[30:31], v137 offset:4096
v_and_b32 v36, 31, v0
v_lshrrev_b32 v37, 5, v0
v_lshlrev_b32 v37, 2, v37
v_sub_u32 v36, v36, v37
v_cmp_le_i32 s[40:41], 0, v36
v_cmp_le_i32 s[42:43], 1, v36
v_cmp_le_i32 s[44:45], 2, v36
v_cmp_le_i32 s[46:47], 3, v36
v_cmp_le_i32 s[48:49], 8, v36
buffer_load_dwordx4 v[224:227], v2, s[24:27], s101 offen offset:0 sc1
v_cmp_le_i32 s[50:51], 9, v36
v_cmp_le_i32 s[52:53], 10, v36
v_cmp_le_i32 s[54:55], 11, v36
v_cmp_le_i32 s[56:57], 16, v36
v_cmp_le_i32 s[58:59], 17, v36
v_cmp_le_i32 s[60:61], 18, v36
v_cmp_le_i32 s[62:63], 19, v36
v_cmp_le_i32 s[64:65], 24, v36
v_cmp_le_i32 s[66:67], 25, v36
v_cmp_le_i32 s[68:69], 26, v36
v_cmp_le_i32 s[70:71], 27, v36
v_mov_b32 v37, 0xffff
v_mov_b32 v38, s85
v_cndmask_b32 v248, 0, v37, s[40:41]
v_cndmask_b32 v40, 0, v38, s[42:43]
buffer_load_dwordx4 a[224:227], v1, s[24:27], s100 offen offset:0 sc1
v_cndmask_b32 v249, 0, v37, s[44:45]
v_cndmask_b32 v41, 0, v38, s[46:47]
v_cndmask_b32 v250, 0, v37, s[48:49]
v_cndmask_b32 v42, 0, v38, s[50:51]
v_cndmask_b32 v251, 0, v37, s[52:53]
v_cndmask_b32 v43, 0, v38, s[54:55]
v_cndmask_b32 v252, 0, v37, s[56:57]
v_cndmask_b32 v44, 0, v38, s[58:59]
v_cndmask_b32 v253, 0, v37, s[60:61]
v_cndmask_b32 v45, 0, v38, s[62:63]
v_cndmask_b32 v254, 0, v37, s[64:65]
v_cndmask_b32 v46, 0, v38, s[66:67]
buffer_load_dwordx4 a[228:231], v1, s[24:27], s100 offen offset:512 sc1
v_cndmask_b32 v255, 0, v37, s[68:69]
v_cndmask_b32 v47, 0, v38, s[70:71]
v_or_b32 v248, v248, v40
v_or_b32 v249, v249, v41
v_or_b32 v250, v250, v42
v_or_b32 v251, v251, v43
v_or_b32 v252, v252, v44
v_or_b32 v253, v253, v45
v_or_b32 v254, v254, v46
v_or_b32 v255, v255, v47
v_cmp_ne_u32 vcc, s72, v35
s_nop 0
s_cbranch_vccnz L_poll_11
L_ret_12:
s_add_u32 s101, s82, 851968
s_cmp_ge_u32 s75, 3
s_cselect_b32 s101, s101, 0x2000000
s_add_u32 s100, s101, 2097152
buffer_load_dwordx4 v[220:223], v2, s[24:27], s101 offen offset:1024 sc1
s_getreg_b32 s78, hwreg(HW_REG_XCC_ID, 0, 4)
v_cmp_ne_u32 vcc, s78, v34
s_nop 0
s_cmp_lg_u64 vcc, 0
s_cselect_b32 s3, 1, 0
s_cmp_lg_u32 s3, 0
s_cbranch_scc1 L_slowmode
s_lshl_b32 s79, s2, 2
s_add_u32 s79, s79, s73
s_cmp_lg_u32 s79, 3
s_cbranch_scc1 L_noep_13
s_mov_b32 s83, 4096
buffer_load_dwordx4 v[32:35], v2, s[24:27], s83 offen offset:0 sc1
buffer_load_dwordx4 v[36:39], v2, s[24:27], s83 offen offset:1024 sc1
s_waitcnt vmcnt(1)
v_cmp_ne_u32 vcc, s72, v33
v_cmp_ne_u32 s[86:87], s72, v35
s_nop 0
s_or_b64 vcc, vcc, s[86:87]
s_waitcnt vmcnt(0)
v_cmp_ne_u32 s[86:87], s72, v37
s_nop 0
s_or_b64 vcc, vcc, s[86:87]
v_cmp_ne_u32 s[86:87], s72, v39
s_nop 0
s_or_b64 vcc, vcc, s[86:87]
s_cbranch_vccnz L_poll_14
L_ret_15:
buffer_store_dword v15, v14, s[24:27], 0 offen sc1
L_noep_13:
s_waitcnt vmcnt(12)
v_mfma_f32_32x32x16_bf16 v[32:47], v[236:239], v[200:203], 0
s_waitcnt vmcnt(9)
v_mfma_f32_32x32x16_bf16 v[48:63], v[232:235], v[200:203], 0
buffer_load_dwordx4 a[216:219], v1, s[24:27], s100 offen offset:1024 sc1
s_nop 8
v_exp_f32 v32, v32
v_exp_f32 v33, v33
v_exp_f32 v34, v34
v_exp_f32 v35, v35
v_exp_f32 v36, v36
v_exp_f32 v37, v37
buffer_load_dwordx4 a[220:223], v1, s[24:27], s100 offen offset:1536 sc1
v_exp_f32 v38, v38
v_exp_f32 v39, v39
v_exp_f32 v40, v40
v_cvt_pk_bf16_f32 v112, v32, v33
v_cvt_pk_bf16_f32 v113, v34, v35
v_cvt_pk_bf16_f32 v114, v36, v37
v_cvt_pk_bf16_f32 v115, v38, v39
buffer_load_dwordx4 v[216:219], v2, s[24:27], s101 offen offset:0 sc1
v_exp_f32 v41, v41
v_exp_f32 v42, v42
v_mfma_f32_32x32x16_bf16 v[96:111], a[248:251], v[112:115], 0
v_exp_f32 v43, v43
v_exp_f32 v44, v44
v_exp_f32 v45, v45
v_exp_f32 v46, v46
v_exp_f32 v47, v47
buffer_load_dwordx4 a[208:211], v1, s[24:27], s100 offen offset:0 sc1
v_cvt_pk_bf16_f32 v116, v40, v41
v_cvt_pk_bf16_f32 v117, v42, v43
v_cvt_pk_bf16_f32 v118, v44, v45
v_cvt_pk_bf16_f32 v119, v46, v47
s_waitcnt vmcnt(10)
v_mfma_f32_32x32x16_bf16 v[32:47], v[228:231], v[200:203], 0
v_exp_f32 v48, v48
v_exp_f32 v49, v49
buffer_load_dwordx4 a[212:215], v1, s[24:27], s100 offen offset:512 sc1
v_exp_f32 v50, v50
v_exp_f32 v51, v51
v_mfma_f32_32x32x16_bf16 v[96:111], a[252:255], v[116:119], v[96:111]
v_exp_f32 v52, v52
v_exp_f32 v53, v53
v_exp_f32 v54, v54
s_add_u32 s101, s82, 786432
s_cmp_ge_u32 s75, 4
s_cselect_b32 s101, s101, 0x2000000
s_add_u32 s100, s101, 2097152
buffer_load_dwordx4 v[212:215], v2, s[24:27], s101 offen offset:1024 sc1
v_exp_f32 v55, v55
v_exp_f32 v56, v56
v_cvt_pk_bf16_f32 v120, v48, v49
v_cvt_pk_bf16_f32 v121, v50, v51
v_cvt_pk_bf16_f32 v122, v52, v53
v_cvt_pk_bf16_f32 v123, v54, v55
v_exp_f32 v57, v57
v_exp_f32 v58, v58
v_mfma_f32_32x32x16_bf16 v[96:111], a[240:243], v[120:123], v[96:111]
v_exp_f32 v59, v59
v_exp_f32 v60, v60
v_exp_f32 v61, v61
v_exp_f32 v62, v62
v_exp_f32 v63, v63
v_cvt_pk_bf16_f32 v124, v56, v57
v_cvt_pk_bf16_f32 v125, v58, v59
v_cvt_pk_bf16_f32 v126, v60, v61
v_cvt_pk_bf16_f32 v127, v62, v63
s_waitcnt vmcnt(9)
v_mfma_f32_32x32x16_bf16 v[48:63], v[224:227], v[200:203], 0
buffer_load_dwordx4 a[200:203], v1, s[24:27], s100 offen offset:1024 sc1
v_exp_f32 v32, v32
v_exp_f32 v33, v33
v_exp_f32 v34, v34
v_exp_f32 v35, v35
v_mfma_f32_32x32x16_bf16 v[96:111], a[244:247], v[124:127], v[96:111]
v_exp_f32 v36, v36
v_exp_f32 v37, v37
v_exp_f32 v38, v38
buffer_load_dwordx4 a[204:207], v1, s[24:27], s100 offen offset:1536 sc1
v_exp_f32 v39, v39
v_exp_f32 v40, v40
v_cvt_pk_bf16_f32 v112, v32, v33
v_cvt_pk_bf16_f32 v113, v34, v35
v_cvt_pk_bf16_f32 v114, v36, v37
v_cvt_pk_bf16_f32 v115, v38, v39
v_exp_f32 v41, v41
v_exp_f32 v42, v42
buffer_load_dwordx4 v[208:211], v2, s[24:27], s101 offen offset:0 sc1
v_mfma_f32_32x32x16_bf16 v[96:111], a[232:235], v[112:115], v[96:111]
v_exp_f32 v43, v43
v_exp_f32 v44, v44
v_exp_f32 v45, v45
v_exp_f32 v46, v46
v_exp_f32 v47, v47
v_cvt_pk_bf16_f32 v116, v40, v41
v_cvt_pk_bf16_f32 v117, v42, v43
v_cvt_pk_bf16_f32 v118, v44, v45
buffer_load_dwordx4 a[192:195], v1, s[24:27], s100 offen offset:0 sc1
v_cvt_pk_bf16_f32 v119, v46, v47
s_waitcnt vmcnt(10)
v_mfma_f32_32x32x16_bf16 v[32:47], v[220:223], v[200:203], 0
v_exp_f32 v48, v48
v_exp_f32 v49, v49
v_exp_f32 v50, v50
v_exp_f32 v51, v51
v_mfma_f32_32x32x16_bf16 v[96:111], a[236:239], v[116:119], v[96:111]
v_exp_f32 v52, v52
buffer_load_dwordx4 a[196:199], v1, s[24:27], s100 offen offset:512 sc1
v_exp_f32 v53, v53
v_exp_f32 v54, v54
v_exp_f32 v55, v55
v_exp_f32 v56, v56
v_cvt_pk_bf16_f32 v120, v48, v49
v_cvt_pk_bf16_f32 v121, v50, v51
v_cvt_pk_bf16_f32 v122, v52, v53
buffer_load_dwordx4 v2, s[24:27], s98 offen offset:1024 sc1 lds
v_cvt_pk_bf16_f32 v123, v54, v55
v_exp_f32 v57, v57
v_exp_f32 v58, v58
v_mfma_f32_32x32x16_bf16 v[96:111], a[224:227], v[120:123], v[96:111]
v_exp_f32 v59, v59
v_exp_f32 v60, v60
v_exp_f32 v61, v61
v_exp_f32 v62, v62
buffer_load_dwordx4 v2, s[24:27], s98 offen offset:2048 sc1 lds
v_exp_f32 v63, v63
v_cvt_pk_bf16_f32 v124, v56, v57
v_cvt_pk_bf16_f32 v125, v58, v59
v_cvt_pk_bf16_f32 v126, v60, v61
v_cvt_pk_bf16_f32 v127, v62, v63
s_waitcnt vmcnt(10)
v_mfma_f32_32x32x16_bf16 v[48:63], v[216:219], v[200:203], 0
v_exp_f32 v32, v32
v_exp_f32 v33, v33
buffer_load_dwordx4 v2, s[24:27], s98 offen offset:3072 sc1 lds
v_exp_f32 v34, v34
v_exp_f32 v35, v35
v_mfma_f32_32x32x16_bf16 v[96:111], a[228:231], v[124:127], v[96:111]
v_exp_f32 v36, v36
v_exp_f32 v37, v37
v_exp_f32 v38, v38
s_add_u32 m0, s35, 77824
s_add_u32 s98, s34, 4096
buffer_load_dwordx4 v2, s[24:27], s98 offen offset:0 sc1 lds
v_exp_f32 v39, v39
v_exp_f32 v40, v40
v_cvt_pk_bf16_f32 v112, v32, v33
v_cvt_pk_bf16_f32 v113, v34, v35
v_cvt_pk_bf16_f32 v114, v36, v37
v_cvt_pk_bf16_f32 v115, v38, v39
v_exp_f32 v41, v41
v_exp_f32 v42, v42
buffer_load_dwordx4 v2, s[24:27], s98 offen offset:1024 sc1 lds
v_mfma_f32_32x32x16_bf16 v[96:111], a[216:219], v[112:115], v[96:111]
v_exp_f32 v43, v43
v_exp_f32 v44, v44
v_exp_f32 v45, v45
v_exp_f32 v46, v46
v_exp_f32 v47, v47
v_cvt_pk_bf16_f32 v116, v40, v41
v_cvt_pk_bf16_f32 v117, v42, v43
v_cvt_pk_bf16_f32 v118, v44, v45
v_cvt_pk_bf16_f32 v119, v46, v47
s_waitcnt vmcnt(10)
v_mfma_f32_32x32x16_bf16 v[32:47], v[212:215], v[200:203], 0
v_exp_f32 v48, v48
v_exp_f32 v49, v49
v_exp_f32 v50, v50
v_exp_f32 v51, v51
v_mfma_f32_32x32x16_bf16 v[96:111], a[220:223], v[116:119], v[96:111]
v_exp_f32 v52, v52
v_exp_f32 v53, v53
v_exp_f32 v54, v54
v_exp_f32 v55, v55
buffer_load_dwordx4 v2, s[24:27], s98 offen offset:2048 sc1 lds
v_exp_f32 v56, v56
v_cvt_pk_bf16_f32 v120, v48, v49
v_cvt_pk_bf16_f32 v121, v50, v51
v_cvt_pk_bf16_f32 v122, v52, v53
v_cvt_pk_bf16_f32 v123, v54, v55
v_exp_f32 v57, v57
v_exp_f32 v58, v58
v_mfma_f32_32x32x16_bf16 v[96:111], a[208:211], v[120:123], v[96:111]
v_exp_f32 v59, v59
buffer_load_dwordx4 v2, s[24:27], s98 offen offset:3072 sc1 lds
v_exp_f32 v60, v60
v_exp_f32 v61, v61
v_exp_f32 v62, v62
v_exp_f32 v63, v63
v_cvt_pk_bf16_f32 v124, v56, v57
v_cvt_pk_bf16_f32 v125, v58, v59
v_cvt_pk_bf16_f32 v126, v60, v61
v_cvt_pk_bf16_f32 v127, v62, v63
v_mfma_f32_32x32x16_bf16 v[48:63], v[176:179], v[200:203], 0
v_exp_f32 v32, v32
v_exp_f32 v33, v33
s_add_u32 m0, s35, 81920
s_add_u32 s98, s34, 8192
buffer_load_dwordx4 v2, s[24:27], s98 offen offset:0 sc1 lds
v_exp_f32 v34, v34
v_exp_f32 v35, v35
v_mfma_f32_32x32x16_bf16 v[96:111], a[212:215], v[124:127], v[96:111]
v_exp_f32 v36, v36
v_exp_f32 v37, v37
buffer_load_dwordx4 v2, s[24:27], s98 offen offset:1024 sc1 lds
v_exp_f32 v38, v38
v_exp_f32 v39, v39
v_exp_f32 v40, v40
v_cvt_pk_bf16_f32 v112, v32, v33
v_cvt_pk_bf16_f32 v113, v34, v35
v_cvt_pk_bf16_f32 v114, v36, v37
v_cvt_pk_bf16_f32 v115, v38, v39
v_exp_f32 v41, v41
v_exp_f32 v42, v42
s_waitcnt vmcnt(13)
v_mfma_f32_32x32x16_bf16 v[96:111], a[200:203], v[112:115], v[96:111]
buffer_load_dwordx4 v2, s[24:27], s98 offen offset:2048 sc1 lds
v_exp_f32 v43, v43
v_exp_f32 v44, v44
v_exp_f32 v45, v45
v_exp_f32 v46, v46
v_exp_f32 v47, v47
s_waitcnt vmcnt(12)
v_mfma_f32_32x32x16_bf16 v[64:79], v[208:211], v[200:203], 0
v_cvt_pk_bf16_f32 v116, v40, v41
v_cvt_pk_bf16_f32 v117, v42, v43
v_cvt_pk_bf16_f32 v118, v44, v45
v_cvt_pk_bf16_f32 v119, v46, v47
s_nop 1
v_mfma_f32_32x32x16_bf16 v[96:111], a[204:207], v[116:119], v[96:111]
buffer_load_dwordx4 v2, s[24:27], s98 offen offset:3072 sc1 lds
s_nop 3
v_cndmask_b32 v48, v64, v48, s[40:41]
v_cndmask_b32 v49, v65, v49, s[42:43]
v_cndmask_b32 v50, v66, v50, s[44:45]
v_cndmask_b32 v51, v67, v51, s[46:47]
v_cndmask_b32 v52, v68, v52, s[48:49]
v_cndmask_b32 v53, v69, v53, s[50:51]
v_cndmask_b32 v54, v70, v54, s[52:53]
v_cndmask_b32 v55, v71, v55, s[54:55]
v_cndmask_b32 v56, v72, v56, s[56:57]
v_cndmask_b32 v57, v73, v57, s[58:59]
v_cndmask_b32 v58, v74, v58, s[60:61]
v_cndmask_b32 v59, v75, v59, s[62:63]
v_cndmask_b32 v60, v76, v60, s[64:65]
s_add_u32 m0, s35, 86016
s_add_u32 s98, s34, 12288
buffer_load_dwordx4 v2, s[24:27], s98 offen offset:0 sc1 lds
v_cndmask_b32 v61, v77, v61, s[66:67]
v_cndmask_b32 v62, v78, v62, s[68:69]
v_cndmask_b32 v63, v79, v63, s[70:71]
v_exp_f32 v48, v48
v_exp_f32 v49, v49
v_exp_f32 v50, v50
v_exp_f32 v51, v51
v_exp_f32 v52, v52
buffer_load_dwordx4 v2, s[24:27], s98 offen offset:1024 sc1 lds
v_exp_f32 v53, v53
v_exp_f32 v54, v54
v_exp_f32 v55, v55
v_exp_f32 v56, v56
v_cvt_pk_bf16_f32 v120, v48, v49
v_cvt_pk_bf16_f32 v121, v50, v51
v_cvt_pk_bf16_f32 v122, v52, v53
v_cvt_pk_bf16_f32 v123, v54, v55
v_and_b32 v128, v120, v248
v_and_b32 v129, v121, v249
v_and_b32 v130, v122, v250
buffer_load_dwordx4 v2, s[24:27], s98 offen offset:2048 sc1 lds
v_and_b32 v131, v123, v251
v_xor_b32 v120, v120, v128
v_xor_b32 v121, v121, v129
v_xor_b32 v122, v122, v130
v_xor_b32 v123, v123, v131
v_mfma_f32_32x32x16_bf16 v[96:111], v[184:187], v[128:131], v[96:111]
v_exp_f32 v57, v57
v_exp_f32 v58, v58
v_exp_f32 v59, v59
v_exp_f32 v60, v60
buffer_load_dwordx4 v2, s[24:27], s98 offen offset:3072 sc1 lds
s_waitcnt vmcnt(16)
v_mfma_f32_32x32x16_bf16 v[96:111], a[192:195], v[120:123], v[96:111]
v_exp_f32 v61, v61
v_exp_f32 v62, v62
v_exp_f32 v63, v63
v_cvt_pk_bf16_f32 v124, v56, v57
v_cvt_pk_bf16_f32 v125, v58, v59
v_cvt_pk_bf16_f32 v126, v60, v61
v_cvt_pk_bf16_f32 v127, v62, v63
v_and_b32 v132, v124, v252
v_and_b32 v133, v125, v253
v_and_b32 v134, v126, v254
v_and_b32 v135, v127, v255
v_xor_b32 v124, v124, v132
v_xor_b32 v125, v125, v133
v_xor_b32 v126, v126, v134
v_xor_b32 v127, v127, v135
v_mfma_f32_32x32x16_bf16 v[96:111], v[188:191], v[132:135], v[96:111]
s_add_u32 s98, s32, 0
buffer_load_dwordx4 a[64:67], v2, s[24:27], s98 offen offset:0 sc1
s_waitcnt vmcnt(16)
v_mfma_f32_32x32x16_bf16 v[96:111], a[196:199], v[124:127], v[96:111]
s_nop 11
v_subrev_u32 v80, 0x21800000, v104
v_cmp_lt_u32 vcc, 0x3c000000, v80
s_nop 0
s_cbranch_vccnz L_fb_16
L_fbret_17:
v_rcp_f32 v104, v104
s_nop 0
v_pk_mul_f32 v[96:97], v[96:97], v[104:105] op_sel_hi:[1,0]
v_pk_mul_f32 v[98:99], v[98:99], v[104:105] op_sel_hi:[1,0]
v_pk_mul_f32 v[100:101], v[100:101], v[104:105] op_sel_hi:[1,0]
v_pk_mul_f32 v[102:103], v[102:103], v[104:105] op_sel_hi:[1,0]
v_cvt_pk_bf16_f32 v108, v96, v97
v_cvt_pk_bf16_f32 v109, v98, v99
v_cvt_pk_bf16_f32 v110, v100, v101
buffer_load_dwordx4 a[76:79], v2, s[24:27], s98 offen offset:1024 sc1
v_cvt_pk_bf16_f32 v111, v102, v103
buffer_store_dwordx4 v[108:111], v2, s[24:27], s8 offen sc1
s_add_u32 s8, s8, 32768
v_mfma_f32_32x32x16_bf16 v[32:47], v[176:179], v[204:207], 0
v_mfma_f32_32x32x16_bf16 v[48:63], v[236:239], v[204:207], 0
s_nop 10
v_exp_f32 v32, v32
v_exp_f32 v33, v33
buffer_load_dwordx4 a[88:91], v2, s[24:27], s98 offen offset:2048 sc1
v_exp_f32 v34, v34
v_exp_f32 v35, v35
v_exp_f32 v36, v36
v_exp_f32 v37, v37
v_exp_f32 v38, v38
v_exp_f32 v39, v39
v_exp_f32 v40, v40
v_cvt_pk_bf16_f32 v112, v32, v33
v_cvt_pk_bf16_f32 v113, v34, v35
v_cvt_pk_bf16_f32 v114, v36, v37
buffer_load_dwordx4 a[100:103], v2, s[24:27], s98 offen offset:3072 sc1
v_cvt_pk_bf16_f32 v115, v38, v39
v_exp_f32 v41, v41
v_exp_f32 v42, v42
v_mfma_f32_32x32x16_bf16 v[96:111], v[184:187], v[112:115], 0
v_exp_f32 v43, v43
v_exp_f32 v44, v44
v_exp_f32 v45, v45
v_exp_f32 v46, v46
s_add_u32 s98, s33, 16384
buffer_load_dwordx4 a[68:71], v2, s[24:27], s98 offen offset:0 sc1
v_exp_f32 v47, v47
v_cvt_pk_bf16_f32 v116, v40, v41
v_cvt_pk_bf16_f32 v117, v42, v43
v_cvt_pk_bf16_f32 v118, v44, v45
v_cvt_pk_bf16_f32 v119, v46, v47
v_mfma_f32_32x32x16_bf16 v[32:47], v[232:235], v[204:207], 0
v_exp_f32 v48, v48
v_exp_f32 v49, v49
v_exp_f32 v50, v50
buffer_load_dwordx4 a[80:83], v2, s[24:27], s98 offen offset:1024 sc1
v_exp_f32 v51, v51
v_mfma_f32_32x32x16_bf16 v[96:111], v[188:191], v[116:119], v[96:111]
v_exp_f32 v52, v52
v_exp_f32 v53, v53
v_exp_f32 v54, v54
v_exp_f32 v55, v55
v_exp_f32 v56, v56
v_cvt_pk_bf16_f32 v120, v48, v49
buffer_load_dwordx4 a[92:95], v2, s[24:27], s98 offen offset:2048 sc1
v_cvt_pk_bf16_f32 v121, v50, v51
v_cvt_pk_bf16_f32 v122, v52, v53
v_cvt_pk_bf16_f32 v123, v54, v55
v_exp_f32 v57, v57
v_exp_f32 v58, v58
v_mfma_f32_32x32x16_bf16 v[96:111], a[248:251], v[120:123], v[96:111]
v_exp_f32 v59, v59
v_exp_f32 v60, v60
v_exp_f32 v61, v61
buffer_load_dwordx4 a[104:107], v2, s[24:27], s98 offen offset:3072 sc1
v_exp_f32 v62, v62
v_exp_f32 v63, v63
v_cvt_pk_bf16_f32 v124, v56, v57
v_cvt_pk_bf16_f32 v125, v58, v59
v_cvt_pk_bf16_f32 v126, v60, v61
v_cvt_pk_bf16_f32 v127, v62, v63
v_mfma_f32_32x32x16_bf16 v[48:63], v[228:231], v[204:207], 0
v_exp_f32 v32, v32
v_exp_f32 v33, v33
s_lshl_b32 s81, s73, 11
s_add_u32 s81, s81, 12288
buffer_load_dwordx4 v[136:139], v2, s[24:27], s81 offen offset:0 sc1
v_exp_f32 v34, v34
v_exp_f32 v35, v35
v_mfma_f32_32x32x16_bf16 v[96:111], a[252:255], v[124:127], v[96:111]
v_exp_f32 v36, v36
v_exp_f32 v37, v37
v_exp_f32 v38, v38
v_exp_f32 v39, v39
v_exp_f32 v40, v40
buffer_load_dwordx4 v[140:143], v2, s[24:27], s81 offen offset:1024 sc1
v_cvt_pk_bf16_f32 v112, v32, v33
v_cvt_pk_bf16_f32 v113, v34, v35
v_cvt_pk_bf16_f32 v114, v36, v37
v_cvt_pk_bf16_f32 v115, v38, v39
v_exp_f32 v41, v41
v_exp_f32 v42, v42
v_mfma_f32_32x32x16_bf16 v[96:111], a[240:243], v[112:115], v[96:111]
v_exp_f32 v43, v43
v_exp_f32 v44, v44
v_exp_f32 v45, v45
s_add_u32 s98, s33, 32768
buffer_load_dwordx4 a[72:75], v2, s[24:27], s98 offen offset:0 sc1
v_exp_f32 v46, v46
v_exp_f32 v47, v47
v_cvt_pk_bf16_f32 v116, v40, v41
v_cvt_pk_bf16_f32 v117, v42, v43
v_cvt_pk_bf16_f32 v118, v44, v45
v_cvt_pk_bf16_f32 v119, v46, v47
v_mfma_f32_32x32x16_bf16 v[32:47], v[224:227], v[204:207], 0
v_exp_f32 v48, v48
v_exp_f32 v49, v49
v_exp_f32 v50, v50
v_exp_f32 v51, v51
v_mfma_f32_32x32x16_bf16 v[96:111], a[244:247], v[116:119], v[96:111]
v_exp_f32 v52, v52
v_exp_f32 v53, v53
v_exp_f32 v54, v54
v_exp_f32 v55, v55
v_exp_f32 v56, v56
v_cvt_pk_bf16_f32 v120, v48, v49
v_cvt_pk_bf16_f32 v121, v50, v51
v_cvt_pk_bf16_f32 v122, v52, v53
v_cvt_pk_bf16_f32 v123, v54, v55
v_exp_f32 v57, v57
v_exp_f32 v58, v58
v_mfma_f32_32x32x16_bf16 v[96:111], a[232:235], v[120:123], v[96:111]
v_exp_f32 v59, v59
v_exp_f32 v60, v60
v_exp_f32 v61, v61
v_exp_f32 v62, v62
v_exp_f32 v63, v63
v_cvt_pk_bf16_f32 v124, v56, v57
v_cvt_pk_bf16_f32 v125, v58, v59
v_cvt_pk_bf16_f32 v126, v60, v61
v_cvt_pk_bf16_f32 v127, v62, v63
v_mfma_f32_32x32x16_bf16 v[48:63], v[220:223], v[204:207], 0
v_exp_f32 v32, v32
s_waitcnt vmcnt(9)
buffer_store_dword v15, v14, s[24:27], s19 offen offset:0
v_exp_f32 v33, v33
v_exp_f32 v34, v34
v_exp_f32 v35, v35
v_mfma_f32_32x32x16_bf16 v[96:111], a[236:239], v[124:127], v[96:111]
v_exp_f32 v36, v36
v_exp_f32 v37, v37
v_exp_f32 v38, v38
v_exp_f32 v39, v39
v_exp_f32 v40, v40
buffer_load_dwordx4 a[84:87], v2, s[24:27], s98 offen offset:1024 sc1
v_cvt_pk_bf16_f32 v112, v32, v33
v_cvt_pk_bf16_f32 v113, v34, v35
v_cvt_pk_bf16_f32 v114, v36, v37
v_cvt_pk_bf16_f32 v115, v38, v39
v_exp_f32 v41, v41
v_exp_f32 v42, v42
v_mfma_f32_32x32x16_bf16 v[96:111], a[224:227], v[112:115], v[96:111]
v_exp_f32 v43, v43
v_exp_f32 v44, v44
buffer_load_dwordx4 a[96:99], v2, s[24:27], s98 offen offset:2048 sc1
v_exp_f32 v45, v45
v_exp_f32 v46, v46
v_exp_f32 v47, v47
v_cvt_pk_bf16_f32 v116, v40, v41
v_cvt_pk_bf16_f32 v117, v42, v43
v_cvt_pk_bf16_f32 v118, v44, v45
v_cvt_pk_bf16_f32 v119, v46, v47
v_mfma_f32_32x32x16_bf16 v[32:47], v[216:219], v[204:207], 0
v_exp_f32 v48, v48
v_exp_f32 v49, v49
buffer_load_dwordx4 a[108:111], v2, s[24:27], s98 offen offset:3072 sc1
v_exp_f32 v50, v50
v_exp_f32 v51, v51
v_mfma_f32_32x32x16_bf16 v[96:111], a[228:231], v[116:119], v[96:111]
v_exp_f32 v52, v52
v_exp_f32 v53, v53
v_exp_f32 v54, v54
v_exp_f32 v55, v55
v_exp_f32 v56, v56
v_cvt_pk_bf16_f32 v120, v48, v49
s_add_u32 s98, s32, 4096
buffer_load_dwordx4 a[112:115], v2, s[24:27], s98 offen offset:0 sc1
v_cvt_pk_bf16_f32 v121, v50, v51
v_cvt_pk_bf16_f32 v122, v52, v53
v_cvt_pk_bf16_f32 v123, v54, v55
v_exp_f32 v57, v57
v_exp_f32 v58, v58
v_mfma_f32_32x32x16_bf16 v[96:111], a[216:219], v[120:123], v[96:111]
v_exp_f32 v59, v59
v_exp_f32 v60, v60
v_exp_f32 v61, v61
buffer_load_dwordx4 a[124:127], v2, s[24:27], s98 offen offset:1024 sc1
v_exp_f32 v62, v62
v_exp_f32 v63, v63
v_cvt_pk_bf16_f32 v124, v56, v57
v_cvt_pk_bf16_f32 v125, v58, v59
v_cvt_pk_bf16_f32 v126, v60, v61
v_cvt_pk_bf16_f32 v127, v62, v63
v_mfma_f32_32x32x16_bf16 v[48:63], v[180:183], v[204:207], 0
v_exp_f32 v32, v32
v_exp_f32 v33, v33
buffer_load_dwordx4 a[136:139], v2, s[24:27], s98 offen offset:2048 sc1
v_exp_f32 v34, v34
v_exp_f32 v35, v35
v_mfma_f32_32x32x16_bf16 v[96:111], a[220:223], v[124:127], v[96:111]
v_exp_f32 v36, v36
v_exp_f32 v37, v37
v_exp_f32 v38, v38
v_exp_f32 v39, v39
v_exp_f32 v40, v40
buffer_load_dwordx4 a[148:151], v2, s[24:27], s98 offen offset:3072 sc1
v_cvt_pk_bf16_f32 v112, v32, v33
v_cvt_pk_bf16_f32 v113, v34, v35
v_cvt_pk_bf16_f32 v114, v36, v37
v_cvt_pk_bf16_f32 v115, v38, v39
v_exp_f32 v41, v41
v_exp_f32 v42, v42
v_mfma_f32_32x32x16_bf16 v[96:111], a[208:211], v[112:115], v[96:111]
v_exp_f32 v43, v43
v_exp_f32 v44, v44
v_exp_f32 v45, v45
s_add_u32 s98, s33, 20480
buffer_load_dwordx4 a[116:119], v2, s[24:27], s98 offen offset:0 sc1
v_exp_f32 v46, v46
v_exp_f32 v47, v47
v_mfma_f32_32x32x16_bf16 v[64:79], v[212:215], v[204:207], 0
v_cvt_pk_bf16_f32 v116, v40, v41
v_cvt_pk_bf16_f32 v117, v42, v43
v_cvt_pk_bf16_f32 v118, v44, v45
v_cvt_pk_bf16_f32 v119, v46, v47
s_nop 1
v_mfma_f32_32x32x16_bf16 v[96:111], a[212:215], v[116:119], v[96:111]
buffer_load_dwordx4 a[128:131], v2, s[24:27], s98 offen offset:1024 sc1
s_waitcnt vmcnt(12)
v_cmp_ne_u32 vcc, s72, v137
v_cmp_ne_u32 s[86:87], s72, v139
s_nop 0
s_or_b64 vcc, vcc, s[86:87]
s_waitcnt vmcnt(11)
v_cmp_ne_u32 s[86:87], s72, v141
s_nop 0
s_or_b64 vcc, vcc, s[86:87]
v_cmp_ne_u32 s[86:87], s72, v143
s_nop 0
s_or_b64 vcc, vcc, s[86:87]
s_cbranch_vccnz L_poll_1035
L_ret_1036:
v_mov_b32 v137, v138
v_mov_b32 v141, v142
s_lshl_b32 s79, s73, 10
buffer_load_dwordx4 a[140:143], v2, s[24:27], s98 offen offset:2048 sc1
v_lshl_add_u32 v7, v0, 3, s79
ds_write_b64 v7, v[136:137] offset:2048
ds_write_b64 v7, v[140:141] offset:2560
s_waitcnt lgkmcnt(0)
s_barrier
v_cndmask_b32 v48, v64, v48, s[40:41]
v_cndmask_b32 v49, v65, v49, s[42:43]
v_cndmask_b32 v50, v66, v50, s[44:45]
v_cndmask_b32 v51, v67, v51, s[46:47]
v_cndmask_b32 v52, v68, v52, s[48:49]
v_cndmask_b32 v53, v69, v53, s[50:51]
v_cndmask_b32 v54, v70, v54, s[52:53]
buffer_load_dwordx4 a[152:155], v2, s[24:27], s98 offen offset:3072 sc1
v_cndmask_b32 v55, v71, v55, s[54:55]
v_cndmask_b32 v56, v72, v56, s[56:57]
v_cndmask_b32 v57, v73, v57, s[58:59]
v_cndmask_b32 v58, v74, v58, s[60:61]
v_cndmask_b32 v59, v75, v59, s[62:63]
v_cndmask_b32 v60, v76, v60, s[64:65]
v_cndmask_b32 v61, v77, v61, s[66:67]
v_cndmask_b32 v62, v78, v62, s[68:69]
v_cndmask_b32 v63, v79, v63, s[70:71]
v_exp_f32 v48, v48
v_exp_f32 v49, v49
v_exp_f32 v50, v50
s_add_u32 s98, s33, 36864
buffer_load_dwordx4 a[120:123], v2, s[24:27], s98 offen offset:0 sc1
v_exp_f32 v51, v51
v_exp_f32 v52, v52
v_exp_f32 v53, v53
v_exp_f32 v54, v54
v_exp_f32 v55, v55
buffer_load_dword v8, v13, s[24:27], s20 offen offset:0 sc1
v_exp_f32 v56, v56
v_cvt_pk_bf16_f32 v120, v48, v49
v_cvt_pk_bf16_f32 v121, v50, v51
v_cvt_pk_bf16_f32 v122, v52, v53
v_cvt_pk_bf16_f32 v123, v54, v55
v_and_b32 v128, v120, v248
v_and_b32 v129, v121, v249
v_and_b32 v130, v122, v250
v_and_b32 v131, v123, v251
v_xor_b32 v120, v120, v128
v_xor_b32 v121, v121, v129
v_xor_b32 v122, v122, v130
v_xor_b32 v123, v123, v131
v_mfma_f32_32x32x16_bf16 v[96:111], v[192:195], v[128:131], v[96:111]
buffer_load_dwordx4 a[132:135], v2, s[24:27], s98 offen offset:1024 sc1
v_exp_f32 v57, v57
v_exp_f32 v58, v58
v_exp_f32 v59, v59
v_exp_f32 v60, v60
v_mfma_f32_32x32x16_bf16 v[96:111], a[200:203], v[120:123], v[96:111]
v_exp_f32 v61, v61
v_exp_f32 v62, v62
v_exp_f32 v63, v63
buffer_load_dwordx4 a[144:147], v2, s[24:27], s98 offen offset:2048 sc1
v_cvt_pk_bf16_f32 v124, v56, v57
v_cvt_pk_bf16_f32 v125, v58, v59
v_cvt_pk_bf16_f32 v126, v60, v61
v_cvt_pk_bf16_f32 v127, v62, v63
v_and_b32 v132, v124, v252
v_and_b32 v133, v125, v253
v_and_b32 v134, v126, v254
v_and_b32 v135, v127, v255
v_xor_b32 v124, v124, v132
v_xor_b32 v125, v125, v133
v_xor_b32 v126, v126, v134
v_xor_b32 v127, v127, v135
v_mfma_f32_32x32x16_bf16 v[96:111], v[196:199], v[132:135], v[96:111]
s_nop 0
v_mfma_f32_32x32x16_bf16 v[96:111], a[204:207], v[124:127], v[96:111]
buffer_load_dwordx4 a[156:159], v2, s[24:27], s98 offen offset:3072 sc1
s_nop 10
v_subrev_u32 v80, 0x21800000, v104
v_cmp_lt_u32 vcc, 0x3c000000, v80
s_nop 0
s_cbranch_vccnz L_fb_1037
L_fbret_1038:
v_rcp_f32 v104, v104
s_nop 0
v_pk_mul_f32 v[96:97], v[96:97], v[104:105] op_sel_hi:[1,0]
v_pk_mul_f32 v[98:99], v[98:99], v[104:105] op_sel_hi:[1,0]
v_pk_mul_f32 v[100:101], v[100:101], v[104:105] op_sel_hi:[1,0]
v_pk_mul_f32 v[102:103], v[102:103], v[104:105] op_sel_hi:[1,0]
v_cvt_pk_bf16_f32 v108, v96, v97
v_cvt_pk_bf16_f32 v109, v98, v99
s_add_u32 s98, s32, 8192
buffer_load_dwordx4 a[160:163], v2, s[24:27], s98 offen offset:0 sc1
v_cvt_pk_bf16_f32 v110, v100, v101
v_cvt_pk_bf16_f32 v111, v102, v103
buffer_store_dwordx4 v[108:111], v2, s[24:27], s8 offen sc1
s_mul_i32 s99, s73, 6144
s_add_u32 s99, s99, 139264
v_add_u32 v108, s99, v2
s_xor_b32 s99, s73, 1
s_mul_i32 s99, s99, 6144
s_add_u32 s99, s99, 139264
v_add_u32 v109, s99, v2
s_xor_b32 s99, s73, 2
s_mul_i32 s99, s99, 6144
s_add_u32 s99, s99, 139264
v_add_u32 v110, s99, v2
s_xor_b32 s99, s73, 3
s_mul_i32 s99, s99, 6144
s_add_u32 s99, s99, 139264
v_add_u32 v111, s99, v2
buffer_load_dwordx4 a[172:175], v2, s[24:27], s98 offen offset:1024 sc1
v_lshrrev_b32 v1, 5, v0
s_lshl_b32 s99, s76, 5
v_lshl_add_u32 v12, v1, 3, s99
ds_read_b64 v[80:81], v12 offset:2048
ds_read_b64 v[82:83], v12 offset:2064
s_waitcnt lgkmcnt(1)
v_lshlrev_b32 v64, 16, v80
s_add_u32 s98, s33, 24576
buffer_load_dwordx4 a[164:167], v2, s[24:27], s98 offen offset:0 sc1
v_and_b32 v65, s85, v80
v_lshlrev_b32 v66, 16, v81
v_and_b32 v67, s85, v81
s_waitcnt lgkmcnt(0)
v_lshlrev_b32 v68, 16, v82
v_and_b32 v69, s85, v82
v_lshlrev_b32 v70, 16, v83
v_and_b32 v71, s85, v83
ds_read_b64 v[84:85], v12 offset:4096
buffer_load_dwordx4 a[176:179], v2, s[24:27], s98 offen offset:1024 sc1
ds_read_b64 v[86:87], v12 offset:4112
s_waitcnt lgkmcnt(1)
v_lshlrev_b32 v72, 16, v84
s_waitcnt vmcnt(8)
v_cmp_ne_u32 vcc, s72, v8
s_nop 0
s_cbranch_vccnz L_poll_1033
L_ret_1034:
s_add_u32 s101, s9, 0
buffer_load_dwordx4 v[144:147], v2, s[24:27], s101 offen offset:0 sc1
v_and_b32 v73, s85, v84
v_lshlrev_b32 v74, 16, v85
v_and_b32 v75, s85, v85
s_waitcnt lgkmcnt(0)
v_lshlrev_b32 v76, 16, v86
v_and_b32 v77, s85, v86
v_lshlrev_b32 v78, 16, v87
v_and_b32 v79, s85, v87
v_lshlrev_b32 v16, 16, v20
v_and_b32 v17, s85, v20
v_lshlrev_b32 v18, 16, v21
buffer_load_dwordx4 v[148:151], v2, s[24:27], s101 offen offset:1024 sc1
v_and_b32 v19, s85, v21
v_lshlrev_b32 v20, 16, v22
v_and_b32 v21, s85, v22
v_lshlrev_b32 v22, 16, v23
v_and_b32 v23, s85, v23
v_bfe_u32 v3, v0, 4, 1
v_lshlrev_b32 v3, 14, v3
v_and_b32 v7, 15, v0
v_lshl_add_u32 v3, v7, 4, v3
v_lshl_add_u32 v3, v1, 8, v3
buffer_load_dwordx4 v[152:155], v2, s[24:27], s101 offen offset:2048 sc1
v_and_b32 v5, 31, v0
v_lshlrev_b32 v10, 2, v5
v_lshlrev_b32 v6, 3, v5
v_mov_b32 v9, v6
v_lshl_add_u32 v7, v1, 2, v6
s_lshl_b32 s99, s73, 8
v_add_u32 v7, s99, v7
v_lshlrev_b32 v5, 4, v5
v_lshl_add_u32 v11, v1, 12, v5
v_lshl_add_u32 v5, v1, 25, v5
buffer_load_dwordx4 v[156:159], v2, s[24:27], s101 offen offset:3072 sc1
s_add_u32 s99, s35, 73728
v_add_u32 v142, s99, v2
ds_read_b128 a[4:7], v142 offset:1024
ds_read_b128 a[12:15], v142 offset:3072
ds_read_b128 a[20:23], v142 offset:5120
s_waitcnt vmcnt(7)
buffer_store_dword v15, v14, s[24:27], s19 offen offset:128
s_add_u32 s101, s9, 4096
buffer_load_dwordx4 v[160:163], v2, s[24:27], s101 offen offset:0 sc1
buffer_load_dwordx4 v[164:167], v2, s[24:27], s101 offen offset:1024 sc1
s_waitcnt vmcnt(6) lgkmcnt(2)
v_mfma_f32_32x32x16_bf16 v[48:63], a[4:7], v[144:147], 0
buffer_load_dwordx4 v[168:171], v2, s[24:27], s101 offen offset:2048 sc1
ds_read_b128 a[28:31], v142 offset:7168
s_waitcnt vmcnt(6) lgkmcnt(2)
v_mfma_f32_32x32x16_bf16 v[48:63], a[12:15], v[148:151], v[48:63]
buffer_load_dwordx4 v[172:175], v2, s[24:27], s101 offen offset:3072 sc1
ds_read_b128 a[36:39], v142 offset:9216
s_waitcnt vmcnt(6) lgkmcnt(2)
v_mfma_f32_32x32x16_bf16 v[48:63], a[20:23], v[152:155], v[48:63]
s_add_u32 s98, s33, 40960
buffer_load_dwordx4 a[168:171], v2, s[24:27], s98 offen offset:0 sc1
ds_read_b128 a[44:47], v142 offset:11264
s_waitcnt vmcnt(6) lgkmcnt(2)
v_mfma_f32_32x32x16_bf16 v[48:63], a[28:31], v[156:159], v[48:63]
buffer_load_dwordx4 a[180:183], v2, s[24:27], s98 offen offset:1024 sc1
ds_read_b128 a[52:55], v142 offset:13312
s_add_u32 s98, s32, 8192
buffer_load_dwordx4 a[184:187], v2, s[24:27], s98 offen offset:2048 sc1
buffer_load_dwordx4 a[196:199], v2, s[24:27], s98 offen offset:3072 sc1
s_add_u32 s98, s33, 24576
buffer_load_dwordx4 a[188:191], v2, s[24:27], s98 offen offset:2048 sc1
buffer_load_dwordx4 a[200:203], v2, s[24:27], s98 offen offset:3072 sc1
s_waitcnt vmcnt(9) lgkmcnt(2)
v_mfma_f32_32x32x16_bf16 v[48:63], a[36:39], v[160:163], v[48:63]
s_add_u32 s98, s33, 40960
buffer_load_dwordx4 a[192:195], v2, s[24:27], s98 offen offset:2048 sc1
ds_read_b128 a[60:63], v142 offset:15360
s_waitcnt vmcnt(9) lgkmcnt(2)
v_mfma_f32_32x32x16_bf16 v[48:63], a[44:47], v[164:167], v[48:63]
buffer_load_dwordx4 a[204:207], v2, s[24:27], s98 offen offset:3072 sc1
ds_read_b128 a[0:3], v142 offset:0
s_waitcnt vmcnt(9) lgkmcnt(2)
v_mfma_f32_32x32x16_bf16 v[48:63], a[52:55], v[168:171], v[48:63]
buffer_load_dword v4, v13, s[24:27], s20 offen offset:128 sc1
ds_read_b128 a[8:11], v142 offset:2048
s_waitcnt vmcnt(9) lgkmcnt(2)
v_mfma_f32_32x32x16_bf16 v[48:63], a[60:63], v[172:175], v[48:63]
s_add_u32 s98, s32, 12288
buffer_load_dwordx4 a[208:211], v2, s[24:27], s98 offen offset:0 sc1
ds_read_b128 a[16:19], v142 offset:4096
s_waitcnt lgkmcnt(2)
v_mfma_f32_32x32x16_bf16 v[32:47], a[0:3], v[144:147], 0
ds_read_b128 a[24:27], v142 offset:6144
s_waitcnt lgkmcnt(2)
v_mfma_f32_32x32x16_bf16 v[32:47], a[8:11], v[148:151], v[32:47]
ds_read_b128 a[32:35], v142 offset:8192
s_waitcnt lgkmcnt(2)
v_mfma_f32_32x32x16_bf16 v[32:47], a[16:19], v[152:155], v[32:47]
buffer_load_dwordx4 a[220:223], v2, s[24:27], s98 offen offset:1024 sc1
ds_read_b128 a[40:43], v142 offset:10240
ds_write_b128 v110, v[48:51] offset:2048
buffer_load_dwordx4 a[232:235], v2, s[24:27], s98 offen offset:2048 sc1
s_waitcnt lgkmcnt(3)
v_mfma_f32_32x32x16_bf16 v[32:47], a[24:27], v[156:159], v[32:47]
ds_read_b128 a[48:51], v142 offset:12288
s_waitcnt lgkmcnt(3)
v_mfma_f32_32x32x16_bf16 v[32:47], a[32:35], v[160:163], v[32:47]
buffer_load_dwordx4 a[244:247], v2, s[24:27], s98 offen offset:3072 sc1
ds_read_b128 a[56:59], v142 offset:14336
ds_write_b128 v110, v[52:55] offset:3072
s_waitcnt lgkmcnt(4)
v_mfma_f32_32x32x16_bf16 v[32:47], a[40:43], v[164:167], v[32:47]
s_add_u32 s98, s33, 28672
buffer_load_dwordx4 a[212:215], v2, s[24:27], s98 offen offset:0 sc1
s_waitcnt lgkmcnt(2)
v_mfma_f32_32x32x16_bf16 v[32:47], a[48:51], v[168:171], v[32:47]
ds_write_b128 v111, v[56:59] offset:4096
s_waitcnt lgkmcnt(2)
v_mfma_f32_32x32x16_bf16 v[32:47], a[56:59], v[172:175], v[32:47]
buffer_load_dwordx4 a[224:227], v2, s[24:27], s98 offen offset:1024 sc1
ds_write_b128 v111, v[60:63] offset:5120
s_nop 9
ds_write_b128 v109, v[40:43] offset:0
buffer_load_dwordx4 a[236:239], v2, s[24:27], s98 offen offset:2048 sc1
ds_write_b128 v109, v[44:47] offset:1024
s_waitcnt lgkmcnt(0)
s_barrier
buffer_load_dwordx4 a[248:251], v2, s[24:27], s98 offen offset:3072 sc1
ds_read_b128 v[80:83], v108 offset:0
ds_read_b128 v[84:87], v108 offset:1024
ds_read_b128 v[88:91], v108 offset:2048
ds_read_b128 v[92:95], v108 offset:3072
s_add_u32 s98, s33, 45056
buffer_load_dwordx4 a[216:219], v2, s[24:27], s98 offen offset:0 sc1
ds_read_b128 v[96:99], v108 offset:4096
s_waitcnt vmcnt(9)
v_cmp_ne_u32 vcc, s72, v4
s_nop 0
s_cbranch_vccnz L_poll_2052
L_ret_2053:
ds_read_b128 v[100:103], v108 offset:5120
s_waitcnt lgkmcnt(5)
v_pk_add_f32 v[32:33], v[32:33], v[80:81]
s_add_u32 s101, s9, 32768
buffer_load_dwordx4 v[144:147], v2, s[24:27], s101 offen offset:0 sc1
v_pk_add_f32 v[34:35], v[34:35], v[82:83]
s_waitcnt lgkmcnt(4)
v_pk_add_f32 v[36:37], v[36:37], v[84:85]
v_pk_add_f32 v[38:39], v[38:39], v[86:87]
s_waitcnt lgkmcnt(1)
v_pk_add_f32 v[88:89], v[88:89], v[96:97]
v_pk_add_f32 v[90:91], v[90:91], v[98:99]
s_waitcnt lgkmcnt(0)
v_pk_add_f32 v[92:93], v[92:93], v[100:101]
v_pk_add_f32 v[94:95], v[94:95], v[102:103]
v_pk_add_f32 v[32:33], v[32:33], v[88:89]
v_pk_add_f32 v[34:35], v[34:35], v[90:91]
buffer_load_dwordx4 v[148:151], v2, s[24:27], s101 offen offset:1024 sc1
v_pk_add_f32 v[36:37], v[36:37], v[92:93]
v_pk_add_f32 v[38:39], v[38:39], v[94:95]
v_pk_fma_f32 v[16:17], v[64:65], v[32:33], v[16:17]
v_pk_fma_f32 v[18:19], v[66:67], v[34:35], v[18:19]
v_pk_fma_f32 v[20:21], v[68:69], v[36:37], v[20:21]
v_pk_fma_f32 v[22:23], v[70:71], v[38:39], v[22:23]
v_pk_mul_f32 v[32:33], v[72:73], v[16:17]
v_pk_mul_f32 v[34:35], v[74:75], v[18:19]
v_pk_mul_f32 v[36:37], v[76:77], v[20:21]
v_pk_mul_f32 v[38:39], v[78:79], v[22:23]
v_cvt_pk_bf16_f32 v104, v32, v33
v_cvt_pk_bf16_f32 v105, v34, v35
v_cvt_pk_bf16_f32 v106, v36, v37
v_cvt_pk_bf16_f32 v107, v38, v39
buffer_store_dwordx4 v[104:107], v3, s[24:27], s10 offen sc1
v_add_f32 v40, v16, v17
v_mul_f32 v41, v16, v16
v_fmac_f32 v41, v17, v17
v_add_f32 v40, v40, v18
v_fmac_f32 v41, v18, v18
v_add_f32 v40, v40, v19
v_fmac_f32 v41, v19, v19
v_add_f32 v40, v40, v20
v_fmac_f32 v41, v20, v20
v_add_f32 v40, v40, v21
v_fmac_f32 v41, v21, v21
v_add_f32 v40, v40, v22
v_fmac_f32 v41, v22, v22
v_add_f32 v40, v40, v23
v_fmac_f32 v41, v23, v23
buffer_load_dwordx4 v[152:155], v2, s[24:27], s101 offen offset:2048 sc1
s_nop 0
v_permlane32_swap_b32 v40, v41
v_add_f32 v40, v40, v41
ds_write_b32 v7, v40 offset:6144
s_add_u32 s10, s10, 32768
s_waitcnt lgkmcnt(0)
s_barrier
buffer_load_dwordx4 v[156:159], v2, s[24:27], s101 offen offset:3072 sc1
ds_read_b64 v[32:33], v6 offset:6144
ds_read_b64 v[34:35], v6 offset:6400
ds_read_b64 v[36:37], v6 offset:6656
ds_read_b64 v[38:39], v6 offset:6912
s_waitcnt lgkmcnt(2)
v_pk_add_f32 v[32:33], v[32:33], v[34:35]
s_add_u32 s101, s9, 36864
buffer_load_dwordx4 v[160:163], v2, s[24:27], s101 offen offset:0 sc1
s_waitcnt lgkmcnt(0)
v_pk_add_f32 v[36:37], v[36:37], v[38:39]
v_pk_add_f32 v[32:33], v[32:33], v[36:37]
v_mov_b32 v34, v15
v_mov_b32 v35, v15
buffer_store_dwordx4 v[32:35], v5, s[24:27], s22 offen offset:0
v_lshlrev_b32 v24, 16, v28
v_and_b32 v25, s85, v28
v_lshlrev_b32 v26, 16, v29
v_and_b32 v27, s85, v29
v_lshlrev_b32 v28, 16, v30
v_and_b32 v29, s85, v30
v_lshlrev_b32 v30, 16, v31
v_and_b32 v31, s85, v31
v_and_b32 v141, 1, v0
v_lshlrev_b32 v141, 10, v141
buffer_load_dwordx4 v[164:167], v2, s[24:27], s101 offen offset:1024 sc1
v_sub_u32 v141, 4096, v141
v_lshrrev_b32 v140, 5, v0
v_lshl_add_u32 v141, v140, 5, v141
v_bfe_u32 v140, v0, 4, 1
v_lshl_add_u32 v141, v140, 3, v141
ds_read2_b64 v[124:127], v141 offset0:0 offset1:2
ds_read2_b64 v[128:131], v141 offset0:8 offset1:10
ds_read2_b64 v[132:135], v141 offset0:16 offset1:18
buffer_load_dwordx4 v[168:171], v2, s[24:27], s101 offen offset:2048 sc1
s_waitcnt lgkmcnt(2)
v_mfma_f32_16x16x32_bf16 v[112:115], a[64:67], v[124:127], 0
buffer_load_dwordx4 v[172:175], v2, s[24:27], s101 offen offset:3072 sc1
ds_read2_b64 v[136:139], v141 offset0:24 offset1:26
v_mfma_f32_16x16x32_bf16 v[116:119], a[68:71], v[124:127], 0
v_mfma_f32_16x16x32_bf16 v[120:123], a[72:75], v[124:127], 0
s_waitcnt lgkmcnt(2)
v_mfma_f32_16x16x32_bf16 v[112:115], a[76:79], v[128:131], v[112:115]
ds_read2_b64 v[124:127], v141 offset0:32 offset1:34
buffer_load_dwordx4 a[228:231], v2, s[24:27], s98 offen offset:1024 sc1
v_mfma_f32_16x16x32_bf16 v[116:119], a[80:83], v[128:131], v[116:119]
v_mfma_f32_16x16x32_bf16 v[120:123], a[84:87], v[128:131], v[120:123]
s_waitcnt lgkmcnt(2)
v_mfma_f32_16x16x32_bf16 v[112:115], a[88:91], v[132:135], v[112:115]
ds_read2_b64 v[128:131], v141 offset0:40 offset1:42
v_mfma_f32_16x16x32_bf16 v[116:119], a[92:95], v[132:135], v[116:119]
v_mfma_f32_16x16x32_bf16 v[120:123], a[96:99], v[132:135], v[120:123]
buffer_load_dwordx4 a[240:243], v2, s[24:27], s98 offen offset:2048 sc1
s_waitcnt lgkmcnt(2)
v_mfma_f32_16x16x32_bf16 v[112:115], a[100:103], v[136:139], v[112:115]
v_mfma_f32_16x16x32_bf16 v[116:119], a[104:107], v[136:139], v[116:119]
v_mfma_f32_16x16x32_bf16 v[120:123], a[108:111], v[136:139], v[120:123]
s_waitcnt lgkmcnt(1)
v_mfma_f32_16x16x32_bf16 v[112:115], a[112:115], v[124:127], v[112:115]
v_mfma_f32_16x16x32_bf16 v[116:119], a[116:119], v[124:127], v[116:119]
v_mfma_f32_16x16x32_bf16 v[120:123], a[120:123], v[124:127], v[120:123]
s_waitcnt lgkmcnt(0)
v_mfma_f32_16x16x32_bf16 v[112:115], a[124:127], v[128:131], v[112:115]
v_mfma_f32_16x16x32_bf16 v[116:119], a[128:131], v[128:131], v[116:119]
v_mfma_f32_16x16x32_bf16 v[120:123], a[132:135], v[128:131], v[120:123]
s_waitcnt vmcnt(11)
v_mfma_f32_32x32x16_bf16 v[48:63], a[4:7], v[144:147], 0
s_waitcnt vmcnt(10)
v_mfma_f32_32x32x16_bf16 v[48:63], a[12:15], v[148:151], v[48:63]
s_waitcnt vmcnt(9)
buffer_store_dword v15, v14, s[24:27], s19 offen offset:256
s_waitcnt vmcnt(9)
v_mfma_f32_32x32x16_bf16 v[48:63], a[20:23], v[152:155], v[48:63]
buffer_load_dwordx4 a[252:255], v2, s[24:27], s98 offen offset:3072 sc1
s_waitcnt vmcnt(9)
v_mfma_f32_32x32x16_bf16 v[48:63], a[28:31], v[156:159], v[48:63]
s_waitcnt vmcnt(8)
v_mfma_f32_32x32x16_bf16 v[48:63], a[36:39], v[160:163], v[48:63]
s_waitcnt vmcnt(6)
v_mfma_f32_32x32x16_bf16 v[48:63], a[44:47], v[164:167], v[48:63]
s_waitcnt vmcnt(5)
v_mfma_f32_32x32x16_bf16 v[48:63], a[52:55], v[168:171], v[48:63]
s_waitcnt vmcnt(4)
v_mfma_f32_32x32x16_bf16 v[48:63], a[60:63], v[172:175], v[48:63]
v_mfma_f32_32x32x16_bf16 v[32:47], a[0:3], v[144:147], 0
v_mfma_f32_32x32x16_bf16 v[32:47], a[8:11], v[148:151], v[32:47]
v_mfma_f32_32x32x16_bf16 v[32:47], a[16:19], v[152:155], v[32:47]
buffer_load_dword v8, v13, s[24:27], s20 offen offset:256 sc1
s_nop 7
ds_write_b128 v110, v[48:51] offset:2048
v_mfma_f32_32x32x16_bf16 v[32:47], a[24:27], v[156:159], v[32:47]
v_mfma_f32_32x32x16_bf16 v[32:47], a[32:35], v[160:163], v[32:47]
ds_write_b128 v110, v[52:55] offset:3072
v_mfma_f32_32x32x16_bf16 v[32:47], a[40:43], v[164:167], v[32:47]
v_mfma_f32_32x32x16_bf16 v[32:47], a[48:51], v[168:171], v[32:47]
ds_write_b128 v111, v[56:59] offset:4096
v_mfma_f32_32x32x16_bf16 v[32:47], a[56:59], v[172:175], v[32:47]
ds_write_b128 v111, v[60:63] offset:5120
s_nop 10
ds_write_b128 v109, v[40:43] offset:0
ds_write_b128 v109, v[44:47] offset:1024
s_waitcnt lgkmcnt(0)
s_barrier
ds_read_b128 v[80:83], v108 offset:0
ds_read_b128 v[84:87], v108 offset:1024
ds_read_b128 v[88:91], v108 offset:2048
ds_read_b128 v[92:95], v108 offset:3072
ds_read_b128 v[96:99], v108 offset:4096
ds_read_b128 v[100:103], v108 offset:5120
s_waitcnt lgkmcnt(5)
v_pk_add_f32 v[32:33], v[32:33], v[80:81]
s_waitcnt vmcnt(0)
v_cmp_ne_u32 vcc, s72, v8
s_nop 0
s_cbranch_vccnz L_poll_2057
L_ret_2058:
s_cmp_lg_u32 s73, 0
s_cbranch_scc1 L_nost_2054a
buffer_load_dwordx4 v[240:243], v11, s[24:27], s23 offen offset:0 sc1
buffer_load_dwordx4 v[244:247], v11, s[24:27], s23 offen offset:1024 sc1
buffer_load_dwordx4 v[248:251], v11, s[24:27], s23 offen offset:2048 sc1
buffer_load_dwordx4 v[252:255], v11, s[24:27], s23 offen offset:3072 sc1
L_nost_2054a:
v_pk_add_f32 v[34:35], v[34:35], v[82:83]
s_waitcnt lgkmcnt(4)
v_pk_add_f32 v[36:37], v[36:37], v[84:85]
v_pk_add_f32 v[38:39], v[38:39], v[86:87]
s_waitcnt lgkmcnt(1)
v_pk_add_f32 v[88:89], v[88:89], v[96:97]
v_pk_add_f32 v[90:91], v[90:91], v[98:99]
s_waitcnt lgkmcnt(0)
v_pk_add_f32 v[92:93], v[92:93], v[100:101]
v_pk_add_f32 v[94:95], v[94:95], v[102:103]
v_pk_add_f32 v[32:33], v[32:33], v[88:89]
v_pk_add_f32 v[34:35], v[34:35], v[90:91]
v_pk_add_f32 v[36:37], v[36:37], v[92:93]
s_add_u32 m0, s38, 8192
s_add_u32 s101, s11, 0
buffer_load_dwordx4 v2, s[24:27], s101 offen offset:0 sc1 lds
v_pk_add_f32 v[38:39], v[38:39], v[94:95]
v_pk_fma_f32 v[24:25], v[64:65], v[32:33], v[24:25]
v_pk_fma_f32 v[26:27], v[66:67], v[34:35], v[26:27]
v_pk_fma_f32 v[28:29], v[68:69], v[36:37], v[28:29]
v_pk_fma_f32 v[30:31], v[70:71], v[38:39], v[30:31]
v_pk_mul_f32 v[32:33], v[72:73], v[24:25]
v_pk_mul_f32 v[34:35], v[74:75], v[26:27]
v_pk_mul_f32 v[36:37], v[76:77], v[28:29]
v_pk_mul_f32 v[38:39], v[78:79], v[30:31]
v_cvt_pk_bf16_f32 v104, v32, v33
buffer_load_dwordx4 v2, s[24:27], s101 offen offset:1024 sc1 lds
v_cvt_pk_bf16_f32 v105, v34, v35
v_cvt_pk_bf16_f32 v106, v36, v37
v_cvt_pk_bf16_f32 v107, v38, v39
buffer_store_dwordx4 v[104:107], v3, s[24:27], s10 offen sc1
v_add_f32 v40, v24, v25
v_mul_f32 v41, v24, v24
v_fmac_f32 v41, v25, v25
v_add_f32 v40, v40, v26
v_fmac_f32 v41, v26, v26
v_add_f32 v40, v40, v27
v_fmac_f32 v41, v27, v27
v_add_f32 v40, v40, v28
v_fmac_f32 v41, v28, v28
v_add_f32 v40, v40, v29
buffer_load_dwordx4 v2, s[24:27], s101 offen offset:2048 sc1 lds
v_fmac_f32 v41, v29, v29
v_add_f32 v40, v40, v30
v_fmac_f32 v41, v30, v30
v_add_f32 v40, v40, v31
v_fmac_f32 v41, v31, v31
s_nop 1
v_permlane32_swap_b32 v40, v41
v_add_f32 v40, v40, v41
ds_write_b32 v7, v40 offset:6144
s_waitcnt lgkmcnt(0)
s_barrier
buffer_load_dwordx4 v2, s[24:27], s101 offen offset:3072 sc1 lds
ds_read_b64 v[32:33], v6 offset:6144
ds_read_b64 v[34:35], v6 offset:6400
ds_read_b64 v[36:37], v6 offset:6656
ds_read_b64 v[38:39], v6 offset:6912
s_add_u32 m0, s38, 24576
s_add_u32 s101, s11, 16384
buffer_load_dwordx4 v2, s[24:27], s101 offen offset:0 sc1 lds
s_waitcnt lgkmcnt(2)
v_pk_add_f32 v[32:33], v[32:33], v[34:35]
s_waitcnt lgkmcnt(0)
v_pk_add_f32 v[36:37], v[36:37], v[38:39]
v_pk_add_f32 v[32:33], v[32:33], v[36:37]
v_mov_b32 v34, v15
v_mov_b32 v35, v15
buffer_store_dwordx4 v[32:35], v5, s[24:27], s22 offen offset:512
ds_read2_b64 v[132:135], v141 offset0:48 offset1:50
ds_read2_b64 v[136:139], v141 offset0:56 offset1:58
ds_read2_b64 v[124:127], v141 offset0:64 offset1:66
s_waitcnt lgkmcnt(2)
v_mfma_f32_16x16x32_bf16 v[112:115], a[136:139], v[132:135], v[112:115]
buffer_load_dwordx4 v2, s[24:27], s101 offen offset:1024 sc1 lds
ds_read2_b64 v[128:131], v141 offset0:72 offset1:74
v_mfma_f32_16x16x32_bf16 v[116:119], a[140:143], v[132:135], v[116:119]
v_mfma_f32_16x16x32_bf16 v[120:123], a[144:147], v[132:135], v[120:123]
s_waitcnt lgkmcnt(2)
v_mfma_f32_16x16x32_bf16 v[112:115], a[148:151], v[136:139], v[112:115]
buffer_load_dwordx4 v2, s[24:27], s101 offen offset:2048 sc1 lds
ds_read2_b64 v[132:135], v141 offset0:80 offset1:82
v_mfma_f32_16x16x32_bf16 v[116:119], a[152:155], v[136:139], v[116:119]
v_mfma_f32_16x16x32_bf16 v[120:123], a[156:159], v[136:139], v[120:123]
s_waitcnt lgkmcnt(2)
v_mfma_f32_16x16x32_bf16 v[112:115], a[160:163], v[124:127], v[112:115]
buffer_load_dwordx4 v2, s[24:27], s101 offen offset:3072 sc1 lds
ds_read2_b64 v[136:139], v141 offset0:88 offset1:90
v_mfma_f32_16x16x32_bf16 v[116:119], a[164:167], v[124:127], v[116:119]
v_mfma_f32_16x16x32_bf16 v[120:123], a[168:171], v[124:127], v[120:123]
s_waitcnt lgkmcnt(2)
v_mfma_f32_16x16x32_bf16 v[112:115], a[172:175], v[128:131], v[112:115]
s_add_u32 s98, s39, 24576
buffer_load_dwordx4 v[176:179], v2, s[24:27], s98 offen offset:0 sc1
ds_read2_b64 v[124:127], v141 offset0:96 offset1:98
v_mfma_f32_16x16x32_bf16 v[116:119], a[176:179], v[128:131], v[116:119]
v_mfma_f32_16x16x32_bf16 v[120:123], a[180:183], v[128:131], v[120:123]
s_waitcnt lgkmcnt(2)
v_mfma_f32_16x16x32_bf16 v[112:115], a[184:187], v[132:135], v[112:115]
buffer_load_dwordx4 v[180:183], v2, s[24:27], s98 offen offset:1024 sc1
ds_read2_b64 v[128:131], v141 offset0:104 offset1:106
v_mfma_f32_16x16x32_bf16 v[116:119], a[188:191], v[132:135], v[116:119]
v_mfma_f32_16x16x32_bf16 v[120:123], a[192:195], v[132:135], v[120:123]
s_waitcnt lgkmcnt(2)
v_mfma_f32_16x16x32_bf16 v[112:115], a[196:199], v[136:139], v[112:115]
ds_read2_b64 v[132:135], v141 offset0:112 offset1:114
v_mfma_f32_16x16x32_bf16 v[116:119], a[200:203], v[136:139], v[116:119]
s_waitcnt vmcnt(9)
buffer_store_dword v15, v14, s[24:27], s19 offen offset:384
v_mfma_f32_16x16x32_bf16 v[120:123], a[204:207], v[136:139], v[120:123]
s_waitcnt lgkmcnt(2)
v_mfma_f32_16x16x32_bf16 v[112:115], a[208:211], v[124:127], v[112:115]
ds_read2_b64 v[136:139], v141 offset0:120 offset1:122
v_mfma_f32_16x16x32_bf16 v[116:119], a[212:215], v[124:127], v[116:119]
v_mfma_f32_16x16x32_bf16 v[120:123], a[216:219], v[124:127], v[120:123]
s_waitcnt lgkmcnt(2)
v_mfma_f32_16x16x32_bf16 v[112:115], a[220:223], v[128:131], v[112:115]
buffer_load_dwordx4 v[184:187], v2, s[24:27], s98 offen offset:2048 sc1
v_mfma_f32_16x16x32_bf16 v[116:119], a[224:227], v[128:131], v[116:119]
v_mfma_f32_16x16x32_bf16 v[120:123], a[228:231], v[128:131], v[120:123]
s_waitcnt lgkmcnt(1)
v_mfma_f32_16x16x32_bf16 v[112:115], a[232:235], v[132:135], v[112:115]
v_mfma_f32_16x16x32_bf16 v[116:119], a[236:239], v[132:135], v[116:119]
v_mfma_f32_16x16x32_bf16 v[120:123], a[240:243], v[132:135], v[120:123]
buffer_load_dwordx4 v[188:191], v2, s[24:27], s98 offen offset:3072 sc1
s_waitcnt lgkmcnt(0)
v_mfma_f32_16x16x32_bf16 v[112:115], a[244:247], v[136:139], v[112:115]
v_mfma_f32_16x16x32_bf16 v[116:119], a[248:251], v[136:139], v[116:119]
v_mfma_f32_16x16x32_bf16 v[120:123], a[252:255], v[136:139], v[120:123]
v_mov_b32 v140, 0xbfb8aa3b
s_nop 4
v_mul_f32_dpp v124, v112, v140 quad_perm:[1,1,3,3] row_mask:0xf bank_mask:0xf
v_mul_f32_dpp v125, v113, v140 quad_perm:[1,1,3,3] row_mask:0xf bank_mask:0xf
v_mul_f32_dpp v126, v114, v140 quad_perm:[1,1,3,3] row_mask:0xf bank_mask:0xf
s_add_u32 s98, s39, 28672
buffer_load_dwordx4 v[192:195], v2, s[24:27], s98 offen offset:0 sc1
v_mul_f32_dpp v127, v115, v140 quad_perm:[1,1,3,3] row_mask:0xf bank_mask:0xf
v_mul_f32_dpp v128, v116, v140 quad_perm:[1,1,3,3] row_mask:0xf bank_mask:0xf
v_mul_f32_dpp v129, v117, v140 quad_perm:[1,1,3,3] row_mask:0xf bank_mask:0xf
v_mul_f32_dpp v130, v118, v140 quad_perm:[1,1,3,3] row_mask:0xf bank_mask:0xf
v_mul_f32_dpp v131, v119, v140 quad_perm:[1,1,3,3] row_mask:0xf bank_mask:0xf
v_mul_f32_dpp v132, v120, v140 quad_perm:[1,1,3,3] row_mask:0xf bank_mask:0xf
v_mul_f32_dpp v133, v121, v140 quad_perm:[1,1,3,3] row_mask:0xf bank_mask:0xf
v_mul_f32_dpp v134, v122, v140 quad_perm:[1,1,3,3] row_mask:0xf bank_mask:0xf
v_mul_f32_dpp v135, v123, v140 quad_perm:[1,1,3,3] row_mask:0xf bank_mask:0xf
v_mov_b32_dpp v112, v112 quad_perm:[0,0,2,2] row_mask:0xf bank_mask:0xf
buffer_load_dwordx4 v[196:199], v2, s[24:27], s98 offen offset:1024 sc1
v_mov_b32_dpp v113, v113 quad_perm:[0,0,2,2] row_mask:0xf bank_mask:0xf
v_mov_b32_dpp v114, v114 quad_perm:[0,0,2,2] row_mask:0xf bank_mask:0xf
v_mov_b32_dpp v115, v115 quad_perm:[0,0,2,2] row_mask:0xf bank_mask:0xf
v_mov_b32_dpp v116, v116 quad_perm:[0,0,2,2] row_mask:0xf bank_mask:0xf
v_mov_b32_dpp v117, v117 quad_perm:[0,0,2,2] row_mask:0xf bank_mask:0xf
v_mov_b32_dpp v118, v118 quad_perm:[0,0,2,2] row_mask:0xf bank_mask:0xf
v_mov_b32_dpp v119, v119 quad_perm:[0,0,2,2] row_mask:0xf bank_mask:0xf
v_mov_b32_dpp v120, v120 quad_perm:[0,0,2,2] row_mask:0xf bank_mask:0xf
v_mov_b32_dpp v121, v121 quad_perm:[0,0,2,2] row_mask:0xf bank_mask:0xf
v_mov_b32_dpp v122, v122 quad_perm:[0,0,2,2] row_mask:0xf bank_mask:0xf
v_mov_b32_dpp v123, v123 quad_perm:[0,0,2,2] row_mask:0xf bank_mask:0xf
v_add_u32 v6, 8192, v2
v_and_b32 v7, 15, v0
v_lshlrev_b32 v7, 3, v7
s_cmp_lg_u32 s73, 0
s_cbranch_scc1 L_nost_2054b
v_cmp_ne_u32 vcc, s72, v242
v_cmp_ne_u32 s[86:87], s72, v246
s_nop 0
s_or_b64 vcc, vcc, s[86:87]
v_cmp_ne_u32 s[86:87], s72, v250
s_nop 0
s_or_b64 vcc, vcc, s[86:87]
v_cmp_ne_u32 s[86:87], s72, v254
s_nop 0
s_or_b64 vcc, vcc, s[86:87]
s_cbranch_vccnz L_poll_2055
L_ret_2056:
v_pk_add_f32 v[240:241], v[240:241], v[244:245]
v_pk_add_f32 v[248:249], v[248:249], v[252:253]
v_pk_add_f32 v[240:241], v[240:241], v[248:249]
s_nop 1
v_permlane32_swap_b32 v240, v241
v_add_f32 v240, v240, v241
v_mov_b32 v241, v240
s_nop 1
v_permlane32_swap_b32 v240, v241
s_mov_b32 s78, 0x3b000000
v_mul_f32 v240, s78, v240
v_mul_f32 v242, v240, v240
v_fma_f32 v241, v241, s78, -v242
v_max_f32 v241, 0, v241
v_add_f32 v241, 0x3727c5ac, v241
v_rsq_f32 v241, v241
s_nop 0
v_mul_f32 v241, 0xbfb8aa3b, v241
ds_write_b64 v9, v[240:241] offset:7168
s_waitcnt lgkmcnt(0)
L_nost_2054b:
buffer_load_dword v4, v13, s[24:27], s20 offen offset:384 sc1
s_waitcnt vmcnt(8)
s_barrier
buffer_load_dwordx4 v[200:203], v2, s[24:27], s98 offen offset:2048 sc1
ds_read_b64 v[72:73], v7 offset:7168
ds_read_b64 v[74:75], v7 offset:7296
ds_read_b128 v[56:59], v6 offset:0
ds_read_b128 v[60:63], v6 offset:1024
buffer_load_dwordx4 v[204:207], v2, s[24:27], s98 offen offset:3072 sc1
ds_read_b128 v[64:67], v6 offset:2048
s_waitcnt lgkmcnt(2)
v_mfma_f32_16x16x32_bf16 v[32:35], a[64:67], v[56:59], 0
s_add_u32 s98, s39, 32768
buffer_load_dwordx4 v[208:211], v2, s[24:27], s98 offen offset:0 sc1
ds_read_b128 v[68:71], v6 offset:3072
v_mfma_f32_16x16x32_bf16 v[36:39], a[68:71], v[56:59], 0
v_mfma_f32_16x16x32_bf16 v[40:43], a[72:75], v[56:59], 0
s_waitcnt lgkmcnt(2)
v_mfma_f32_16x16x32_bf16 v[32:35], a[76:79], v[60:63], v[32:35]
buffer_load_dwordx4 v[212:215], v2, s[24:27], s98 offen offset:1024 sc1
ds_read_b128 v[56:59], v6 offset:4096
v_mfma_f32_16x16x32_bf16 v[36:39], a[80:83], v[60:63], v[36:39]
v_mfma_f32_16x16x32_bf16 v[40:43], a[84:87], v[60:63], v[40:43]
s_waitcnt lgkmcnt(2)
v_mfma_f32_16x16x32_bf16 v[32:35], a[88:91], v[64:67], v[32:35]
buffer_load_dwordx4 v[216:219], v2, s[24:27], s98 offen offset:2048 sc1
ds_read_b128 v[60:63], v6 offset:5120
v_mfma_f32_16x16x32_bf16 v[36:39], a[92:95], v[64:67], v[36:39]
v_mfma_f32_16x16x32_bf16 v[40:43], a[96:99], v[64:67], v[40:43]
s_waitcnt lgkmcnt(2)
v_mfma_f32_16x16x32_bf16 v[32:35], a[100:103], v[68:71], v[32:35]
buffer_load_dwordx4 v[220:223], v2, s[24:27], s98 offen offset:3072 sc1
ds_read_b128 v[64:67], v6 offset:6144
v_mfma_f32_16x16x32_bf16 v[36:39], a[104:107], v[68:71], v[36:39]
v_mfma_f32_16x16x32_bf16 v[40:43], a[108:111], v[68:71], v[40:43]
s_waitcnt lgkmcnt(2)
v_mfma_f32_16x16x32_bf16 v[32:35], a[112:115], v[56:59], v[32:35]
s_add_u32 s98, s39, 36864
buffer_load_dwordx4 v[224:227], v2, s[24:27], s98 offen offset:0 sc1
ds_read_b128 v[68:71], v6 offset:7168
v_mfma_f32_16x16x32_bf16 v[36:39], a[116:119], v[56:59], v[36:39]
v_mfma_f32_16x16x32_bf16 v[40:43], a[120:123], v[56:59], v[40:43]
s_waitcnt lgkmcnt(2)
v_mfma_f32_16x16x32_bf16 v[32:35], a[124:127], v[60:63], v[32:35]
buffer_load_dwordx4 v[228:231], v2, s[24:27], s98 offen offset:1024 sc1
ds_read_b128 v[56:59], v6 offset:8192
s_waitcnt vmcnt(8)
v_cmp_ne_u32 vcc, s72, v4
s_nop 0
s_cbranch_vccnz L_poll_2062
L_ret_2063:
s_cmp_lg_u32 s73, 0
s_cbranch_scc1 L_nost_2059a
buffer_load_dwordx4 v[240:243], v11, s[24:27], s23 offen offset:512 sc1
buffer_load_dwordx4 v[244:247], v11, s[24:27], s23 offen offset:1536 sc1
buffer_load_dwordx4 v[248:251], v11, s[24:27], s23 offen offset:2560 sc1
buffer_load_dwordx4 v[252:255], v11, s[24:27], s23 offen offset:3584 sc1
L_nost_2059a:
v_mfma_f32_16x16x32_bf16 v[36:39], a[128:131], v[60:63], v[36:39]
v_mfma_f32_16x16x32_bf16 v[40:43], a[132:135], v[60:63], v[40:43]
s_waitcnt lgkmcnt(2)
v_mfma_f32_16x16x32_bf16 v[32:35], a[136:139], v[64:67], v[32:35]
ds_read_b128 v[60:63], v6 offset:9216
v_mfma_f32_16x16x32_bf16 v[36:39], a[140:143], v[64:67], v[36:39]
v_mfma_f32_16x16x32_bf16 v[40:43], a[144:147], v[64:67], v[40:43]
s_add_u32 m0, s38, 40960
s_add_u32 s101, s11, 32768
buffer_load_dwordx4 v2, s[24:27], s101 offen offset:0 sc1 lds
s_waitcnt lgkmcnt(2)
v_mfma_f32_16x16x32_bf16 v[32:35], a[148:151], v[68:71], v[32:35]
ds_read_b128 v[64:67], v6 offset:10240
v_mfma_f32_16x16x32_bf16 v[36:39], a[152:155], v[68:71], v[36:39]
v_mfma_f32_16x16x32_bf16 v[40:43], a[156:159], v[68:71], v[40:43]
s_waitcnt lgkmcnt(2)
v_mfma_f32_16x16x32_bf16 v[32:35], a[160:163], v[56:59], v[32:35]
buffer_load_dwordx4 v2, s[24:27], s101 offen offset:1024 sc1 lds
ds_read_b128 v[68:71], v6 offset:11264
v_mfma_f32_16x16x32_bf16 v[36:39], a[164:167], v[56:59], v[36:39]
v_mfma_f32_16x16x32_bf16 v[40:43], a[168:171], v[56:59], v[40:43]
s_waitcnt lgkmcnt(2)
v_mfma_f32_16x16x32_bf16 v[32:35], a[172:175], v[60:63], v[32:35]
ds_read_b128 v[56:59], v6 offset:12288
buffer_load_dwordx4 v2, s[24:27], s101 offen offset:2048 sc1 lds
v_mfma_f32_16x16x32_bf16 v[36:39], a[176:179], v[60:63], v[36:39]
v_mfma_f32_16x16x32_bf16 v[40:43], a[180:183], v[60:63], v[40:43]
s_waitcnt lgkmcnt(2)
v_mfma_f32_16x16x32_bf16 v[32:35], a[184:187], v[64:67], v[32:35]
ds_read_b128 v[60:63], v6 offset:13312
v_mfma_f32_16x16x32_bf16 v[36:39], a[188:191], v[64:67], v[36:39]
v_mfma_f32_16x16x32_bf16 v[40:43], a[192:195], v[64:67], v[40:43]
buffer_load_dwordx4 v2, s[24:27], s101 offen offset:3072 sc1 lds
s_waitcnt lgkmcnt(2)
v_mfma_f32_16x16x32_bf16 v[32:35], a[196:199], v[68:71], v[32:35]
ds_read_b128 v[64:67], v6 offset:14336
v_mfma_f32_16x16x32_bf16 v[36:39], a[200:203], v[68:71], v[36:39]
v_mfma_f32_16x16x32_bf16 v[40:43], a[204:207], v[68:71], v[40:43]
s_waitcnt lgkmcnt(2)
v_mfma_f32_16x16x32_bf16 v[32:35], a[208:211], v[56:59], v[32:35]
s_add_u32 m0, s38, 57344
s_add_u32 s101, s11, 49152
buffer_load_dwordx4 v2, s[24:27], s101 offen offset:0 sc1 lds
ds_read_b128 v[68:71], v6 offset:15360
v_mfma_f32_16x16x32_bf16 v[36:39], a[212:215], v[56:59], v[36:39]
v_mfma_f32_16x16x32_bf16 v[40:43], a[216:219], v[56:59], v[40:43]
s_waitcnt lgkmcnt(2)
v_mfma_f32_16x16x32_bf16 v[32:35], a[220:223], v[60:63], v[32:35]
buffer_load_dwordx4 v2, s[24:27], s101 offen offset:1024 sc1 lds
v_mfma_f32_16x16x32_bf16 v[36:39], a[224:227], v[60:63], v[36:39]
v_mfma_f32_16x16x32_bf16 v[40:43], a[228:231], v[60:63], v[40:43]
s_waitcnt lgkmcnt(1)
v_mfma_f32_16x16x32_bf16 v[32:35], a[232:235], v[64:67], v[32:35]
v_mfma_f32_16x16x32_bf16 v[36:39], a[236:239], v[64:67], v[36:39]
buffer_load_dwordx4 v2, s[24:27], s101 offen offset:2048 sc1 lds
v_mfma_f32_16x16x32_bf16 v[40:43], a[240:243], v[64:67], v[40:43]
s_waitcnt lgkmcnt(0)
v_mfma_f32_16x16x32_bf16 v[32:35], a[244:247], v[68:71], v[32:35]
v_mfma_f32_16x16x32_bf16 v[36:39], a[248:251], v[68:71], v[36:39]
v_mfma_f32_16x16x32_bf16 v[40:43], a[252:255], v[68:71], v[40:43]
buffer_load_dwordx4 v2, s[24:27], s101 offen offset:3072 sc1 lds
ds_read_b128 v[56:59], v6 offset:16384
ds_read_b128 v[60:63], v6 offset:17408
ds_read_b128 v[64:67], v6 offset:18432
s_waitcnt lgkmcnt(2)
v_mfma_f32_16x16x32_bf16 v[44:47], a[64:67], v[56:59], 0
buffer_load_dwordx4 v[232:235], v2, s[24:27], s98 offen offset:2048 sc1
ds_read_b128 v[68:71], v6 offset:19456
v_mfma_f32_16x16x32_bf16 v[48:51], a[68:71], v[56:59], 0
v_fma_f32 v32, -v72, v112, v32
v_fma_f32 v33, -v72, v113, v33
v_mfma_f32_16x16x32_bf16 v[52:55], a[72:75], v[56:59], 0
v_fma_f32 v34, -v72, v114, v34
v_fma_f32 v35, -v72, v115, v35
s_waitcnt lgkmcnt(2)
v_mfma_f32_16x16x32_bf16 v[44:47], a[76:79], v[60:63], v[44:47]
buffer_load_dwordx4 v[236:239], v2, s[24:27], s98 offen offset:3072 sc1
ds_read_b128 v[56:59], v6 offset:20480
v_mfma_f32_16x16x32_bf16 v[48:51], a[80:83], v[60:63], v[48:51]
v_fma_f32 v36, -v72, v116, v36
v_fma_f32 v37, -v72, v117, v37
v_mfma_f32_16x16x32_bf16 v[52:55], a[84:87], v[60:63], v[52:55]
v_fma_f32 v38, -v72, v118, v38
v_fma_f32 v39, -v72, v119, v39
s_waitcnt lgkmcnt(2)
v_mfma_f32_16x16x32_bf16 v[44:47], a[88:91], v[64:67], v[44:47]
ds_read_b128 v[60:63], v6 offset:21504
v_mfma_f32_16x16x32_bf16 v[48:51], a[92:95], v[64:67], v[48:51]
v_fma_f32 v40, -v72, v120, v40
v_fma_f32 v41, -v72, v121, v41
v_mfma_f32_16x16x32_bf16 v[52:55], a[96:99], v[64:67], v[52:55]
s_add_u32 s98, s39, 0
buffer_load_dwordx4 a[0:3], v2, s[24:27], s98 offen offset:0 sc1
s_waitcnt lgkmcnt(2)
v_mfma_f32_16x16x32_bf16 v[44:47], a[100:103], v[68:71], v[44:47]
ds_read_b128 v[64:67], v6 offset:22528
v_mfma_f32_16x16x32_bf16 v[48:51], a[104:107], v[68:71], v[48:51]
v_fma_f32 v42, -v72, v122, v42
v_fma_f32 v43, -v72, v123, v43
v_mfma_f32_16x16x32_bf16 v[52:55], a[108:111], v[68:71], v[52:55]
v_fma_f32 v32, v32, v73, v124
v_fma_f32 v33, v33, v73, v125
s_waitcnt lgkmcnt(2)
v_mfma_f32_16x16x32_bf16 v[44:47], a[112:115], v[56:59], v[44:47]
buffer_load_dwordx4 a[4:7], v2, s[24:27], s98 offen offset:1024 sc1
ds_read_b128 v[68:71], v6 offset:23552
v_mfma_f32_16x16x32_bf16 v[48:51], a[116:119], v[56:59], v[48:51]
v_fma_f32 v34, v34, v73, v126
v_fma_f32 v35, v35, v73, v127
v_mfma_f32_16x16x32_bf16 v[52:55], a[120:123], v[56:59], v[52:55]
v_fma_f32 v36, v36, v73, v128
v_fma_f32 v37, v37, v73, v129
s_waitcnt lgkmcnt(2)
v_mfma_f32_16x16x32_bf16 v[44:47], a[124:127], v[60:63], v[44:47]
ds_read_b128 v[56:59], v6 offset:24576
v_mfma_f32_16x16x32_bf16 v[48:51], a[128:131], v[60:63], v[48:51]
buffer_load_dwordx4 a[8:11], v2, s[24:27], s98 offen offset:2048 sc1
v_mfma_f32_16x16x32_bf16 v[52:55], a[132:135], v[60:63], v[52:55]
v_fma_f32 v38, v38, v73, v130
v_fma_f32 v39, v39, v73, v131
s_waitcnt lgkmcnt(2)
v_mfma_f32_16x16x32_bf16 v[44:47], a[136:139], v[64:67], v[44:47]
ds_read_b128 v[60:63], v6 offset:25600
v_mfma_f32_16x16x32_bf16 v[48:51], a[140:143], v[64:67], v[48:51]
v_fma_f32 v40, v40, v73, v132
v_fma_f32 v41, v41, v73, v133
v_mfma_f32_16x16x32_bf16 v[52:55], a[144:147], v[64:67], v[52:55]
v_fma_f32 v42, v42, v73, v134
v_fma_f32 v43, v43, v73, v135
s_waitcnt lgkmcnt(2)
v_mfma_f32_16x16x32_bf16 v[44:47], a[148:151], v[68:71], v[44:47]
buffer_load_dwordx4 a[12:15], v2, s[24:27], s98 offen offset:3072 sc1
ds_read_b128 v[64:67], v6 offset:26624
v_mfma_f32_16x16x32_bf16 v[48:51], a[152:155], v[68:71], v[48:51]
v_exp_f32 v80, v32
v_mfma_f32_16x16x32_bf16 v[52:55], a[156:159], v[68:71], v[52:55]
v_exp_f32 v81, v33
s_waitcnt lgkmcnt(2)
v_mfma_f32_16x16x32_bf16 v[44:47], a[160:163], v[56:59], v[44:47]
ds_read_b128 v[68:71], v6 offset:27648
s_add_u32 s98, s39, 4096
buffer_load_dwordx4 a[16:19], v2, s[24:27], s98 offen offset:0 sc1
v_mfma_f32_16x16x32_bf16 v[48:51], a[164:167], v[56:59], v[48:51]
v_exp_f32 v82, v34
v_mfma_f32_16x16x32_bf16 v[52:55], a[168:171], v[56:59], v[52:55]
v_exp_f32 v83, v35
s_waitcnt lgkmcnt(2)
v_mfma_f32_16x16x32_bf16 v[44:47], a[172:175], v[60:63], v[44:47]
ds_read_b128 v[56:59], v6 offset:28672
v_mfma_f32_16x16x32_bf16 v[48:51], a[176:179], v[60:63], v[48:51]
buffer_load_dwordx4 a[20:23], v2, s[24:27], s98 offen offset:1024 sc1
v_mfma_f32_16x16x32_bf16 v[52:55], a[180:183], v[60:63], v[52:55]
v_exp_f32 v84, v36
s_waitcnt lgkmcnt(2)
v_mfma_f32_16x16x32_bf16 v[44:47], a[184:187], v[64:67], v[44:47]
ds_read_b128 v[60:63], v6 offset:29696
v_mfma_f32_16x16x32_bf16 v[48:51], a[188:191], v[64:67], v[48:51]
v_exp_f32 v85, v37
v_mfma_f32_16x16x32_bf16 v[52:55], a[192:195], v[64:67], v[52:55]
v_exp_f32 v86, v38
s_waitcnt lgkmcnt(2)
v_mfma_f32_16x16x32_bf16 v[44:47], a[196:199], v[68:71], v[44:47]
buffer_load_dwordx4 a[24:27], v2, s[24:27], s98 offen offset:2048 sc1
ds_read_b128 v[64:67], v6 offset:30720
v_mfma_f32_16x16x32_bf16 v[48:51], a[200:203], v[68:71], v[48:51]
v_exp_f32 v87, v39
v_mfma_f32_16x16x32_bf16 v[52:55], a[204:207], v[68:71], v[52:55]
v_exp_f32 v88, v40
s_waitcnt lgkmcnt(2)
v_mfma_f32_16x16x32_bf16 v[44:47], a[208:211], v[56:59], v[44:47]
ds_read_b128 v[68:71], v6 offset:31744
buffer_load_dwordx4 a[28:31], v2, s[24:27], s98 offen offset:3072 sc1
v_mfma_f32_16x16x32_bf16 v[48:51], a[212:215], v[56:59], v[48:51]
v_exp_f32 v89, v41
v_mfma_f32_16x16x32_bf16 v[52:55], a[216:219], v[56:59], v[52:55]
v_exp_f32 v90, v42
s_waitcnt lgkmcnt(2)
v_mfma_f32_16x16x32_bf16 v[44:47], a[220:223], v[60:63], v[44:47]
v_exp_f32 v91, v43
v_mfma_f32_16x16x32_bf16 v[48:51], a[224:227], v[60:63], v[48:51]
v_add_f32 v80, 1.0, v80
v_add_f32 v81, 1.0, v81
v_mfma_f32_16x16x32_bf16 v[52:55], a[228:231], v[60:63], v[52:55]
v_add_f32 v82, 1.0, v82
v_add_f32 v83, 1.0, v83
s_waitcnt lgkmcnt(1)
v_mfma_f32_16x16x32_bf16 v[44:47], a[232:235], v[64:67], v[44:47]
s_add_u32 s98, s39, 8192
buffer_load_dwordx4 a[32:35], v2, s[24:27], s98 offen offset:0 sc1
v_mfma_f32_16x16x32_bf16 v[48:51], a[236:239], v[64:67], v[48:51]
v_add_f32 v84, 1.0, v84
v_add_f32 v85, 1.0, v85
v_mfma_f32_16x16x32_bf16 v[52:55], a[240:243], v[64:67], v[52:55]
v_add_f32 v86, 1.0, v86
v_add_f32 v87, 1.0, v87
s_waitcnt lgkmcnt(0)
v_mfma_f32_16x16x32_bf16 v[44:47], a[244:247], v[68:71], v[44:47]
v_add_f32 v88, 1.0, v88
v_add_f32 v89, 1.0, v89
v_mfma_f32_16x16x32_bf16 v[48:51], a[248:251], v[68:71], v[48:51]
buffer_load_dwordx4 a[36:39], v2, s[24:27], s98 offen offset:1024 sc1
v_mfma_f32_16x16x32_bf16 v[52:55], a[252:255], v[68:71], v[52:55]
v_add_f32 v90, 1.0, v90
v_add_f32 v91, 1.0, v91
v_rcp_f32 v80, v80
v_rcp_f32 v81, v81
v_rcp_f32 v82, v82
v_rcp_f32 v83, v83
v_rcp_f32 v84, v84
v_rcp_f32 v85, v85
v_rcp_f32 v86, v86
v_rcp_f32 v87, v87
v_rcp_f32 v88, v88
v_rcp_f32 v89, v89
v_rcp_f32 v90, v90
v_rcp_f32 v91, v91
v_mul_f32 v80, v80, v32
v_mul_f32 v81, v81, v33
v_mul_f32 v82, v82, v34
v_mul_f32 v83, v83, v35
v_mul_f32 v84, v84, v36
v_mul_f32 v85, v85, v37
v_mul_f32 v86, v86, v38
v_mul_f32 v87, v87, v39
v_mul_f32 v88, v88, v40
v_mul_f32 v89, v89, v41
v_mul_f32 v90, v90, v42
v_mul_f32 v91, v91, v43
v_cvt_pk_bf16_f32 v96, v80, v81
v_cvt_pk_bf16_f32 v97, v82, v83
v_cvt_pk_bf16_f32 v100, v84, v85
v_cvt_pk_bf16_f32 v101, v86, v87
v_cvt_pk_bf16_f32 v104, v88, v89
v_cvt_pk_bf16_f32 v105, v90, v91
buffer_load_dwordx4 a[40:43], v2, s[24:27], s98 offen offset:2048 sc1
v_pk_fma_f32 v[44:45], v[74:75], v[112:113], v[44:45] op_sel_hi:[0,1,1] neg_lo:[1,0,0] neg_hi:[1,0,0]
v_pk_fma_f32 v[46:47], v[74:75], v[114:115], v[46:47] op_sel_hi:[0,1,1] neg_lo:[1,0,0] neg_hi:[1,0,0]
v_pk_fma_f32 v[44:45], v[44:45], v[74:75], v[124:125] op_sel:[0,1,0] op_sel_hi:[1,1,1]
v_pk_fma_f32 v[46:47], v[46:47], v[74:75], v[126:127] op_sel:[0,1,0] op_sel_hi:[1,1,1]
v_exp_f32 v80, v44
v_exp_f32 v81, v45
v_exp_f32 v82, v46
buffer_load_dwordx4 a[44:47], v2, s[24:27], s98 offen offset:3072 sc1
v_exp_f32 v83, v47
v_pk_add_f32 v[80:81], v[80:81], 1.0 op_sel_hi:[1,0]
v_pk_add_f32 v[82:83], v[82:83], 1.0 op_sel_hi:[1,0]
v_rcp_f32 v80, v80
v_rcp_f32 v81, v81
v_rcp_f32 v82, v82
s_add_u32 s98, s39, 12288
buffer_load_dwordx4 a[48:51], v2, s[24:27], s98 offen offset:0 sc1
v_rcp_f32 v83, v83
v_pk_mul_f32 v[80:81], v[80:81], v[44:45]
v_pk_mul_f32 v[82:83], v[82:83], v[46:47]
v_cvt_pk_bf16_f32 v98, v80, v81
v_cvt_pk_bf16_f32 v99, v82, v83
v_pk_fma_f32 v[48:49], v[74:75], v[116:117], v[48:49] op_sel_hi:[0,1,1] neg_lo:[1,0,0] neg_hi:[1,0,0]
v_pk_fma_f32 v[50:51], v[74:75], v[118:119], v[50:51] op_sel_hi:[0,1,1] neg_lo:[1,0,0] neg_hi:[1,0,0]
v_pk_fma_f32 v[48:49], v[48:49], v[74:75], v[128:129] op_sel:[0,1,0] op_sel_hi:[1,1,1]
v_pk_fma_f32 v[50:51], v[50:51], v[74:75], v[130:131] op_sel:[0,1,0] op_sel_hi:[1,1,1]
buffer_load_dwordx4 a[52:55], v2, s[24:27], s98 offen offset:1024 sc1
v_exp_f32 v84, v48
v_exp_f32 v85, v49
v_exp_f32 v86, v50
v_exp_f32 v87, v51
v_pk_add_f32 v[84:85], v[84:85], 1.0 op_sel_hi:[1,0]
v_pk_add_f32 v[86:87], v[86:87], 1.0 op_sel_hi:[1,0]
buffer_load_dwordx4 a[56:59], v2, s[24:27], s98 offen offset:2048 sc1
v_rcp_f32 v84, v84
v_rcp_f32 v85, v85
v_rcp_f32 v86, v86
v_rcp_f32 v87, v87
v_pk_mul_f32 v[84:85], v[84:85], v[48:49]
v_pk_mul_f32 v[86:87], v[86:87], v[50:51]
v_cvt_pk_bf16_f32 v102, v84, v85
v_cvt_pk_bf16_f32 v103, v86, v87
v_permlane16_swap_b32 v96, v98
v_permlane16_swap_b32 v97, v99
buffer_store_dwordx4 v[96:99], v2, s[24:27], s16 offen offset:0 sc1
v_pk_fma_f32 v[52:53], v[74:75], v[120:121], v[52:53] op_sel_hi:[0,1,1] neg_lo:[1,0,0] neg_hi:[1,0,0]
v_pk_fma_f32 v[54:55], v[74:75], v[122:123], v[54:55] op_sel_hi:[0,1,1] neg_lo:[1,0,0] neg_hi:[1,0,0]
v_pk_fma_f32 v[52:53], v[52:53], v[74:75], v[132:133] op_sel:[0,1,0] op_sel_hi:[1,1,1]
v_pk_fma_f32 v[54:55], v[54:55], v[74:75], v[134:135] op_sel:[0,1,0] op_sel_hi:[1,1,1]
v_exp_f32 v88, v52
v_exp_f32 v89, v53
v_exp_f32 v90, v54
v_exp_f32 v91, v55
v_pk_add_f32 v[88:89], v[88:89], 1.0 op_sel_hi:[1,0]
v_pk_add_f32 v[90:91], v[90:91], 1.0 op_sel_hi:[1,0]
v_rcp_f32 v88, v88
v_rcp_f32 v89, v89
v_rcp_f32 v90, v90
v_rcp_f32 v91, v91
v_pk_mul_f32 v[88:89], v[88:89], v[52:53]
v_pk_mul_f32 v[90:91], v[90:91], v[54:55]
v_cvt_pk_bf16_f32 v106, v88, v89
v_cvt_pk_bf16_f32 v107, v90, v91
v_permlane16_swap_b32 v100, v102
v_permlane16_swap_b32 v101, v103
buffer_store_dwordx4 v[100:103], v2, s[24:27], s17 offen offset:1024 sc1
v_permlane16_swap_b32 v104, v106
v_permlane16_swap_b32 v105, v107
buffer_store_dwordx4 v[104:107], v2, s[24:27], s17 offen offset:2048 sc1
s_add_u32 s16, s16, 90112
s_add_u32 s17, s17, 90112
s_cmp_lg_u32 s73, 0
s_cbranch_scc1 L_nost_2059b
s_waitcnt vmcnt(31)
v_cmp_ne_u32 vcc, s72, v242
s_waitcnt vmcnt(30)
v_cmp_ne_u32 s[86:87], s72, v246
s_nop 0
s_or_b64 vcc, vcc, s[86:87]
s_waitcnt vmcnt(29)
v_cmp_ne_u32 s[86:87], s72, v250
s_nop 0
s_or_b64 vcc, vcc, s[86:87]
s_waitcnt vmcnt(28)
v_cmp_ne_u32 s[86:87], s72, v254
s_nop 0
s_or_b64 vcc, vcc, s[86:87]
s_cbranch_vccnz L_poll_2060
L_ret_2061:
v_pk_add_f32 v[240:241], v[240:241], v[244:245]
v_pk_add_f32 v[248:249], v[248:249], v[252:253]
v_pk_add_f32 v[240:241], v[240:241], v[248:249]
s_nop 1
v_permlane32_swap_b32 v240, v241
v_add_f32 v240, v240, v241
v_mov_b32 v241, v240
s_nop 1
v_permlane32_swap_b32 v240, v241
s_mov_b32 s78, 0x3b000000
v_mul_f32 v240, s78, v240
v_mul_f32 v242, v240, v240
v_fma_f32 v241, v241, s78, -v242
v_max_f32 v241, 0, v241
v_add_f32 v241, 0x3727c5ac, v241
v_rsq_f32 v241, v241
s_nop 0
v_mul_f32 v241, 0xbfb8aa3b, v241
ds_write_b64 v9, v[240:241] offset:7424
s_waitcnt lgkmcnt(0)
L_nost_2059b:
s_waitcnt vmcnt(20)
s_barrier
ds_read_b64 v[76:77], v7 offset:7424
ds_read_b64 v[78:79], v7 offset:7552
ds_read_b128 v[56:59], v6 offset:32768
ds_read_b128 v[60:63], v6 offset:33792
buffer_load_dwordx4 a[60:63], v2, s[24:27], s98 offen offset:3072 sc1
ds_read_b128 v[64:67], v6 offset:34816
s_waitcnt lgkmcnt(2)
v_mfma_f32_16x16x32_bf16 v[32:35], a[64:67], v[56:59], 0
s_add_u32 s98, s39, 16384
buffer_load_dwordx4 v[144:147], v2, s[24:27], s98 offen offset:0 sc1
ds_read_b128 v[68:71], v6 offset:35840
v_mfma_f32_16x16x32_bf16 v[36:39], a[68:71], v[56:59], 0
v_mfma_f32_16x16x32_bf16 v[40:43], a[72:75], v[56:59], 0
s_waitcnt lgkmcnt(2)
v_mfma_f32_16x16x32_bf16 v[32:35], a[76:79], v[60:63], v[32:35]
buffer_load_dwordx4 v[148:151], v2, s[24:27], s98 offen offset:1024 sc1
ds_read_b128 v[56:59], v6 offset:36864
v_mfma_f32_16x16x32_bf16 v[36:39], a[80:83], v[60:63], v[36:39]
v_mfma_f32_16x16x32_bf16 v[40:43], a[84:87], v[60:63], v[40:43]
s_waitcnt lgkmcnt(2)
v_mfma_f32_16x16x32_bf16 v[32:35], a[88:91], v[64:67], v[32:35]
ds_read_b128 v[60:63], v6 offset:37888
buffer_load_dwordx4 v[152:155], v2, s[24:27], s98 offen offset:2048 sc1
v_mfma_f32_16x16x32_bf16 v[36:39], a[92:95], v[64:67], v[36:39]
v_mfma_f32_16x16x32_bf16 v[40:43], a[96:99], v[64:67], v[40:43]
s_waitcnt lgkmcnt(2)
v_mfma_f32_16x16x32_bf16 v[32:35], a[100:103], v[68:71], v[32:35]
ds_read_b128 v[64:67], v6 offset:38912
v_mfma_f32_16x16x32_bf16 v[36:39], a[104:107], v[68:71], v[36:39]
buffer_load_dwordx4 v[156:159], v2, s[24:27], s98 offen offset:3072 sc1
v_mfma_f32_16x16x32_bf16 v[40:43], a[108:111], v[68:71], v[40:43]
s_waitcnt lgkmcnt(2)
v_mfma_f32_16x16x32_bf16 v[32:35], a[112:115], v[56:59], v[32:35]
ds_read_b128 v[68:71], v6 offset:39936
v_mfma_f32_16x16x32_bf16 v[36:39], a[116:119], v[56:59], v[36:39]
v_mfma_f32_16x16x32_bf16 v[40:43], a[120:123], v[56:59], v[40:43]
s_waitcnt lgkmcnt(2)
v_mfma_f32_16x16x32_bf16 v[32:35], a[124:127], v[60:63], v[32:35]
s_add_u32 s98, s39, 20480
buffer_load_dwordx4 v[160:163], v2, s[24:27], s98 offen offset:0 sc1
ds_read_b128 v[56:59], v6 offset:40960
v_mfma_f32_16x16x32_bf16 v[36:39], a[128:131], v[60:63], v[36:39]
v_mfma_f32_16x16x32_bf16 v[40:43], a[132:135], v[60:63], v[40:43]
s_waitcnt lgkmcnt(2)
v_mfma_f32_16x16x32_bf16 v[32:35], a[136:139], v[64:67], v[32:35]
ds_read_b128 v[60:63], v6 offset:41984
buffer_load_dwordx4 v[164:167], v2, s[24:27], s98 offen offset:1024 sc1
v_mfma_f32_16x16x32_bf16 v[36:39], a[140:143], v[64:67], v[36:39]
v_mfma_f32_16x16x32_bf16 v[40:43], a[144:147], v[64:67], v[40:43]
s_waitcnt lgkmcnt(2)
v_mfma_f32_16x16x32_bf16 v[32:35], a[148:151], v[68:71], v[32:35]
ds_read_b128 v[64:67], v6 offset:43008
v_mfma_f32_16x16x32_bf16 v[36:39], a[152:155], v[68:71], v[36:39]
v_mfma_f32_16x16x32_bf16 v[40:43], a[156:159], v[68:71], v[40:43]
s_waitcnt lgkmcnt(2)
v_mfma_f32_16x16x32_bf16 v[32:35], a[160:163], v[56:59], v[32:35]
ds_read_b128 v[68:71], v6 offset:44032
v_mfma_f32_16x16x32_bf16 v[36:39], a[164:167], v[56:59], v[36:39]
v_mfma_f32_16x16x32_bf16 v[40:43], a[168:171], v[56:59], v[40:43]
s_waitcnt lgkmcnt(2)
v_mfma_f32_16x16x32_bf16 v[32:35], a[172:175], v[60:63], v[32:35]
ds_read_b128 v[56:59], v6 offset:45056
v_mfma_f32_16x16x32_bf16 v[36:39], a[176:179], v[60:63], v[36:39]
v_mfma_f32_16x16x32_bf16 v[40:43], a[180:183], v[60:63], v[40:43]
s_waitcnt lgkmcnt(2)
v_mfma_f32_16x16x32_bf16 v[32:35], a[184:187], v[64:67], v[32:35]
ds_read_b128 v[60:63], v6 offset:46080
buffer_load_dwordx4 v[168:171], v2, s[24:27], s98 offen offset:2048 sc1
v_mfma_f32_16x16x32_bf16 v[36:39], a[188:191], v[64:67], v[36:39]
v_mfma_f32_16x16x32_bf16 v[40:43], a[192:195], v[64:67], v[40:43]
s_waitcnt lgkmcnt(2)
v_mfma_f32_16x16x32_bf16 v[32:35], a[196:199], v[68:71], v[32:35]
ds_read_b128 v[64:67], v6 offset:47104
v_mfma_f32_16x16x32_bf16 v[36:39], a[200:203], v[68:71], v[36:39]
v_mfma_f32_16x16x32_bf16 v[40:43], a[204:207], v[68:71], v[40:43]
s_waitcnt lgkmcnt(2)
v_mfma_f32_16x16x32_bf16 v[32:35], a[208:211], v[56:59], v[32:35]
ds_read_b128 v[68:71], v6 offset:48128
v_mfma_f32_16x16x32_bf16 v[36:39], a[212:215], v[56:59], v[36:39]
v_mfma_f32_16x16x32_bf16 v[40:43], a[216:219], v[56:59], v[40:43]
s_waitcnt lgkmcnt(2)
v_mfma_f32_16x16x32_bf16 v[32:35], a[220:223], v[60:63], v[32:35]
v_mfma_f32_16x16x32_bf16 v[36:39], a[224:227], v[60:63], v[36:39]
v_mfma_f32_16x16x32_bf16 v[40:43], a[228:231], v[60:63], v[40:43]
s_waitcnt lgkmcnt(1)
v_mfma_f32_16x16x32_bf16 v[32:35], a[232:235], v[64:67], v[32:35]
v_mfma_f32_16x16x32_bf16 v[36:39], a[236:239], v[64:67], v[36:39]
v_mfma_f32_16x16x32_bf16 v[40:43], a[240:243], v[64:67], v[40:43]
s_waitcnt lgkmcnt(0)
v_mfma_f32_16x16x32_bf16 v[32:35], a[244:247], v[68:71], v[32:35]
v_mfma_f32_16x16x32_bf16 v[36:39], a[248:251], v[68:71], v[36:39]
buffer_load_dwordx4 v[172:175], v2, s[24:27], s98 offen offset:3072 sc1
v_mfma_f32_16x16x32_bf16 v[40:43], a[252:255], v[68:71], v[40:43]
ds_read_b128 v[56:59], v6 offset:49152
ds_read_b128 v[60:63], v6 offset:50176
ds_read_b128 v[64:67], v6 offset:51200
s_waitcnt lgkmcnt(2)
v_mfma_f32_16x16x32_bf16 v[44:47], a[64:67], v[56:59], 0
ds_read_b128 v[68:71], v6 offset:52224
v_mfma_f32_16x16x32_bf16 v[48:51], a[68:71], v[56:59], 0
v_fma_f32 v32, -v76, v112, v32
v_fma_f32 v33, -v76, v113, v33
v_mfma_f32_16x16x32_bf16 v[52:55], a[72:75], v[56:59], 0
v_fma_f32 v34, -v76, v114, v34
v_fma_f32 v35, -v76, v115, v35
s_waitcnt lgkmcnt(2)
v_mfma_f32_16x16x32_bf16 v[44:47], a[76:79], v[60:63], v[44:47]
ds_read_b128 v[56:59], v6 offset:53248
v_mfma_f32_16x16x32_bf16 v[48:51], a[80:83], v[60:63], v[48:51]
v_fma_f32 v36, -v76, v116, v36
v_fma_f32 v37, -v76, v117, v37
v_mfma_f32_16x16x32_bf16 v[52:55], a[84:87], v[60:63], v[52:55]
v_fma_f32 v38, -v76, v118, v38
v_fma_f32 v39, -v76, v119, v39
s_waitcnt lgkmcnt(2)
v_mfma_f32_16x16x32_bf16 v[44:47], a[88:91], v[64:67], v[44:47]
ds_read_b128 v[60:63], v6 offset:54272
v_mfma_f32_16x16x32_bf16 v[48:51], a[92:95], v[64:67], v[48:51]
s_waitcnt vmcnt(9)
buffer_store_dword v15, v14, s[24:27], s19 offen offset:512
v_mfma_f32_16x16x32_bf16 v[52:55], a[96:99], v[64:67], v[52:55]
v_fma_f32 v40, -v76, v120, v40
v_fma_f32 v41, -v76, v121, v41
s_waitcnt lgkmcnt(2)
v_mfma_f32_16x16x32_bf16 v[44:47], a[100:103], v[68:71], v[44:47]
ds_read_b128 v[64:67], v6 offset:55296
v_mfma_f32_16x16x32_bf16 v[48:51], a[104:107], v[68:71], v[48:51]
v_fma_f32 v42, -v76, v122, v42
v_fma_f32 v43, -v76, v123, v43
v_mfma_f32_16x16x32_bf16 v[52:55], a[108:111], v[68:71], v[52:55]
v_fma_f32 v32, v32, v77, v124
v_fma_f32 v33, v33, v77, v125
s_waitcnt lgkmcnt(2)
v_mfma_f32_16x16x32_bf16 v[44:47], a[112:115], v[56:59], v[44:47]
s_add_u32 s98, s39, 40960
s_cmp_eq_u32 s73, 3
s_cselect_b32 s98, 0x2000000, s98
buffer_load_dwordx4 v[240:243], v2, s[24:27], s98 offen offset:0 sc1
ds_read_b128 v[68:71], v6 offset:56320
v_mfma_f32_16x16x32_bf16 v[48:51], a[116:119], v[56:59], v[48:51]
v_fma_f32 v34, v34, v77, v126
v_fma_f32 v35, v35, v77, v127
v_mfma_f32_16x16x32_bf16 v[52:55], a[120:123], v[56:59], v[52:55]
v_fma_f32 v36, v36, v77, v128
v_fma_f32 v37, v37, v77, v129
s_waitcnt lgkmcnt(2)
v_mfma_f32_16x16x32_bf16 v[44:47], a[124:127], v[60:63], v[44:47]
buffer_load_dwordx4 v[244:247], v2, s[24:27], s98 offen offset:1024 sc1
ds_read_b128 v[56:59], v6 offset:57344
v_mfma_f32_16x16x32_bf16 v[48:51], a[128:131], v[60:63], v[48:51]
v_fma_f32 v38, v38, v77, v130
v_fma_f32 v39, v39, v77, v131
v_mfma_f32_16x16x32_bf16 v[52:55], a[132:135], v[60:63], v[52:55]
v_fma_f32 v40, v40, v77, v132
v_fma_f32 v41, v41, v77, v133
s_waitcnt lgkmcnt(2)
v_mfma_f32_16x16x32_bf16 v[44:47], a[136:139], v[64:67], v[44:47]
ds_read_b128 v[60:63], v6 offset:58368
buffer_load_dwordx4 v[248:251], v2, s[24:27], s98 offen offset:2048 sc1
v_mfma_f32_16x16x32_bf16 v[48:51], a[140:143], v[64:67], v[48:51]
v_fma_f32 v42, v42, v77, v134
v_fma_f32 v43, v43, v77, v135
v_mfma_f32_16x16x32_bf16 v[52:55], a[144:147], v[64:67], v[52:55]
v_exp_f32 v80, v32
s_waitcnt lgkmcnt(2)
v_mfma_f32_16x16x32_bf16 v[44:47], a[148:151], v[68:71], v[44:47]
ds_read_b128 v[64:67], v6 offset:59392
v_mfma_f32_16x16x32_bf16 v[48:51], a[152:155], v[68:71], v[48:51]
buffer_load_dwordx4 v[252:255], v2, s[24:27], s98 offen offset:3072 sc1
v_mfma_f32_16x16x32_bf16 v[52:55], a[156:159], v[68:71], v[52:55]
v_exp_f32 v81, v33
s_waitcnt lgkmcnt(2)
v_mfma_f32_16x16x32_bf16 v[44:47], a[160:163], v[56:59], v[44:47]
ds_read_b128 v[68:71], v6 offset:60416
v_mfma_f32_16x16x32_bf16 v[48:51], a[164:167], v[56:59], v[48:51]
v_exp_f32 v82, v34
v_mfma_f32_16x16x32_bf16 v[52:55], a[168:171], v[56:59], v[52:55]
v_exp_f32 v83, v35
s_waitcnt lgkmcnt(2)
v_mfma_f32_16x16x32_bf16 v[44:47], a[172:175], v[60:63], v[44:47]
ds_read_b128 v[56:59], v6 offset:61440
buffer_load_dword v8, v10, s[24:27], s21 offen offset:512 sc1
v_mfma_f32_16x16x32_bf16 v[48:51], a[176:179], v[60:63], v[48:51]
v_exp_f32 v84, v36
v_mfma_f32_16x16x32_bf16 v[52:55], a[180:183], v[60:63], v[52:55]
v_exp_f32 v85, v37
s_waitcnt lgkmcnt(2)
v_mfma_f32_16x16x32_bf16 v[44:47], a[184:187], v[64:67], v[44:47]
ds_read_b128 v[60:63], v6 offset:62464
v_mfma_f32_16x16x32_bf16 v[48:51], a[188:191], v[64:67], v[48:51]
v_exp_f32 v86, v38
v_mfma_f32_16x16x32_bf16 v[52:55], a[192:195], v[64:67], v[52:55]
v_exp_f32 v87, v39
s_waitcnt lgkmcnt(2)
v_mfma_f32_16x16x32_bf16 v[44:47], a[196:199], v[68:71], v[44:47]
ds_read_b128 v[64:67], v6 offset:63488
v_mfma_f32_16x16x32_bf16 v[48:51], a[200:203], v[68:71], v[48:51]
v_exp_f32 v88, v40
v_mfma_f32_16x16x32_bf16 v[52:55], a[204:207], v[68:71], v[52:55]
v_exp_f32 v89, v41
s_waitcnt lgkmcnt(2)
v_mfma_f32_16x16x32_bf16 v[44:47], a[208:211], v[56:59], v[44:47]
ds_read_b128 v[68:71], v6 offset:64512
v_mfma_f32_16x16x32_bf16 v[48:51], a[212:215], v[56:59], v[48:51]
v_exp_f32 v90, v42
v_mfma_f32_16x16x32_bf16 v[52:55], a[216:219], v[56:59], v[52:55]
v_exp_f32 v91, v43
s_waitcnt lgkmcnt(2)
v_mfma_f32_16x16x32_bf16 v[44:47], a[220:223], v[60:63], v[44:47]
v_add_f32 v80, 1.0, v80
v_add_f32 v81, 1.0, v81
v_mfma_f32_16x16x32_bf16 v[48:51], a[224:227], v[60:63], v[48:51]
v_add_f32 v82, 1.0, v82
v_add_f32 v83, 1.0, v83
v_mfma_f32_16x16x32_bf16 v[52:55], a[228:231], v[60:63], v[52:55]
v_add_f32 v84, 1.0, v84
v_add_f32 v85, 1.0, v85
s_waitcnt lgkmcnt(1)
v_mfma_f32_16x16x32_bf16 v[44:47], a[232:235], v[64:67], v[44:47]
v_add_f32 v86, 1.0, v86
v_add_f32 v87, 1.0, v87
v_mfma_f32_16x16x32_bf16 v[48:51], a[236:239], v[64:67], v[48:51]
v_add_f32 v88, 1.0, v88
v_add_f32 v89, 1.0, v89
v_mfma_f32_16x16x32_bf16 v[52:55], a[240:243], v[64:67], v[52:55]
v_add_f32 v90, 1.0, v90
v_add_f32 v91, 1.0, v91
s_waitcnt lgkmcnt(0)
v_mfma_f32_16x16x32_bf16 v[44:47], a[244:247], v[68:71], v[44:47]
v_rcp_f32 v80, v80
v_mfma_f32_16x16x32_bf16 v[48:51], a[248:251], v[68:71], v[48:51]
v_rcp_f32 v81, v81
v_mfma_f32_16x16x32_bf16 v[52:55], a[252:255], v[68:71], v[52:55]
v_rcp_f32 v82, v82
v_rcp_f32 v83, v83
v_rcp_f32 v84, v84
v_rcp_f32 v85, v85
v_rcp_f32 v86, v86
v_rcp_f32 v87, v87
v_rcp_f32 v88, v88
v_rcp_f32 v89, v89
v_rcp_f32 v90, v90
v_rcp_f32 v91, v91
v_mul_f32 v80, v80, v32
v_mul_f32 v81, v81, v33
v_mul_f32 v82, v82, v34
v_mul_f32 v83, v83, v35
v_mul_f32 v84, v84, v36
v_mul_f32 v85, v85, v37
v_mul_f32 v86, v86, v38
v_mul_f32 v87, v87, v39
v_mul_f32 v88, v88, v40
v_mul_f32 v89, v89, v41
v_mul_f32 v90, v90, v42
v_mul_f32 v91, v91, v43
v_cvt_pk_bf16_f32 v96, v80, v81
v_cvt_pk_bf16_f32 v97, v82, v83
v_cvt_pk_bf16_f32 v100, v84, v85
v_cvt_pk_bf16_f32 v101, v86, v87
v_cvt_pk_bf16_f32 v104, v88, v89
v_cvt_pk_bf16_f32 v105, v90, v91
v_pk_fma_f32 v[44:45], v[78:79], v[112:113], v[44:45] op_sel_hi:[0,1,1] neg_lo:[1,0,0] neg_hi:[1,0,0]
v_pk_fma_f32 v[46:47], v[78:79], v[114:115], v[46:47] op_sel_hi:[0,1,1] neg_lo:[1,0,0] neg_hi:[1,0,0]
v_pk_fma_f32 v[44:45], v[44:45], v[78:79], v[124:125] op_sel:[0,1,0] op_sel_hi:[1,1,1]
v_pk_fma_f32 v[46:47], v[46:47], v[78:79], v[126:127] op_sel:[0,1,0] op_sel_hi:[1,1,1]
v_exp_f32 v80, v44
v_exp_f32 v81, v45
v_exp_f32 v82, v46
v_exp_f32 v83, v47
v_pk_add_f32 v[80:81], v[80:81], 1.0 op_sel_hi:[1,0]
v_pk_add_f32 v[82:83], v[82:83], 1.0 op_sel_hi:[1,0]
v_rcp_f32 v80, v80
v_rcp_f32 v81, v81
v_rcp_f32 v82, v82
v_rcp_f32 v83, v83
v_pk_mul_f32 v[80:81], v[80:81], v[44:45]
v_pk_mul_f32 v[82:83], v[82:83], v[46:47]
v_cvt_pk_bf16_f32 v98, v80, v81
v_cvt_pk_bf16_f32 v99, v82, v83
v_pk_fma_f32 v[48:49], v[78:79], v[116:117], v[48:49] op_sel_hi:[0,1,1] neg_lo:[1,0,0] neg_hi:[1,0,0]
v_pk_fma_f32 v[50:51], v[78:79], v[118:119], v[50:51] op_sel_hi:[0,1,1] neg_lo:[1,0,0] neg_hi:[1,0,0]
v_pk_fma_f32 v[48:49], v[48:49], v[78:79], v[128:129] op_sel:[0,1,0] op_sel_hi:[1,1,1]
v_pk_fma_f32 v[50:51], v[50:51], v[78:79], v[130:131] op_sel:[0,1,0] op_sel_hi:[1,1,1]
v_exp_f32 v84, v48
v_exp_f32 v85, v49
v_exp_f32 v86, v50
v_exp_f32 v87, v51
v_pk_add_f32 v[84:85], v[84:85], 1.0 op_sel_hi:[1,0]
v_pk_add_f32 v[86:87], v[86:87], 1.0 op_sel_hi:[1,0]
v_rcp_f32 v84, v84
v_rcp_f32 v85, v85
v_rcp_f32 v86, v86
v_rcp_f32 v87, v87
v_pk_mul_f32 v[84:85], v[84:85], v[48:49]
v_pk_mul_f32 v[86:87], v[86:87], v[50:51]
v_cvt_pk_bf16_f32 v102, v84, v85
v_cvt_pk_bf16_f32 v103, v86, v87
v_permlane16_swap_b32 v96, v98
v_permlane16_swap_b32 v97, v99
buffer_store_dwordx4 v[96:99], v2, s[24:27], s16 offen offset:0 sc1
v_pk_fma_f32 v[52:53], v[78:79], v[120:121], v[52:53] op_sel_hi:[0,1,1] neg_lo:[1,0,0] neg_hi:[1,0,0]
v_pk_fma_f32 v[54:55], v[78:79], v[122:123], v[54:55] op_sel_hi:[0,1,1] neg_lo:[1,0,0] neg_hi:[1,0,0]
v_pk_fma_f32 v[52:53], v[52:53], v[78:79], v[132:133] op_sel:[0,1,0] op_sel_hi:[1,1,1]
v_pk_fma_f32 v[54:55], v[54:55], v[78:79], v[134:135] op_sel:[0,1,0] op_sel_hi:[1,1,1]
v_exp_f32 v88, v52
v_exp_f32 v89, v53
s_waitcnt vmcnt(1)
v_cmp_ne_u32 vcc, s72, v8
s_nop 0
s_cbranch_vccnz L_poll_2064
L_ret_2065:
s_add_u32 s101, s18, 0
s_add_u32 m0, s35, 73728
s_nop 0
buffer_load_dwordx4 v2, s[24:27], s101 offen offset:0 sc1 lds
v_exp_f32 v90, v54
v_exp_f32 v91, v55
v_pk_add_f32 v[88:89], v[88:89], 1.0 op_sel_hi:[1,0]
v_pk_add_f32 v[90:91], v[90:91], 1.0 op_sel_hi:[1,0]
v_rcp_f32 v88, v88
v_rcp_f32 v89, v89
buffer_load_dwordx4 v2, s[24:27], s101 offen offset:1024 sc1 lds
v_rcp_f32 v90, v90
v_rcp_f32 v91, v91
v_pk_mul_f32 v[88:89], v[88:89], v[52:53]
v_pk_mul_f32 v[90:91], v[90:91], v[54:55]
v_cvt_pk_bf16_f32 v106, v88, v89
v_cvt_pk_bf16_f32 v107, v90, v91
v_permlane16_swap_b32 v100, v102
v_permlane16_swap_b32 v101, v103
buffer_load_dwordx4 v2, s[24:27], s101 offen offset:2048 sc1 lds
buffer_store_dwordx4 v[100:103], v2, s[24:27], s17 offen offset:1024 sc1
v_permlane16_swap_b32 v104, v106
v_permlane16_swap_b32 v105, v107
buffer_store_dwordx4 v[104:107], v2, s[24:27], s17 offen offset:2048 sc1
s_add_u32 s99, s35, 73728
v_add_u32 v6, s99, v2
buffer_load_dwordx4 v2, s[24:27], s101 offen offset:3072 sc1 lds
s_add_u32 s101, s18, 4096
s_add_u32 m0, s35, 77824
s_nop 0
buffer_load_dwordx4 v2, s[24:27], s101 offen offset:0 sc1 lds
buffer_load_dwordx4 v2, s[24:27], s101 offen offset:1024 sc1 lds
buffer_load_dwordx4 v2, s[24:27], s101 offen offset:2048 sc1 lds
buffer_load_dwordx4 v2, s[24:27], s101 offen offset:3072 sc1 lds
s_add_u32 s101, s18, 8192
s_add_u32 m0, s35, 81920
s_nop 0
buffer_load_dwordx4 v2, s[24:27], s101 offen offset:0 sc1 lds
buffer_load_dwordx4 v2, s[24:27], s101 offen offset:1024 sc1 lds
buffer_load_dwordx4 v2, s[24:27], s101 offen offset:2048 sc1 lds
buffer_load_dwordx4 v2, s[24:27], s101 offen offset:3072 sc1 lds
s_waitcnt vmcnt(9)
buffer_store_dword v15, v14, s[24:27], s19 offen offset:640
s_waitcnt vmcnt(9)
s_add_u32 s101, s18, 12288
s_add_u32 m0, s35, 86016
s_nop 0
buffer_load_dwordx4 v2, s[24:27], s101 offen offset:0 sc1 lds
ds_read_b128 a[64:67], v6 offset:0
ds_read_b128 a[68:71], v6 offset:1024
ds_read_b128 a[72:75], v6 offset:2048
s_waitcnt lgkmcnt(2)
v_mfma_f32_32x32x16_bf16 v[32:47], a[0:3], a[64:67], 0
buffer_load_dwordx4 v2, s[24:27], s101 offen offset:1024 sc1 lds
v_add_u32 v108, 0xfffe0000, v108
v_add_u32 v109, 0xfffe0000, v109
v_add_u32 v110, 0xfffe0000, v110
v_add_u32 v111, 0xfffe0000, v111
v_mfma_f32_32x32x16_bf16 v[48:63], a[4:7], a[64:67], 0
ds_read_b128 a[76:79], v6 offset:3072
ds_read_b64 v[80:81], v12 offset:5120
ds_read_b64 v[82:83], v12 offset:5136
s_waitcnt lgkmcnt(1)
v_lshlrev_b32 v64, 16, v80
v_mfma_f32_32x32x16_bf16 v[32:47], a[8:11], a[68:71], v[32:47]
buffer_load_dwordx4 v2, s[24:27], s101 offen offset:2048 sc1 lds
v_and_b32 v65, s85, v80
v_lshlrev_b32 v66, 16, v81
v_and_b32 v67, s85, v81
s_waitcnt lgkmcnt(0)
v_lshlrev_b32 v68, 16, v82
v_and_b32 v69, s85, v82
v_mfma_f32_32x32x16_bf16 v[48:63], a[12:15], a[68:71], v[48:63]
buffer_load_dwordx4 v2, s[24:27], s101 offen offset:3072 sc1 lds
s_waitcnt vmcnt(9)
ds_read_b128 a[80:83], v6 offset:4096
v_lshlrev_b32 v70, 16, v83
v_and_b32 v71, s85, v83
s_mov_b32 s99, 0xbf317218
v_mfma_f32_32x32x16_bf16 v[32:47], a[16:19], a[72:75], v[32:47]
v_mul_f32 v64, s99, v64
v_mul_f32 v65, s99, v65
v_mul_f32 v66, s99, v66
v_mul_f32 v67, s99, v67
v_mul_f32 v68, s99, v68
v_mul_f32 v69, s99, v69
v_mul_f32 v70, s99, v70
v_mul_f32 v71, s99, v71
v_mfma_f32_32x32x16_bf16 v[48:63], a[20:23], a[72:75], v[48:63]
buffer_load_dword v4, v10, s[24:27], s21 offen offset:640 sc1
ds_read_b128 a[84:87], v6 offset:5120
v_and_b32 v3, 31, v0
v_lshlrev_b32 v3, 10, v3
v_lshrrev_b32 v1, 5, v0
v_mfma_f32_32x32x16_bf16 v[32:47], a[24:27], a[76:79], v[32:47]
v_lshl_add_u32 v3, v1, 4, v3
v_mfma_f32_32x32x16_bf16 v[48:63], a[28:31], a[76:79], v[48:63]
s_add_u32 s101, s18, 16384
buffer_load_dwordx4 a[128:131], v2, s[24:27], s101 offen offset:0 sc1
ds_read_b128 a[88:91], v6 offset:6144
s_waitcnt lgkmcnt(2)
v_mfma_f32_32x32x16_bf16 v[32:47], a[32:35], a[80:83], v[32:47]
v_mfma_f32_32x32x16_bf16 v[48:63], a[36:39], a[80:83], v[48:63]
buffer_load_dwordx4 a[132:135], v2, s[24:27], s101 offen offset:1024 sc1
ds_read_b128 a[92:95], v6 offset:7168
s_waitcnt lgkmcnt(2)
v_mfma_f32_32x32x16_bf16 v[32:47], a[40:43], a[84:87], v[32:47]
v_mfma_f32_32x32x16_bf16 v[48:63], a[44:47], a[84:87], v[48:63]
s_waitcnt vmcnt(8)
buffer_load_dwordx4 a[136:139], v2, s[24:27], s101 offen offset:2048 sc1
ds_read_b128 a[96:99], v6 offset:8192
s_waitcnt lgkmcnt(2)
v_mfma_f32_32x32x16_bf16 v[32:47], a[48:51], a[88:91], v[32:47]
v_mfma_f32_32x32x16_bf16 v[48:63], a[52:55], a[88:91], v[48:63]
buffer_load_dwordx4 a[140:143], v2, s[24:27], s101 offen offset:3072 sc1
ds_read_b128 a[100:103], v6 offset:9216
s_waitcnt lgkmcnt(2)
v_mfma_f32_32x32x16_bf16 v[32:47], a[56:59], a[92:95], v[32:47]
v_mfma_f32_32x32x16_bf16 v[48:63], a[60:63], a[92:95], v[48:63]
s_add_u32 s101, s18, 20480
s_cmp_eq_u32 s73, 3
s_cselect_b32 s101, 0x2000000, s101
buffer_load_dwordx4 a[144:147], v2, s[24:27], s101 offen offset:0 sc1
ds_read_b128 a[104:107], v6 offset:10240
s_waitcnt lgkmcnt(2)
v_mfma_f32_32x32x16_bf16 v[32:47], v[144:147], a[96:99], v[32:47]
v_mfma_f32_32x32x16_bf16 v[48:63], v[148:151], a[96:99], v[48:63]
buffer_load_dwordx4 a[148:151], v2, s[24:27], s101 offen offset:1024 sc1
ds_read_b128 a[108:111], v6 offset:11264
s_waitcnt lgkmcnt(2)
v_mfma_f32_32x32x16_bf16 v[32:47], v[152:155], a[100:103], v[32:47]
v_mfma_f32_32x32x16_bf16 v[48:63], v[156:159], a[100:103], v[48:63]
s_waitcnt vmcnt(7)
ds_read_b128 a[112:115], v6 offset:12288
s_waitcnt lgkmcnt(2)
v_mfma_f32_32x32x16_bf16 v[32:47], v[160:163], a[104:107], v[32:47]
s_waitcnt vmcnt(6)
v_cmp_ne_u32 vcc, s72, v4
s_nop 0
s_cbranch_vccnz L_poll_2066
L_ret_2067:
s_add_u32 s101, s18, 90112
buffer_load_dwordx4 a[152:155], v2, s[24:27], s101 offen offset:0 sc1
v_mfma_f32_32x32x16_bf16 v[48:63], v[164:167], a[104:107], v[48:63]
ds_read_b128 a[116:119], v6 offset:13312
s_waitcnt lgkmcnt(2)
v_mfma_f32_32x32x16_bf16 v[32:47], v[168:171], a[108:111], v[32:47]
v_mfma_f32_32x32x16_bf16 v[48:63], v[172:175], a[108:111], v[48:63]
buffer_load_dwordx4 a[156:159], v2, s[24:27], s101 offen offset:1024 sc1
ds_read_b128 a[120:123], v6 offset:14336
s_waitcnt lgkmcnt(2)
v_mfma_f32_32x32x16_bf16 v[32:47], v[176:179], a[112:115], v[32:47]
v_mfma_f32_32x32x16_bf16 v[48:63], v[180:183], a[112:115], v[48:63]
buffer_load_dwordx4 a[160:163], v2, s[24:27], s101 offen offset:2048 sc1
ds_read_b128 a[124:127], v6 offset:15360
s_waitcnt lgkmcnt(2)
v_mfma_f32_32x32x16_bf16 v[32:47], v[184:187], a[116:119], v[32:47]
v_mfma_f32_32x32x16_bf16 v[48:63], v[188:191], a[116:119], v[48:63]
buffer_load_dwordx4 a[164:167], v2, s[24:27], s101 offen offset:3072 sc1
s_waitcnt lgkmcnt(1)
v_mfma_f32_32x32x16_bf16 v[32:47], v[192:195], a[120:123], v[32:47]
v_mfma_f32_32x32x16_bf16 v[48:63], v[196:199], a[120:123], v[48:63]
s_add_u32 s101, s18, 94208
buffer_load_dwordx4 a[168:171], v2, s[24:27], s101 offen offset:0 sc1
s_waitcnt lgkmcnt(0)
v_mfma_f32_32x32x16_bf16 v[32:47], v[200:203], a[124:127], v[32:47]
v_mfma_f32_32x32x16_bf16 v[48:63], v[204:207], a[124:127], v[48:63]
buffer_load_dwordx4 a[172:175], v2, s[24:27], s101 offen offset:1024 sc1
s_waitcnt vmcnt(11)
v_mfma_f32_32x32x16_bf16 v[48:63], v[212:215], a[128:131], v[48:63]
s_waitcnt vmcnt(10)
v_mfma_f32_32x32x16_bf16 v[48:63], v[220:223], a[132:135], v[48:63]
buffer_load_dwordx4 a[176:179], v2, s[24:27], s101 offen offset:2048 sc1
s_waitcnt vmcnt(10)
v_mfma_f32_32x32x16_bf16 v[48:63], v[228:231], a[136:139], v[48:63]
s_waitcnt vmcnt(9)
v_mfma_f32_32x32x16_bf16 v[48:63], v[236:239], a[140:143], v[48:63]
buffer_load_dwordx4 a[180:183], v2, s[24:27], s101 offen offset:3072 sc1
s_waitcnt vmcnt(9)
v_mfma_f32_32x32x16_bf16 v[48:63], v[244:247], a[144:147], v[48:63]
s_waitcnt vmcnt(8)
v_mfma_f32_32x32x16_bf16 v[48:63], v[252:255], a[148:151], v[48:63]
s_add_u32 s101, s18, 98304
buffer_load_dwordx4 a[184:187], v2, s[24:27], s101 offen offset:0 sc1
v_mfma_f32_32x32x16_bf16 v[32:47], v[208:211], a[128:131], v[32:47]
v_mfma_f32_32x32x16_bf16 v[32:47], v[216:219], a[132:135], v[32:47]
buffer_load_dwordx4 a[188:191], v2, s[24:27], s101 offen offset:1024 sc1
v_mfma_f32_32x32x16_bf16 v[32:47], v[224:227], a[136:139], v[32:47]
s_nop 5
ds_write_b128 v110, v[48:51] offset:2048
v_mfma_f32_32x32x16_bf16 v[32:47], v[232:235], a[140:143], v[32:47]
ds_write_b128 v110, v[52:55] offset:3072
v_mfma_f32_32x32x16_bf16 v[32:47], v[240:243], a[144:147], v[32:47]
ds_write_b128 v111, v[56:59] offset:4096
v_mfma_f32_32x32x16_bf16 v[32:47], v[248:251], a[148:151], v[32:47]
ds_write_b128 v111, v[60:63] offset:5120
buffer_load_dwordx4 a[192:195], v2, s[24:27], s101 offen offset:2048 sc1
s_nop 9
ds_write_b128 v109, v[40:43] offset:0
ds_write_b128 v109, v[44:47] offset:1024
s_waitcnt lgkmcnt(0)
s_barrier
buffer_load_dwordx4 a[196:199], v2, s[24:27], s101 offen offset:3072 sc1
ds_read_b128 v[80:83], v108 offset:0
ds_read_b128 v[84:87], v108 offset:1024
ds_read_b128 v[88:91], v108 offset:2048
ds_read_b128 v[92:95], v108 offset:3072
s_add_u32 s101, s18, 102400
buffer_load_dwordx4 a[200:203], v2, s[24:27], s101 offen offset:0 sc1
ds_read_b128 v[96:99], v108 offset:4096
ds_read_b128 v[100:103], v108 offset:5120
s_waitcnt lgkmcnt(5)
v_pk_add_f32 v[32:33], v[32:33], v[80:81]
buffer_load_dwordx4 a[204:207], v2, s[24:27], s101 offen offset:1024 sc1
v_pk_add_f32 v[34:35], v[34:35], v[82:83]
s_waitcnt lgkmcnt(4)
v_pk_add_f32 v[36:37], v[36:37], v[84:85]
v_pk_add_f32 v[38:39], v[38:39], v[86:87]
s_waitcnt lgkmcnt(1)
v_pk_add_f32 v[88:89], v[88:89], v[96:97]
buffer_load_dwordx4 a[208:211], v2, s[24:27], s101 offen offset:2048 sc1
v_pk_add_f32 v[90:91], v[90:91], v[98:99]
s_waitcnt lgkmcnt(0)
v_pk_add_f32 v[92:93], v[92:93], v[100:101]
v_pk_add_f32 v[94:95], v[94:95], v[102:103]
v_pk_add_f32 v[32:33], v[32:33], v[88:89]
v_pk_add_f32 v[34:35], v[34:35], v[90:91]
v_pk_add_f32 v[36:37], v[36:37], v[92:93]
v_pk_add_f32 v[38:39], v[38:39], v[94:95]
v_pk_fma_f32 v[16:17], v[64:65], v[32:33], v[16:17]
v_pk_fma_f32 v[18:19], v[66:67], v[34:35], v[18:19]
v_pk_fma_f32 v[20:21], v[68:69], v[36:37], v[20:21]
v_pk_fma_f32 v[22:23], v[70:71], v[38:39], v[22:23]
s_lshl_b32 s78, s75, 11
buffer_load_dwordx4 a[212:215], v2, s[24:27], s101 offen offset:3072 sc1
s_add_u32 s78, s78, s76
s_add_u32 s78, s78, 0
s_lshl_b32 s78, s78, 5
v_cvt_pk_bf16_f32 v104, v16, v17
v_cvt_pk_bf16_f32 v105, v18, v19
v_cvt_pk_bf16_f32 v106, v20, v21
v_cvt_pk_bf16_f32 v107, v22, v23
s_nop 0
v_permlane32_swap_b32 v104, v106
v_permlane32_swap_b32 v105, v107
buffer_store_dwordx4 v[104:107], v3, s[28:31], s78 offen
s_waitcnt vmcnt(16)
v_mfma_f32_32x32x16_bf16 v[32:47], a[0:3], a[152:155], 0
v_mfma_f32_32x32x16_bf16 v[48:63], a[4:7], a[152:155], 0
s_waitcnt vmcnt(15)
v_mfma_f32_32x32x16_bf16 v[32:47], a[8:11], a[156:159], v[32:47]
s_add_u32 s101, s18, 106496
buffer_load_dwordx4 a[216:219], v2, s[24:27], s101 offen offset:0 sc1
v_mfma_f32_32x32x16_bf16 v[48:63], a[12:15], a[156:159], v[48:63]
s_waitcnt vmcnt(15)
v_mfma_f32_32x32x16_bf16 v[32:47], a[16:19], a[160:163], v[32:47]
v_mfma_f32_32x32x16_bf16 v[48:63], a[20:23], a[160:163], v[48:63]
buffer_load_dwordx4 a[220:223], v2, s[24:27], s101 offen offset:1024 sc1
s_waitcnt vmcnt(15)
v_mfma_f32_32x32x16_bf16 v[32:47], a[24:27], a[164:167], v[32:47]
v_mfma_f32_32x32x16_bf16 v[48:63], a[28:31], a[164:167], v[48:63]
buffer_load_dwordx4 a[224:227], v2, s[24:27], s101 offen offset:2048 sc1
s_waitcnt vmcnt(15)
v_mfma_f32_32x32x16_bf16 v[32:47], a[32:35], a[168:171], v[32:47]
v_mfma_f32_32x32x16_bf16 v[48:63], a[36:39], a[168:171], v[48:63]
s_waitcnt vmcnt(14)
v_mfma_f32_32x32x16_bf16 v[32:47], a[40:43], a[172:175], v[32:47]
buffer_load_dwordx4 a[228:231], v2, s[24:27], s101 offen offset:3072 sc1
v_mfma_f32_32x32x16_bf16 v[48:63], a[44:47], a[172:175], v[48:63]
s_waitcnt vmcnt(14)
v_mfma_f32_32x32x16_bf16 v[32:47], a[48:51], a[176:179], v[32:47]
v_mfma_f32_32x32x16_bf16 v[48:63], a[52:55], a[176:179], v[48:63]
s_waitcnt vmcnt(13)
v_mfma_f32_32x32x16_bf16 v[32:47], a[56:59], a[180:183], v[32:47]
s_add_u32 s101, s18, 110592
s_cmp_eq_u32 s73, 3
s_cselect_b32 s101, 0x2000000, s101
buffer_load_dwordx4 a[232:235], v2, s[24:27], s101 offen offset:0 sc1
v_mfma_f32_32x32x16_bf16 v[48:63], a[60:63], a[180:183], v[48:63]
s_waitcnt vmcnt(13)
v_mfma_f32_32x32x16_bf16 v[32:47], v[144:147], a[184:187], v[32:47]
v_mfma_f32_32x32x16_bf16 v[48:63], v[148:151], a[184:187], v[48:63]
buffer_load_dwordx4 a[236:239], v2, s[24:27], s101 offen offset:1024 sc1
s_waitcnt vmcnt(13)
v_mfma_f32_32x32x16_bf16 v[32:47], v[152:155], a[188:191], v[32:47]
v_mfma_f32_32x32x16_bf16 v[48:63], v[156:159], a[188:191], v[48:63]
s_waitcnt vmcnt(12)
v_mfma_f32_32x32x16_bf16 v[32:47], v[160:163], a[192:195], v[32:47]
v_mfma_f32_32x32x16_bf16 v[48:63], v[164:167], a[192:195], v[48:63]
s_waitcnt vmcnt(11)
v_mfma_f32_32x32x16_bf16 v[32:47], v[168:171], a[196:199], v[32:47]
v_mfma_f32_32x32x16_bf16 v[48:63], v[172:175], a[196:199], v[48:63]
s_waitcnt vmcnt(10)
v_mfma_f32_32x32x16_bf16 v[32:47], v[176:179], a[200:203], v[32:47]
v_mfma_f32_32x32x16_bf16 v[48:63], v[180:183], a[200:203], v[48:63]
s_waitcnt vmcnt(9)
v_mfma_f32_32x32x16_bf16 v[32:47], v[184:187], a[204:207], v[32:47]
v_mfma_f32_32x32x16_bf16 v[48:63], v[188:191], a[204:207], v[48:63]
s_waitcnt vmcnt(8)
v_mfma_f32_32x32x16_bf16 v[32:47], v[192:195], a[208:211], v[32:47]
v_mfma_f32_32x32x16_bf16 v[48:63], v[196:199], a[208:211], v[48:63]
s_waitcnt vmcnt(7)
v_mfma_f32_32x32x16_bf16 v[32:47], v[200:203], a[212:215], v[32:47]
v_mfma_f32_32x32x16_bf16 v[48:63], v[204:207], a[212:215], v[48:63]
s_waitcnt vmcnt(5)
v_mfma_f32_32x32x16_bf16 v[48:63], v[212:215], a[216:219], v[48:63]
s_waitcnt vmcnt(4)
v_mfma_f32_32x32x16_bf16 v[48:63], v[220:223], a[220:223], v[48:63]
s_waitcnt vmcnt(3)
v_mfma_f32_32x32x16_bf16 v[48:63], v[228:231], a[224:227], v[48:63]
s_waitcnt vmcnt(2)
v_mfma_f32_32x32x16_bf16 v[48:63], v[236:239], a[228:231], v[48:63]
s_waitcnt vmcnt(1)
v_mfma_f32_32x32x16_bf16 v[48:63], v[244:247], a[232:235], v[48:63]
s_waitcnt vmcnt(0)
v_mfma_f32_32x32x16_bf16 v[48:63], v[252:255], a[236:239], v[48:63]
v_mfma_f32_32x32x16_bf16 v[32:47], v[208:211], a[216:219], v[32:47]
v_mfma_f32_32x32x16_bf16 v[32:47], v[216:219], a[220:223], v[32:47]
v_mfma_f32_32x32x16_bf16 v[32:47], v[224:227], a[224:227], v[32:47]
s_nop 8
ds_write_b128 v110, v[48:51] offset:26624
v_mfma_f32_32x32x16_bf16 v[32:47], v[232:235], a[228:231], v[32:47]
ds_write_b128 v110, v[52:55] offset:27648
v_mfma_f32_32x32x16_bf16 v[32:47], v[240:243], a[232:235], v[32:47]
ds_write_b128 v111, v[56:59] offset:28672
v_mfma_f32_32x32x16_bf16 v[32:47], v[248:251], a[236:239], v[32:47]
ds_write_b128 v111, v[60:63] offset:29696
s_nop 10
ds_write_b128 v109, v[40:43] offset:24576
ds_write_b128 v109, v[44:47] offset:25600
s_waitcnt lgkmcnt(0)
s_barrier
ds_read_b128 v[80:83], v108 offset:24576
ds_read_b128 v[84:87], v108 offset:25600
ds_read_b128 v[88:91], v108 offset:26624
ds_read_b128 v[92:95], v108 offset:27648
ds_read_b128 v[96:99], v108 offset:28672
ds_read_b128 v[100:103], v108 offset:29696
s_waitcnt lgkmcnt(5)
v_pk_add_f32 v[32:33], v[32:33], v[80:81]
v_pk_add_f32 v[34:35], v[34:35], v[82:83]
s_waitcnt lgkmcnt(4)
v_pk_add_f32 v[36:37], v[36:37], v[84:85]
v_pk_add_f32 v[38:39], v[38:39], v[86:87]
s_waitcnt lgkmcnt(1)
v_pk_add_f32 v[88:89], v[88:89], v[96:97]
v_pk_add_f32 v[90:91], v[90:91], v[98:99]
s_waitcnt lgkmcnt(0)
v_pk_add_f32 v[92:93], v[92:93], v[100:101]
v_pk_add_f32 v[94:95], v[94:95], v[102:103]
v_pk_add_f32 v[32:33], v[32:33], v[88:89]
v_pk_add_f32 v[34:35], v[34:35], v[90:91]
v_pk_add_f32 v[36:37], v[36:37], v[92:93]
v_pk_add_f32 v[38:39], v[38:39], v[94:95]
v_pk_fma_f32 v[24:25], v[64:65], v[32:33], v[24:25]
v_pk_fma_f32 v[26:27], v[66:67], v[34:35], v[26:27]
v_pk_fma_f32 v[28:29], v[68:69], v[36:37], v[28:29]
v_pk_fma_f32 v[30:31], v[70:71], v[38:39], v[30:31]
s_lshl_b32 s78, s75, 11
s_add_u32 s78, s78, s76
s_add_u32 s78, s78, 1024
s_lshl_b32 s78, s78, 5
v_cvt_pk_bf16_f32 v104, v24, v25
v_cvt_pk_bf16_f32 v105, v26, v27
v_cvt_pk_bf16_f32 v106, v28, v29
v_cvt_pk_bf16_f32 v107, v30, v31
s_nop 0
v_permlane32_swap_b32 v104, v106
v_permlane32_swap_b32 v105, v107
buffer_store_dwordx4 v[104:107], v3, s[28:31], s78 offen
s_endpgm
L_prod:
s_lshl_b32 s99, s73, 14
s_add_u32 s82, s82, s99
s_add_u32 s101, s74, 0
s_and_b32 s101, s101, 3
s_lshl_b32 s101, s101, 12
s_add_u32 s101, s101, s82
buffer_load_dwordx4 v[20:23], v2, s[4:7], s101 offen offset:0 nt
buffer_load_dwordx4 v[28:31], v2, s[4:7], s101 offen offset:1024 nt
buffer_load_dwordx4 v[36:39], v2, s[4:7], s101 offen offset:2048 nt
buffer_load_dwordx4 v[44:47], v2, s[4:7], s101 offen offset:3072 nt
s_mul_i32 s99, s2, 6144
s_cmp_eq_u32 s73, 1
s_cselect_b32 s99, s99, s6
v_bfe_u32 v10, v0, 4, 1
v_and_b32 v9, 0x780, v9
v_mad_u32_u24 v9, v10, s100, v9
buffer_load_dword a1, v9, s[8:11], s99 offen offset:1024
v_lshrrev_b32 v208, 3, v0
s_and_b32 s101, s2, 7
s_lshl_b32 s101, s101, 2
v_mul_u32_u24 v7, 0x3000, v208
v_lshl_add_u32 v7, v4, 4, v7
s_add_u32 s64, s101, s73
s_lshl_b32 s65, s64, 5
s_mul_i32 s64, s64, 98304
s_andn2_b32 s99, s2, 7
s_lshl_b32 s99, s99, 4
s_add_u32 s64, s64, s99
buffer_load_dwordx4 v[216:219], v7, s[32:35], s64 offen offset:2048 nt
s_addk_i32 s64, 6144
buffer_load_dwordx4 v[220:223], v7, s[32:35], s64 offen offset:2048 nt
v_lshlrev_b32 v7, 2, v208
buffer_load_dword v224, v7, s[36:39], s65 offen
s_waitcnt vmcnt(12)
v_lshlrev_b32 v252, 16, v248
v_mul_f32 v249, 0xbfb8aa3b, v252
v_exp_f32 v249, v249
s_nop 0
v_add_f32 v249, 1.0, v249
v_rcp_f32 v249, v249
s_nop 0
v_mul_f32 v252, v252, v249
v_cvt_pk_bf16_f32 v248, v252, v252
s_lshl_b32 s78, s73, 9
s_add_u32 s78, s78, 155648
v_lshlrev_b32 v252, 16, v248
v_lshl_add_u32 v7, v0, 2, s78
v_lshl_add_u32 v6, v3, 4, s78
ds_write_b32 v7, v252
v_lshl_add_u32 v5, v0, 3, s78
s_waitcnt lgkmcnt(0)
ds_read_b128 v[144:147], v6 offset:0
s_waitcnt vmcnt(11)
v_lshlrev_b32 v168, 16, v176
v_and_b32 v169, s85, v176
v_lshlrev_b32 v170, 16, v177
v_and_b32 v171, s85, v177
v_lshlrev_b32 v172, 16, v178
v_and_b32 v173, s85, v178
v_lshlrev_b32 v174, 16, v179
v_and_b32 v175, s85, v179
s_waitcnt lgkmcnt(0)
v_pk_mul_f32 v[240:241], v[168:169], v[144:145] op_sel:[0,0] op_sel_hi:[1,0]
v_pk_mul_f32 v[242:243], v[170:171], v[144:145] op_sel:[0,0] op_sel_hi:[1,0]
v_pk_mul_f32 v[244:245], v[172:173], v[144:145] op_sel:[0,0] op_sel_hi:[1,0]
v_pk_mul_f32 v[246:247], v[174:175], v[144:145] op_sel:[0,0] op_sel_hi:[1,0]
s_waitcnt vmcnt(10)
v_lshlrev_b32 v160, 16, v180
v_and_b32 v161, s85, v180
v_lshlrev_b32 v162, 16, v181
v_and_b32 v163, s85, v181
v_lshlrev_b32 v164, 16, v182
v_and_b32 v165, s85, v182
v_lshlrev_b32 v166, 16, v183
v_and_b32 v167, s85, v183
v_pk_fma_f32 v[240:241], v[160:161], v[144:145], v[240:241] op_sel:[0,1,0] op_sel_hi:[1,1,1]
v_pk_fma_f32 v[242:243], v[162:163], v[144:145], v[242:243] op_sel:[0,1,0] op_sel_hi:[1,1,1]
v_pk_fma_f32 v[244:245], v[164:165], v[144:145], v[244:245] op_sel:[0,1,0] op_sel_hi:[1,1,1]
v_pk_fma_f32 v[246:247], v[166:167], v[144:145], v[246:247] op_sel:[0,1,0] op_sel_hi:[1,1,1]
s_waitcnt vmcnt(9)
v_lshlrev_b32 v168, 16, v184
v_and_b32 v169, s85, v184
v_lshlrev_b32 v170, 16, v185
v_and_b32 v171, s85, v185
v_lshlrev_b32 v172, 16, v186
v_and_b32 v173, s85, v186
v_lshlrev_b32 v174, 16, v187
v_and_b32 v175, s85, v187
v_pk_fma_f32 v[240:241], v[168:169], v[146:147], v[240:241] op_sel:[0,0,0] op_sel_hi:[1,0,1]
v_pk_fma_f32 v[242:243], v[170:171], v[146:147], v[242:243] op_sel:[0,0,0] op_sel_hi:[1,0,1]
v_pk_fma_f32 v[244:245], v[172:173], v[146:147], v[244:245] op_sel:[0,0,0] op_sel_hi:[1,0,1]
v_pk_fma_f32 v[246:247], v[174:175], v[146:147], v[246:247] op_sel:[0,0,0] op_sel_hi:[1,0,1]
s_waitcnt vmcnt(8)
v_lshlrev_b32 v160, 16, v188
v_and_b32 v161, s85, v188
v_lshlrev_b32 v162, 16, v189
v_and_b32 v163, s85, v189
v_lshlrev_b32 v164, 16, v190
v_and_b32 v165, s85, v190
v_lshlrev_b32 v166, 16, v191
v_and_b32 v167, s85, v191
v_pk_fma_f32 v[240:241], v[160:161], v[146:147], v[240:241] op_sel:[0,1,0] op_sel_hi:[1,1,1]
v_pk_fma_f32 v[242:243], v[162:163], v[146:147], v[242:243] op_sel:[0,1,0] op_sel_hi:[1,1,1]
v_pk_fma_f32 v[244:245], v[164:165], v[146:147], v[244:245] op_sel:[0,1,0] op_sel_hi:[1,1,1]
v_pk_fma_f32 v[246:247], v[166:167], v[146:147], v[246:247] op_sel:[0,1,0] op_sel_hi:[1,1,1]
s_nop 0
v_permlane32_swap_b32 v240, v244
v_permlane32_swap_b32 v241, v245
v_permlane32_swap_b32 v242, v246
v_permlane32_swap_b32 v243, v247
v_add_f32 v240, v240, v244
v_add_f32 v241, v241, v245
v_add_f32 v242, v242, v246
v_add_f32 v243, v243, v247
s_nop 0
v_permlane16_swap_b32 v240, v242
v_permlane16_swap_b32 v241, v243
v_add_f32 v240, v240, v242
v_add_f32 v241, v241, v243
s_nop 0
v_add_f32_dpp v240, v240, v240 row_ror:8 row_mask:0xf bank_mask:0xf
v_add_f32_dpp v241, v241, v241 row_ror:8 row_mask:0xf bank_mask:0xf
ds_write_b64 v5, v[240:241] offset:2048
s_waitcnt lgkmcnt(0)
s_barrier
s_cmp_lg_u32 s73, 0
s_cbranch_scc1 L_w0_1
ds_read_b64 v[240:241], v5 offset:2048
ds_read_b64 v[242:243], v5 offset:2560
ds_read_b64 v[244:245], v5 offset:3072
ds_read_b64 v[246:247], v5 offset:3584
v_lshlrev_b32 v6, 2, v4
v_lshrrev_b32 v7, 5, v0
v_lshl_add_u32 v6, v7, 1, v6
v_bfe_u32 v7, v0, 4, 1
v_add_u32 v6, v6, v7
v_lshlrev_b32 v6, 4, v6
s_and_b32 s78, s77, 3
s_lshl_b32 s78, s78, 4
s_lshr_b32 s79, s77, 2
s_add_u32 s78, s78, s79
s_lshl_b32 s78, s78, 9
s_add_u32 s78, s78, 327680
s_add_u32 s83, s72, 0x9e3779b9
s_waitcnt lgkmcnt(2)
v_pk_add_f32 v[240:241], v[240:241], v[242:243]
s_waitcnt lgkmcnt(0)
v_pk_add_f32 v[244:245], v[244:245], v[246:247]
v_pk_add_f32 v[240:241], v[240:241], v[244:245]
v_mov_b32 v242, v241
v_mov_b32 v241, s83
v_mov_b32 v243, s83
s_mov_b32 exec_lo, 0x00ff00ff
s_mov_b32 exec_hi, 0x00ff00ff
buffer_store_dwordx4 v[240:243], v6, s[24:27], s78 offen sc1
s_mov_b64 exec, -1
L_w0_1:
s_add_u32 s101, s74, 1
s_and_b32 s101, s101, 3
s_lshl_b32 s101, s101, 12
s_add_u32 s101, s101, s82
buffer_load_dwordx4 v[52:55], v2, s[4:7], s101 offen offset:0 nt
buffer_load_dwordx4 v[60:63], v2, s[4:7], s101 offen offset:1024 nt
buffer_load_dwordx4 v[68:71], v2, s[4:7], s101 offen offset:2048 nt
s_cmp_eq_u32 s73, 1
s_cselect_b64 s[40:41], s[28:29], s[24:25]
s_cselect_b32 s42, 2, 32
s_lshl_b32 s42, s42, 20
s_cmp_eq_u32 s73, 2
s_cselect_b64 s[40:41], s[68:69], s[40:41]
s_cselect_b32 s42, 1409024, s42
s_cmp_eq_u32 s73, 3
s_cselect_b64 s[40:41], s[70:71], s[40:41]
s_cselect_b32 s42, 1409024, s42
s_mov_b32 s43, 0x20000
s_add_u32 s99, s42, -4
v_lshlrev_b32 v5, 20, v0
v_min_u32 v5, s99, v5
buffer_load_dword a3, v5, s[40:43], 0 offen
s_mov_b32 s14, 524288
s_mov_b32 s15, 0x20000
v_min_u32 v5, 524284, v5
buffer_load_dword a4, v5, s[12:15], 0 offen
s_lshl_b32 s76, s74, 2
s_add_u32 s76, s76, s73
v_bfe_u32 v5, v0, 4, 1
v_lshrrev_b32 v6, 1, v4
v_xor_b32 v5, v5, v6
v_lshlrev_b32 v5, 5, v5
v_and_b32 v6, 1, v0
v_lshl_add_u32 v5, v6, 4, v5
v_mul_u32_u24 v6, 3072, v3
v_add_u32 v8, v5, v6
v_xor_b32 v9, 64, v5
v_add_u32 v9, v9, v6
v_add_u32 v9, 23552, v9
v_add_u32 v10, 47104, v8
v_add_u32 v11, 47104, v9
s_mul_i32 s79, s73, 98304
s_add_u32 s81, s81, s79
s_lshl_b32 s80, s73, 12
s_mov_b32 s30, 0x200000
s_mov_b32 s31, 0x20000
s_mul_i32 s48, s74, 5
s_min_u32 s49, s74, 3
s_add_u32 s48, s48, s49
s_lshl_b32 s48, s48, 1
s_and_b32 s49, s75, 1
s_lshl_b32 s49, s49, 1
s_add_u32 s49, s49, s73
s_sub_u32 s49, s49, 2
s_lshr_b32 s50, s75, 1
s_mul_i32 s51, s49, 3
s_add_u32 s48, s48, s51
s_lshl_b32 s48, s48, 5
s_mul_i32 s51, s50, 88064
s_add_u32 s48, s48, s51
s_lshl_b32 s51, s74, 2
s_add_u32 s51, s51, s49
s_mul_i32 s51, s51, 48
s_add_u32 s51, s51, s50
s_lshl_b32 s51, s51, 10
s_add_u32 s51, s51, 24117248
s_mul_i32 s52, s75, 3
s_add_u32 s53, s52, s73
s_add_u32 s53, s53, s73
s_add_u32 s52, s52, 1
s_lshl_b32 s54, s74, 7
s_cmp_eq_u32 s73, 0
s_cselect_b32 s55, s75, s52
s_lshl_b32 s56, s55, 14
s_add_u32 s56, s56, s54
s_lshl_b32 s57, s53, 14
s_add_u32 s57, s57, s54
s_cmp_eq_u32 s73, 0
s_cselect_b64 s[40:41], s[12:13], s[70:71]
s_mov_b32 s42, 1409024
s_mov_b32 s43, 0x20000
s_mov_b32 s46, 1409024
s_mov_b32 s47, 0x20000
s_cmp_ge_u32 s73, 2
s_cselect_b64 s[40:41], s[68:69], s[40:41]
s_cselect_b64 s[44:45], s[68:69], s[70:71]
s_cselect_b32 s58, 43, 16
s_mulk_i32 s58, 64
s_cselect_b32 s56, s48, s56
s_cselect_b64 vcc, -1, 0
s_add_u32 s48, s48, 44032
s_cmp_ge_u32 s73, 2
s_cselect_b32 s57, s48, s57
v_lshrrev_b32 v5, 4, v0
v_lshlrev_b32 v6, 1, v5
v_and_b32 v5, 1, v5
v_lshlrev_b32 v5, 2, v5
v_cndmask_b32 v5, v5, v6, vcc
v_xor_b32 v5, v5, v4
v_mul_u32_u24 v6, s58, v3
v_lshl_add_u32 v5, v5, 4, v6
s_lshl_b32 s58, s58, 3
s_lshl_b32 s59, s73, 12
s_add_u32 s59, s59, 139264
v_mov_b32 v1, v5
s_mul_i32 s60, s52, 745
s_lshr_b32 s60, s60, 14
s_mul_i32 s61, s53, 745
s_lshr_b32 s61, s61, 14
s_lshr_b32 s62, s75, 3
s_cmp_eq_u32 s73, 0
s_cselect_b32 s60, s62, s60
s_lshl_b32 s60, s60, 5
s_lshl_b32 s61, s61, 5
s_cmp_ge_u32 s73, 2
s_cselect_b32 s60, 0, s60
s_cselect_b32 s61, 64, s61
s_cselect_b32 s62, 32, 64
s_cselect_b32 s63, 0, 2048
s_cselect_b64 vcc, -1, 0
v_bfe_u32 v5, v0, 3, 1
v_bfe_u32 v6, v0, 4, 1
v_lshlrev_b32 v7, 6, v5
v_lshl_add_u32 v7, v6, 5, v7
v_bfe_u32 v5, v0, 3, 2
v_lshlrev_b32 v5, 5, v5
v_cndmask_b32 v7, v7, v5, vcc
v_lshrrev_b32 v5, 5, v0
v_lshlrev_b32 v208, 10, v5
v_lshlrev_b32 v209, 11, v5
v_lshl_add_u32 v209, v6, 9, v209
v_cndmask_b32 v210, v208, v209, vcc
s_cmp_eq_u32 s73, 0
s_cselect_b64 vcc, -1, 0
v_lshlrev_b32 v209, 9, v5
v_cndmask_b32 v208, v210, v209, vcc
v_bfe_u32 v5, v0, 2, 2
v_and_b32 v6, 3, v0
v_lshlrev_b32 v6, 3, v6
v_lshl_add_u32 v5, v5, 7, v6
v_add_u32 v5, s59, v5
v_add_u32 v208, v208, v5
v_add3_u32 v210, v210, v5, s63
v_xor_b32 v5, s60, v7
v_xor_b32 v6, s61, v7
v_xor_b32 v209, s62, v5
v_xor_b32 v211, s62, v6
v_add_u32 v209, v209, v208
v_add_u32 v208, v5, v208
v_add_u32 v211, v211, v210
v_add_u32 v210, v6, v210
s_cmp_eq_u32 s73, 1
s_cselect_b32 s60, 1, 2
s_cmp_ge_u32 s73, 2
s_cselect_b32 s61, 2, 1
s_lshl_b32 s60, s60, 9
s_lshl_b32 s61, s61, 9
v_add_u32 v212, s60, v208
v_add_u32 v213, s60, v209
v_add_u32 v214, s61, v210
v_add_u32 v215, s61, v211
s_mul_i32 s48, s74, 88
s_add_u32 s49, s48, s52
s_lshl_b32 s49, s49, 11
s_add_u32 s49, s49, 26214400
s_cmp_lt_u32 s52, 86
s_cselect_b32 s60, s49, 0x2000000
s_add_u32 s49, s48, s53
s_lshl_b32 s49, s49, 11
s_add_u32 s49, s49, 26214400
s_cmp_lt_u32 s53, 86
s_cselect_b32 s62, s49, 0x2000000
s_lshl_b32 s48, s74, 5
s_add_u32 s48, s48, s75
s_lshl_b32 s48, s48, 11
s_add_u32 s48, s48, 23068672
s_cmp_eq_u32 s73, 0
s_cselect_b32 s60, s48, s60
s_add_u32 s63, s62, 1024
s_add_u32 s61, s60, 1024
s_add_u32 s48, s51, 32768
s_add_u32 s49, s51, 16384
s_cmp_ge_u32 s73, 2
s_cselect_b32 s60, s51, s60
s_cselect_b32 s61, s49, s61
s_cselect_b32 s62, s48, s62
s_cselect_b32 s63, 0x2000000, s63
v_accvgpr_write_b32 a241, v208
v_accvgpr_write_b32 a242, v209
v_accvgpr_write_b32 a243, v210
v_accvgpr_write_b32 a244, v211
v_accvgpr_write_b32 a245, v212
v_accvgpr_write_b32 a246, v213
v_accvgpr_write_b32 a247, v214
v_accvgpr_write_b32 a248, v215
v_bfe_u32 v5, v0, 3, 1
v_mul_u32_u24 v5, 3072, v5
v_lshl_add_u32 v5, v4, 7, v5
v_accvgpr_write_b32 a252, v5
s_mul_i32 s69, s2, 6144
s_cmp_eq_u32 s73, 2
s_cselect_b32 s69, s69, 0x2000000
v_and_b32 v5, 7, v0
v_lshlrev_b32 v5, 7, v5
s_lshl_b32 s48, s75, 10
s_add_u32 s48, s48, 32768
v_add_u32 v6, s48, v5
s_lshl_b32 s48, s75, 3
s_add_u32 s48, s48, s74
s_lshl_b32 s48, s48, 10
s_add_u32 s48, s48, 65536
v_add_u32 v5, s48, v5
v_cmp_gt_u32 vcc, 8, v0
s_nop 1
v_cndmask_b32 v3, v5, v6, vcc
s_cmp_eq_u32 s73, 3
s_cselect_b32 s66, 0, 0x2000000
s_lshr_b32 s49, s2, 6
s_mul_i32 s49, s49, 1
s_add_u32 s48, s49, 0
s_and_b32 s48, s48, 3
s_mul_i32 s48, s48, 393216
s_add_u32 s50, s48, s81
s_add_u32 s48, s49, 1
s_and_b32 s48, s48, 3
s_mul_i32 s48, s48, 393216
s_add_u32 s51, s48, s81
s_add_u32 s48, s49, 2
s_and_b32 s48, s48, 3
s_mul_i32 s48, s48, 393216
s_add_u32 s52, s48, s81
s_add_u32 s48, s49, 3
s_and_b32 s48, s48, 3
s_mul_i32 s48, s48, 393216
s_add_u32 s53, s48, s81
buffer_load_dwordx4 v[76:79], v2, s[4:7], s101 offen offset:3072 nt
s_nop 1
s_branch L_join
L_fastend:
L_slowmode:
s_lshl_b32 s79, s2, 2
s_add_u32 s79, s79, s73
s_cmp_lg_u32 s79, 3
s_cbranch_scc1 L_noep_2068
s_mov_b32 s83, 4096
buffer_load_dwordx4 v[32:35], v2, s[24:27], s83 offen offset:0 sc1
buffer_load_dwordx4 v[36:39], v2, s[24:27], s83 offen offset:1024 sc1
s_waitcnt vmcnt(1)
v_cmp_ne_u32 vcc, s72, v33
v_cmp_ne_u32 s[86:87], s72, v35
s_nop 0
s_or_b64 vcc, vcc, s[86:87]
s_waitcnt vmcnt(0)
v_cmp_ne_u32 s[86:87], s72, v37
s_nop 0
s_or_b64 vcc, vcc, s[86:87]
v_cmp_ne_u32 s[86:87], s72, v39
s_nop 0
s_or_b64 vcc, vcc, s[86:87]
s_cbranch_vccnz L_poll_2069
L_ret_2070:
buffer_store_dword v15, v14, s[24:27], 0 offen sc1
L_noep_2068:
s_waitcnt vmcnt(12)
v_mfma_f32_32x32x16_bf16 v[32:47], v[236:239], v[200:203], 0
s_waitcnt vmcnt(9)
v_mfma_f32_32x32x16_bf16 v[48:63], v[232:235], v[200:203], 0
buffer_load_dwordx4 a[216:219], v1, s[24:27], s100 offen offset:1024 sc1
s_nop 8
v_exp_f32 v32, v32
v_exp_f32 v33, v33
v_exp_f32 v34, v34
v_exp_f32 v35, v35
v_exp_f32 v36, v36
v_exp_f32 v37, v37
buffer_load_dwordx4 a[220:223], v1, s[24:27], s100 offen offset:1536 sc1
v_exp_f32 v38, v38
v_exp_f32 v39, v39
v_exp_f32 v40, v40
v_cvt_pk_bf16_f32 v112, v32, v33
v_cvt_pk_bf16_f32 v113, v34, v35
v_cvt_pk_bf16_f32 v114, v36, v37
v_cvt_pk_bf16_f32 v115, v38, v39
buffer_load_dwordx4 v[216:219], v2, s[24:27], s101 offen offset:0 sc1
v_exp_f32 v41, v41
v_exp_f32 v42, v42
v_mfma_f32_32x32x16_bf16 v[96:111], a[248:251], v[112:115], 0
v_exp_f32 v43, v43
v_exp_f32 v44, v44
v_exp_f32 v45, v45
v_exp_f32 v46, v46
v_exp_f32 v47, v47
buffer_load_dwordx4 a[208:211], v1, s[24:27], s100 offen offset:0 sc1
v_cvt_pk_bf16_f32 v116, v40, v41
v_cvt_pk_bf16_f32 v117, v42, v43
v_cvt_pk_bf16_f32 v118, v44, v45
v_cvt_pk_bf16_f32 v119, v46, v47
s_waitcnt vmcnt(10)
v_mfma_f32_32x32x16_bf16 v[32:47], v[228:231], v[200:203], 0
v_exp_f32 v48, v48
v_exp_f32 v49, v49
buffer_load_dwordx4 a[212:215], v1, s[24:27], s100 offen offset:512 sc1
v_exp_f32 v50, v50
v_exp_f32 v51, v51
v_mfma_f32_32x32x16_bf16 v[96:111], a[252:255], v[116:119], v[96:111]
v_exp_f32 v52, v52
v_exp_f32 v53, v53
v_exp_f32 v54, v54
s_add_u32 s101, s82, 786432
s_cmp_ge_u32 s75, 4
s_cselect_b32 s101, s101, 0x2000000
s_add_u32 s100, s101, 2097152
buffer_load_dwordx4 v[212:215], v2, s[24:27], s101 offen offset:1024 sc1
v_exp_f32 v55, v55
v_exp_f32 v56, v56
v_cvt_pk_bf16_f32 v120, v48, v49
v_cvt_pk_bf16_f32 v121, v50, v51
v_cvt_pk_bf16_f32 v122, v52, v53
v_cvt_pk_bf16_f32 v123, v54, v55
v_exp_f32 v57, v57
v_exp_f32 v58, v58
v_mfma_f32_32x32x16_bf16 v[96:111], a[240:243], v[120:123], v[96:111]
v_exp_f32 v59, v59
v_exp_f32 v60, v60
v_exp_f32 v61, v61
v_exp_f32 v62, v62
v_exp_f32 v63, v63
v_cvt_pk_bf16_f32 v124, v56, v57
v_cvt_pk_bf16_f32 v125, v58, v59
v_cvt_pk_bf16_f32 v126, v60, v61
v_cvt_pk_bf16_f32 v127, v62, v63
s_waitcnt vmcnt(9)
v_mfma_f32_32x32x16_bf16 v[48:63], v[224:227], v[200:203], 0
buffer_load_dwordx4 a[200:203], v1, s[24:27], s100 offen offset:1024 sc1
v_exp_f32 v32, v32
v_exp_f32 v33, v33
v_exp_f32 v34, v34
v_exp_f32 v35, v35
v_mfma_f32_32x32x16_bf16 v[96:111], a[244:247], v[124:127], v[96:111]
v_exp_f32 v36, v36
v_exp_f32 v37, v37
v_exp_f32 v38, v38
buffer_load_dwordx4 a[204:207], v1, s[24:27], s100 offen offset:1536 sc1
v_exp_f32 v39, v39
v_exp_f32 v40, v40
v_cvt_pk_bf16_f32 v112, v32, v33
v_cvt_pk_bf16_f32 v113, v34, v35
v_cvt_pk_bf16_f32 v114, v36, v37
v_cvt_pk_bf16_f32 v115, v38, v39
v_exp_f32 v41, v41
v_exp_f32 v42, v42
buffer_load_dwordx4 v[208:211], v2, s[24:27], s101 offen offset:0 sc1
v_mfma_f32_32x32x16_bf16 v[96:111], a[232:235], v[112:115], v[96:111]
v_exp_f32 v43, v43
v_exp_f32 v44, v44
v_exp_f32 v45, v45
v_exp_f32 v46, v46
v_exp_f32 v47, v47
v_cvt_pk_bf16_f32 v116, v40, v41
v_cvt_pk_bf16_f32 v117, v42, v43
v_cvt_pk_bf16_f32 v118, v44, v45
buffer_load_dwordx4 a[192:195], v1, s[24:27], s100 offen offset:0 sc1
v_cvt_pk_bf16_f32 v119, v46, v47
s_waitcnt vmcnt(10)
v_mfma_f32_32x32x16_bf16 v[32:47], v[220:223], v[200:203], 0
v_exp_f32 v48, v48
v_exp_f32 v49, v49
v_exp_f32 v50, v50
v_exp_f32 v51, v51
v_mfma_f32_32x32x16_bf16 v[96:111], a[236:239], v[116:119], v[96:111]
v_exp_f32 v52, v52
buffer_load_dwordx4 a[196:199], v1, s[24:27], s100 offen offset:512 sc1
v_exp_f32 v53, v53
v_exp_f32 v54, v54
v_exp_f32 v55, v55
v_exp_f32 v56, v56
v_cvt_pk_bf16_f32 v120, v48, v49
v_cvt_pk_bf16_f32 v121, v50, v51
v_cvt_pk_bf16_f32 v122, v52, v53
buffer_load_dwordx4 v2, s[24:27], s98 offen offset:1024 sc1 lds
v_cvt_pk_bf16_f32 v123, v54, v55
v_exp_f32 v57, v57
v_exp_f32 v58, v58
v_mfma_f32_32x32x16_bf16 v[96:111], a[224:227], v[120:123], v[96:111]
v_exp_f32 v59, v59
v_exp_f32 v60, v60
v_exp_f32 v61, v61
v_exp_f32 v62, v62
buffer_load_dwordx4 v2, s[24:27], s98 offen offset:2048 sc1 lds
v_exp_f32 v63, v63
v_cvt_pk_bf16_f32 v124, v56, v57
v_cvt_pk_bf16_f32 v125, v58, v59
v_cvt_pk_bf16_f32 v126, v60, v61
v_cvt_pk_bf16_f32 v127, v62, v63
s_waitcnt vmcnt(10)
v_mfma_f32_32x32x16_bf16 v[48:63], v[216:219], v[200:203], 0
v_exp_f32 v32, v32
v_exp_f32 v33, v33
buffer_load_dwordx4 v2, s[24:27], s98 offen offset:3072 sc1 lds
v_exp_f32 v34, v34
v_exp_f32 v35, v35
v_mfma_f32_32x32x16_bf16 v[96:111], a[228:231], v[124:127], v[96:111]
v_exp_f32 v36, v36
v_exp_f32 v37, v37
v_exp_f32 v38, v38
s_add_u32 m0, s35, 77824
s_add_u32 s98, s34, 4096
buffer_load_dwordx4 v2, s[24:27], s98 offen offset:0 sc1 lds
v_exp_f32 v39, v39
v_exp_f32 v40, v40
v_cvt_pk_bf16_f32 v112, v32, v33
v_cvt_pk_bf16_f32 v113, v34, v35
v_cvt_pk_bf16_f32 v114, v36, v37
v_cvt_pk_bf16_f32 v115, v38, v39
v_exp_f32 v41, v41
v_exp_f32 v42, v42
buffer_load_dwordx4 v2, s[24:27], s98 offen offset:1024 sc1 lds
v_mfma_f32_32x32x16_bf16 v[96:111], a[216:219], v[112:115], v[96:111]
v_exp_f32 v43, v43
v_exp_f32 v44, v44
v_exp_f32 v45, v45
v_exp_f32 v46, v46
v_exp_f32 v47, v47
v_cvt_pk_bf16_f32 v116, v40, v41
v_cvt_pk_bf16_f32 v117, v42, v43
v_cvt_pk_bf16_f32 v118, v44, v45
v_cvt_pk_bf16_f32 v119, v46, v47
s_waitcnt vmcnt(10)
v_mfma_f32_32x32x16_bf16 v[32:47], v[212:215], v[200:203], 0
v_exp_f32 v48, v48
v_exp_f32 v49, v49
v_exp_f32 v50, v50
v_exp_f32 v51, v51
v_mfma_f32_32x32x16_bf16 v[96:111], a[220:223], v[116:119], v[96:111]
v_exp_f32 v52, v52
v_exp_f32 v53, v53
v_exp_f32 v54, v54
v_exp_f32 v55, v55
buffer_load_dwordx4 v2, s[24:27], s98 offen offset:2048 sc1 lds
v_exp_f32 v56, v56
v_cvt_pk_bf16_f32 v120, v48, v49
v_cvt_pk_bf16_f32 v121, v50, v51
v_cvt_pk_bf16_f32 v122, v52, v53
v_cvt_pk_bf16_f32 v123, v54, v55
v_exp_f32 v57, v57
v_exp_f32 v58, v58
v_mfma_f32_32x32x16_bf16 v[96:111], a[208:211], v[120:123], v[96:111]
v_exp_f32 v59, v59
buffer_load_dwordx4 v2, s[24:27], s98 offen offset:3072 sc1 lds
v_exp_f32 v60, v60
v_exp_f32 v61, v61
v_exp_f32 v62, v62
v_exp_f32 v63, v63
v_cvt_pk_bf16_f32 v124, v56, v57
v_cvt_pk_bf16_f32 v125, v58, v59
v_cvt_pk_bf16_f32 v126, v60, v61
v_cvt_pk_bf16_f32 v127, v62, v63
v_mfma_f32_32x32x16_bf16 v[48:63], v[176:179], v[200:203], 0
v_exp_f32 v32, v32
v_exp_f32 v33, v33
s_add_u32 m0, s35, 81920
s_add_u32 s98, s34, 8192
buffer_load_dwordx4 v2, s[24:27], s98 offen offset:0 sc1 lds
v_exp_f32 v34, v34
v_exp_f32 v35, v35
v_mfma_f32_32x32x16_bf16 v[96:111], a[212:215], v[124:127], v[96:111]
v_exp_f32 v36, v36
v_exp_f32 v37, v37
buffer_load_dwordx4 v2, s[24:27], s98 offen offset:1024 sc1 lds
v_exp_f32 v38, v38
v_exp_f32 v39, v39
v_exp_f32 v40, v40
v_cvt_pk_bf16_f32 v112, v32, v33
v_cvt_pk_bf16_f32 v113, v34, v35
v_cvt_pk_bf16_f32 v114, v36, v37
v_cvt_pk_bf16_f32 v115, v38, v39
v_exp_f32 v41, v41
v_exp_f32 v42, v42
s_waitcnt vmcnt(13)
v_mfma_f32_32x32x16_bf16 v[96:111], a[200:203], v[112:115], v[96:111]
buffer_load_dwordx4 v2, s[24:27], s98 offen offset:2048 sc1 lds
v_exp_f32 v43, v43
v_exp_f32 v44, v44
v_exp_f32 v45, v45
v_exp_f32 v46, v46
v_exp_f32 v47, v47
s_waitcnt vmcnt(12)
v_mfma_f32_32x32x16_bf16 v[64:79], v[208:211], v[200:203], 0
v_cvt_pk_bf16_f32 v116, v40, v41
v_cvt_pk_bf16_f32 v117, v42, v43
v_cvt_pk_bf16_f32 v118, v44, v45
v_cvt_pk_bf16_f32 v119, v46, v47
s_nop 1
v_mfma_f32_32x32x16_bf16 v[96:111], a[204:207], v[116:119], v[96:111]
buffer_load_dwordx4 v2, s[24:27], s98 offen offset:3072 sc1 lds
s_nop 3
v_cndmask_b32 v48, v64, v48, s[40:41]
v_cndmask_b32 v49, v65, v49, s[42:43]
v_cndmask_b32 v50, v66, v50, s[44:45]
v_cndmask_b32 v51, v67, v51, s[46:47]
v_cndmask_b32 v52, v68, v52, s[48:49]
v_cndmask_b32 v53, v69, v53, s[50:51]
v_cndmask_b32 v54, v70, v54, s[52:53]
v_cndmask_b32 v55, v71, v55, s[54:55]
v_cndmask_b32 v56, v72, v56, s[56:57]
v_cndmask_b32 v57, v73, v57, s[58:59]
v_cndmask_b32 v58, v74, v58, s[60:61]
v_cndmask_b32 v59, v75, v59, s[62:63]
v_cndmask_b32 v60, v76, v60, s[64:65]
s_add_u32 m0, s35, 86016
s_add_u32 s98, s34, 12288
buffer_load_dwordx4 v2, s[24:27], s98 offen offset:0 sc1 lds
v_cndmask_b32 v61, v77, v61, s[66:67]
v_cndmask_b32 v62, v78, v62, s[68:69]
v_cndmask_b32 v63, v79, v63, s[70:71]
v_exp_f32 v48, v48
v_exp_f32 v49, v49
v_exp_f32 v50, v50
v_exp_f32 v51, v51
v_exp_f32 v52, v52
buffer_load_dwordx4 v2, s[24:27], s98 offen offset:1024 sc1 lds
v_exp_f32 v53, v53
v_exp_f32 v54, v54
v_exp_f32 v55, v55
v_exp_f32 v56, v56
v_cvt_pk_bf16_f32 v120, v48, v49
v_cvt_pk_bf16_f32 v121, v50, v51
v_cvt_pk_bf16_f32 v122, v52, v53
v_cvt_pk_bf16_f32 v123, v54, v55
v_and_b32 v128, v120, v248
v_and_b32 v129, v121, v249
v_and_b32 v130, v122, v250
buffer_load_dwordx4 v2, s[24:27], s98 offen offset:2048 sc1 lds
v_and_b32 v131, v123, v251
v_xor_b32 v120, v120, v128
v_xor_b32 v121, v121, v129
v_xor_b32 v122, v122, v130
v_xor_b32 v123, v123, v131
v_mfma_f32_32x32x16_bf16 v[96:111], v[184:187], v[128:131], v[96:111]
v_exp_f32 v57, v57
v_exp_f32 v58, v58
v_exp_f32 v59, v59
v_exp_f32 v60, v60
buffer_load_dwordx4 v2, s[24:27], s98 offen offset:3072 sc1 lds
s_waitcnt vmcnt(16)
v_mfma_f32_32x32x16_bf16 v[96:111], a[192:195], v[120:123], v[96:111]
v_exp_f32 v61, v61
v_exp_f32 v62, v62
v_exp_f32 v63, v63
v_cvt_pk_bf16_f32 v124, v56, v57
v_cvt_pk_bf16_f32 v125, v58, v59
v_cvt_pk_bf16_f32 v126, v60, v61
v_cvt_pk_bf16_f32 v127, v62, v63
v_and_b32 v132, v124, v252
v_and_b32 v133, v125, v253
v_and_b32 v134, v126, v254
v_and_b32 v135, v127, v255
v_xor_b32 v124, v124, v132
v_xor_b32 v125, v125, v133
v_xor_b32 v126, v126, v134
v_xor_b32 v127, v127, v135
v_mfma_f32_32x32x16_bf16 v[96:111], v[188:191], v[132:135], v[96:111]
s_add_u32 s98, s32, 0
buffer_load_dwordx4 a[64:67], v2, s[24:27], s98 offen offset:0 sc1
s_waitcnt vmcnt(16)
v_mfma_f32_32x32x16_bf16 v[96:111], a[196:199], v[124:127], v[96:111]
s_nop 11
v_subrev_u32 v80, 0x21800000, v104
v_cmp_lt_u32 vcc, 0x3c000000, v80
s_nop 0
s_cbranch_vccnz L_fb_2071
L_fbret_2072:
v_rcp_f32 v104, v104
s_nop 0
v_pk_mul_f32 v[96:97], v[96:97], v[104:105] op_sel_hi:[1,0]
v_pk_mul_f32 v[98:99], v[98:99], v[104:105] op_sel_hi:[1,0]
v_pk_mul_f32 v[100:101], v[100:101], v[104:105] op_sel_hi:[1,0]
v_pk_mul_f32 v[102:103], v[102:103], v[104:105] op_sel_hi:[1,0]
v_cvt_pk_bf16_f32 v108, v96, v97
v_cvt_pk_bf16_f32 v109, v98, v99
v_cvt_pk_bf16_f32 v110, v100, v101
buffer_load_dwordx4 a[76:79], v2, s[24:27], s98 offen offset:1024 sc1
v_cvt_pk_bf16_f32 v111, v102, v103
buffer_store_dwordx4 v[108:111], v2, s[24:27], s8 offen sc1
s_add_u32 s8, s8, 32768
v_mfma_f32_32x32x16_bf16 v[32:47], v[176:179], v[204:207], 0
v_mfma_f32_32x32x16_bf16 v[48:63], v[236:239], v[204:207], 0
s_nop 10
v_exp_f32 v32, v32
v_exp_f32 v33, v33
buffer_load_dwordx4 a[88:91], v2, s[24:27], s98 offen offset:2048 sc1
v_exp_f32 v34, v34
v_exp_f32 v35, v35
v_exp_f32 v36, v36
v_exp_f32 v37, v37
v_exp_f32 v38, v38
v_exp_f32 v39, v39
v_exp_f32 v40, v40
v_cvt_pk_bf16_f32 v112, v32, v33
v_cvt_pk_bf16_f32 v113, v34, v35
v_cvt_pk_bf16_f32 v114, v36, v37
buffer_load_dwordx4 a[100:103], v2, s[24:27], s98 offen offset:3072 sc1
v_cvt_pk_bf16_f32 v115, v38, v39
v_exp_f32 v41, v41
v_exp_f32 v42, v42
v_mfma_f32_32x32x16_bf16 v[96:111], v[184:187], v[112:115], 0
v_exp_f32 v43, v43
v_exp_f32 v44, v44
v_exp_f32 v45, v45
v_exp_f32 v46, v46
s_add_u32 s98, s33, 16384
buffer_load_dwordx4 a[68:71], v2, s[24:27], s98 offen offset:0 sc1
v_exp_f32 v47, v47
v_cvt_pk_bf16_f32 v116, v40, v41
v_cvt_pk_bf16_f32 v117, v42, v43
v_cvt_pk_bf16_f32 v118, v44, v45
v_cvt_pk_bf16_f32 v119, v46, v47
v_mfma_f32_32x32x16_bf16 v[32:47], v[232:235], v[204:207], 0
v_exp_f32 v48, v48
v_exp_f32 v49, v49
v_exp_f32 v50, v50
buffer_load_dwordx4 a[80:83], v2, s[24:27], s98 offen offset:1024 sc1
v_exp_f32 v51, v51
v_mfma_f32_32x32x16_bf16 v[96:111], v[188:191], v[116:119], v[96:111]
v_exp_f32 v52, v52
v_exp_f32 v53, v53
v_exp_f32 v54, v54
v_exp_f32 v55, v55
v_exp_f32 v56, v56
v_cvt_pk_bf16_f32 v120, v48, v49
buffer_load_dwordx4 a[92:95], v2, s[24:27], s98 offen offset:2048 sc1
v_cvt_pk_bf16_f32 v121, v50, v51
v_cvt_pk_bf16_f32 v122, v52, v53
v_cvt_pk_bf16_f32 v123, v54, v55
v_exp_f32 v57, v57
v_exp_f32 v58, v58
v_mfma_f32_32x32x16_bf16 v[96:111], a[248:251], v[120:123], v[96:111]
v_exp_f32 v59, v59
v_exp_f32 v60, v60
v_exp_f32 v61, v61
buffer_load_dwordx4 a[104:107], v2, s[24:27], s98 offen offset:3072 sc1
v_exp_f32 v62, v62
v_exp_f32 v63, v63
v_cvt_pk_bf16_f32 v124, v56, v57
v_cvt_pk_bf16_f32 v125, v58, v59
v_cvt_pk_bf16_f32 v126, v60, v61
v_cvt_pk_bf16_f32 v127, v62, v63
v_mfma_f32_32x32x16_bf16 v[48:63], v[228:231], v[204:207], 0
v_exp_f32 v32, v32
v_exp_f32 v33, v33
s_lshl_b32 s81, s73, 11
s_add_u32 s81, s81, 12288
buffer_load_dwordx4 v[136:139], v2, s[24:27], s81 offen offset:0 sc1
v_exp_f32 v34, v34
v_exp_f32 v35, v35
v_mfma_f32_32x32x16_bf16 v[96:111], a[252:255], v[124:127], v[96:111]
v_exp_f32 v36, v36
v_exp_f32 v37, v37
v_exp_f32 v38, v38
v_exp_f32 v39, v39
v_exp_f32 v40, v40
buffer_load_dwordx4 v[140:143], v2, s[24:27], s81 offen offset:1024 sc1
v_cvt_pk_bf16_f32 v112, v32, v33
v_cvt_pk_bf16_f32 v113, v34, v35
v_cvt_pk_bf16_f32 v114, v36, v37
v_cvt_pk_bf16_f32 v115, v38, v39
v_exp_f32 v41, v41
v_exp_f32 v42, v42
v_mfma_f32_32x32x16_bf16 v[96:111], a[240:243], v[112:115], v[96:111]
v_exp_f32 v43, v43
v_exp_f32 v44, v44
v_exp_f32 v45, v45
s_add_u32 s98, s33, 32768
buffer_load_dwordx4 a[72:75], v2, s[24:27], s98 offen offset:0 sc1
v_exp_f32 v46, v46
v_exp_f32 v47, v47
v_cvt_pk_bf16_f32 v116, v40, v41
v_cvt_pk_bf16_f32 v117, v42, v43
v_cvt_pk_bf16_f32 v118, v44, v45
v_cvt_pk_bf16_f32 v119, v46, v47
v_mfma_f32_32x32x16_bf16 v[32:47], v[224:227], v[204:207], 0
v_exp_f32 v48, v48
v_exp_f32 v49, v49
v_exp_f32 v50, v50
v_exp_f32 v51, v51
v_mfma_f32_32x32x16_bf16 v[96:111], a[244:247], v[116:119], v[96:111]
v_exp_f32 v52, v52
v_exp_f32 v53, v53
v_exp_f32 v54, v54
v_exp_f32 v55, v55
v_exp_f32 v56, v56
v_cvt_pk_bf16_f32 v120, v48, v49
v_cvt_pk_bf16_f32 v121, v50, v51
v_cvt_pk_bf16_f32 v122, v52, v53
v_cvt_pk_bf16_f32 v123, v54, v55
v_exp_f32 v57, v57
v_exp_f32 v58, v58
v_mfma_f32_32x32x16_bf16 v[96:111], a[232:235], v[120:123], v[96:111]
v_exp_f32 v59, v59
v_exp_f32 v60, v60
v_exp_f32 v61, v61
v_exp_f32 v62, v62
v_exp_f32 v63, v63
v_cvt_pk_bf16_f32 v124, v56, v57
v_cvt_pk_bf16_f32 v125, v58, v59
v_cvt_pk_bf16_f32 v126, v60, v61
v_cvt_pk_bf16_f32 v127, v62, v63
v_mfma_f32_32x32x16_bf16 v[48:63], v[220:223], v[204:207], 0
v_exp_f32 v32, v32
s_waitcnt vmcnt(9)
buffer_store_dword v15, v14, s[24:27], s19 offen offset:0 sc1
v_exp_f32 v33, v33
v_exp_f32 v34, v34
v_exp_f32 v35, v35
v_mfma_f32_32x32x16_bf16 v[96:111], a[236:239], v[124:127], v[96:111]
v_exp_f32 v36, v36
v_exp_f32 v37, v37
v_exp_f32 v38, v38
v_exp_f32 v39, v39
v_exp_f32 v40, v40
buffer_load_dwordx4 a[84:87], v2, s[24:27], s98 offen offset:1024 sc1
v_cvt_pk_bf16_f32 v112, v32, v33
v_cvt_pk_bf16_f32 v113, v34, v35
v_cvt_pk_bf16_f32 v114, v36, v37
v_cvt_pk_bf16_f32 v115, v38, v39
v_exp_f32 v41, v41
v_exp_f32 v42, v42
v_mfma_f32_32x32x16_bf16 v[96:111], a[224:227], v[112:115], v[96:111]
v_exp_f32 v43, v43
v_exp_f32 v44, v44
buffer_load_dwordx4 a[96:99], v2, s[24:27], s98 offen offset:2048 sc1
v_exp_f32 v45, v45
v_exp_f32 v46, v46
v_exp_f32 v47, v47
v_cvt_pk_bf16_f32 v116, v40, v41
v_cvt_pk_bf16_f32 v117, v42, v43
v_cvt_pk_bf16_f32 v118, v44, v45
v_cvt_pk_bf16_f32 v119, v46, v47
v_mfma_f32_32x32x16_bf16 v[32:47], v[216:219], v[204:207], 0
v_exp_f32 v48, v48
v_exp_f32 v49, v49
buffer_load_dwordx4 a[108:111], v2, s[24:27], s98 offen offset:3072 sc1
v_exp_f32 v50, v50
v_exp_f32 v51, v51
v_mfma_f32_32x32x16_bf16 v[96:111], a[228:231], v[116:119], v[96:111]
v_exp_f32 v52, v52
v_exp_f32 v53, v53
v_exp_f32 v54, v54
v_exp_f32 v55, v55
v_exp_f32 v56, v56
v_cvt_pk_bf16_f32 v120, v48, v49
s_add_u32 s98, s32, 4096
buffer_load_dwordx4 a[112:115], v2, s[24:27], s98 offen offset:0 sc1
v_cvt_pk_bf16_f32 v121, v50, v51
v_cvt_pk_bf16_f32 v122, v52, v53
v_cvt_pk_bf16_f32 v123, v54, v55
v_exp_f32 v57, v57
v_exp_f32 v58, v58
v_mfma_f32_32x32x16_bf16 v[96:111], a[216:219], v[120:123], v[96:111]
v_exp_f32 v59, v59
v_exp_f32 v60, v60
v_exp_f32 v61, v61
buffer_load_dwordx4 a[124:127], v2, s[24:27], s98 offen offset:1024 sc1
v_exp_f32 v62, v62
v_exp_f32 v63, v63
v_cvt_pk_bf16_f32 v124, v56, v57
v_cvt_pk_bf16_f32 v125, v58, v59
v_cvt_pk_bf16_f32 v126, v60, v61
v_cvt_pk_bf16_f32 v127, v62, v63
v_mfma_f32_32x32x16_bf16 v[48:63], v[180:183], v[204:207], 0
v_exp_f32 v32, v32
v_exp_f32 v33, v33
buffer_load_dwordx4 a[136:139], v2, s[24:27], s98 offen offset:2048 sc1
v_exp_f32 v34, v34
v_exp_f32 v35, v35
v_mfma_f32_32x32x16_bf16 v[96:111], a[220:223], v[124:127], v[96:111]
v_exp_f32 v36, v36
v_exp_f32 v37, v37
v_exp_f32 v38, v38
v_exp_f32 v39, v39
v_exp_f32 v40, v40
buffer_load_dwordx4 a[148:151], v2, s[24:27], s98 offen offset:3072 sc1
v_cvt_pk_bf16_f32 v112, v32, v33
v_cvt_pk_bf16_f32 v113, v34, v35
v_cvt_pk_bf16_f32 v114, v36, v37
v_cvt_pk_bf16_f32 v115, v38, v39
v_exp_f32 v41, v41
v_exp_f32 v42, v42
v_mfma_f32_32x32x16_bf16 v[96:111], a[208:211], v[112:115], v[96:111]
v_exp_f32 v43, v43
v_exp_f32 v44, v44
v_exp_f32 v45, v45
s_add_u32 s98, s33, 20480
buffer_load_dwordx4 a[116:119], v2, s[24:27], s98 offen offset:0 sc1
v_exp_f32 v46, v46
v_exp_f32 v47, v47
v_mfma_f32_32x32x16_bf16 v[64:79], v[212:215], v[204:207], 0
v_cvt_pk_bf16_f32 v116, v40, v41
v_cvt_pk_bf16_f32 v117, v42, v43
v_cvt_pk_bf16_f32 v118, v44, v45
v_cvt_pk_bf16_f32 v119, v46, v47
s_nop 1
v_mfma_f32_32x32x16_bf16 v[96:111], a[212:215], v[116:119], v[96:111]
buffer_load_dwordx4 a[128:131], v2, s[24:27], s98 offen offset:1024 sc1
s_waitcnt vmcnt(12)
v_cmp_ne_u32 vcc, s72, v137
v_cmp_ne_u32 s[86:87], s72, v139
s_nop 0
s_or_b64 vcc, vcc, s[86:87]
s_waitcnt vmcnt(11)
v_cmp_ne_u32 s[86:87], s72, v141
s_nop 0
s_or_b64 vcc, vcc, s[86:87]
v_cmp_ne_u32 s[86:87], s72, v143
s_nop 0
s_or_b64 vcc, vcc, s[86:87]
s_cbranch_vccnz L_poll_3090
L_ret_3091:
v_mov_b32 v137, v138
v_mov_b32 v141, v142
s_lshl_b32 s79, s73, 10
v_lshl_add_u32 v7, v0, 3, s79
ds_write_b64 v7, v[136:137] offset:2048
ds_write_b64 v7, v[140:141] offset:2560
s_waitcnt lgkmcnt(0)
s_barrier
v_cndmask_b32 v48, v64, v48, s[40:41]
v_cndmask_b32 v49, v65, v49, s[42:43]
v_cndmask_b32 v50, v66, v50, s[44:45]
v_cndmask_b32 v51, v67, v51, s[46:47]
buffer_load_dwordx4 a[140:143], v2, s[24:27], s98 offen offset:2048 sc1
v_cndmask_b32 v52, v68, v52, s[48:49]
v_cndmask_b32 v53, v69, v53, s[50:51]
v_cndmask_b32 v54, v70, v54, s[52:53]
v_cndmask_b32 v55, v71, v55, s[54:55]
v_cndmask_b32 v56, v72, v56, s[56:57]
v_cndmask_b32 v57, v73, v57, s[58:59]
v_cndmask_b32 v58, v74, v58, s[60:61]
v_cndmask_b32 v59, v75, v59, s[62:63]
v_cndmask_b32 v60, v76, v60, s[64:65]
v_cndmask_b32 v61, v77, v61, s[66:67]
v_cndmask_b32 v62, v78, v62, s[68:69]
v_cndmask_b32 v63, v79, v63, s[70:71]
v_exp_f32 v48, v48
v_exp_f32 v49, v49
buffer_load_dwordx4 a[152:155], v2, s[24:27], s98 offen offset:3072 sc1
v_exp_f32 v50, v50
v_exp_f32 v51, v51
v_exp_f32 v52, v52
v_exp_f32 v53, v53
v_exp_f32 v54, v54
v_exp_f32 v55, v55
v_exp_f32 v56, v56
s_add_u32 s98, s33, 36864
buffer_load_dwordx4 a[120:123], v2, s[24:27], s98 offen offset:0 sc1
v_cvt_pk_bf16_f32 v120, v48, v49
v_cvt_pk_bf16_f32 v121, v50, v51
v_cvt_pk_bf16_f32 v122, v52, v53
v_cvt_pk_bf16_f32 v123, v54, v55
v_and_b32 v128, v120, v248
v_and_b32 v129, v121, v249
v_and_b32 v130, v122, v250
v_and_b32 v131, v123, v251
v_xor_b32 v120, v120, v128
v_xor_b32 v121, v121, v129
v_xor_b32 v122, v122, v130
v_xor_b32 v123, v123, v131
v_mfma_f32_32x32x16_bf16 v[96:111], v[192:195], v[128:131], v[96:111]
buffer_load_dwordx4 a[132:135], v2, s[24:27], s98 offen offset:1024 sc1
v_exp_f32 v57, v57
v_exp_f32 v58, v58
v_exp_f32 v59, v59
v_exp_f32 v60, v60
v_mfma_f32_32x32x16_bf16 v[96:111], a[200:203], v[120:123], v[96:111]
v_exp_f32 v61, v61
v_exp_f32 v62, v62
v_exp_f32 v63, v63
buffer_load_dwordx4 a[144:147], v2, s[24:27], s98 offen offset:2048 sc1
v_cvt_pk_bf16_f32 v124, v56, v57
v_cvt_pk_bf16_f32 v125, v58, v59
v_cvt_pk_bf16_f32 v126, v60, v61
v_cvt_pk_bf16_f32 v127, v62, v63
v_and_b32 v132, v124, v252
v_and_b32 v133, v125, v253
v_and_b32 v134, v126, v254
v_and_b32 v135, v127, v255
v_xor_b32 v124, v124, v132
v_xor_b32 v125, v125, v133
v_xor_b32 v126, v126, v134
v_xor_b32 v127, v127, v135
v_mfma_f32_32x32x16_bf16 v[96:111], v[196:199], v[132:135], v[96:111]
s_nop 0
v_mfma_f32_32x32x16_bf16 v[96:111], a[204:207], v[124:127], v[96:111]
buffer_load_dwordx4 a[156:159], v2, s[24:27], s98 offen offset:3072 sc1
s_nop 10
v_subrev_u32 v80, 0x21800000, v104
v_cmp_lt_u32 vcc, 0x3c000000, v80
s_nop 0
s_cbranch_vccnz L_fb_3092
L_fbret_3093:
v_rcp_f32 v104, v104
s_nop 0
v_pk_mul_f32 v[96:97], v[96:97], v[104:105] op_sel_hi:[1,0]
v_pk_mul_f32 v[98:99], v[98:99], v[104:105] op_sel_hi:[1,0]
v_pk_mul_f32 v[100:101], v[100:101], v[104:105] op_sel_hi:[1,0]
v_pk_mul_f32 v[102:103], v[102:103], v[104:105] op_sel_hi:[1,0]
v_cvt_pk_bf16_f32 v108, v96, v97
v_cvt_pk_bf16_f32 v109, v98, v99
s_add_u32 s98, s32, 8192
buffer_load_dwordx4 a[160:163], v2, s[24:27], s98 offen offset:0 sc1
v_cvt_pk_bf16_f32 v110, v100, v101
v_cvt_pk_bf16_f32 v111, v102, v103
buffer_store_dwordx4 v[108:111], v2, s[24:27], s8 offen sc1
s_mul_i32 s99, s73, 6144
s_add_u32 s99, s99, 139264
v_add_u32 v108, s99, v2
s_xor_b32 s99, s73, 1
s_mul_i32 s99, s99, 6144
s_add_u32 s99, s99, 139264
v_add_u32 v109, s99, v2
s_xor_b32 s99, s73, 2
s_mul_i32 s99, s99, 6144
s_add_u32 s99, s99, 139264
buffer_load_dword v8, v13, s[24:27], s20 offen offset:0 sc1
v_add_u32 v110, s99, v2
s_xor_b32 s99, s73, 3
s_mul_i32 s99, s99, 6144
s_add_u32 s99, s99, 139264
v_add_u32 v111, s99, v2
v_lshrrev_b32 v1, 5, v0
s_lshl_b32 s99, s76, 5
v_lshl_add_u32 v12, v1, 3, s99
ds_read_b64 v[80:81], v12 offset:2048
ds_read_b64 v[82:83], v12 offset:2064
s_waitcnt lgkmcnt(1)
v_lshlrev_b32 v64, 16, v80
buffer_load_dwordx4 a[172:175], v2, s[24:27], s98 offen offset:1024 sc1
v_and_b32 v65, s85, v80
v_lshlrev_b32 v66, 16, v81
v_and_b32 v67, s85, v81
s_waitcnt lgkmcnt(0)
v_lshlrev_b32 v68, 16, v82
v_and_b32 v69, s85, v82
v_lshlrev_b32 v70, 16, v83
v_and_b32 v71, s85, v83
ds_read_b64 v[84:85], v12 offset:4096
s_add_u32 s98, s33, 24576
buffer_load_dwordx4 a[164:167], v2, s[24:27], s98 offen offset:0 sc1
ds_read_b64 v[86:87], v12 offset:4112
s_waitcnt lgkmcnt(1)
v_lshlrev_b32 v72, 16, v84
buffer_load_dwordx4 a[176:179], v2, s[24:27], s98 offen offset:1024 sc1
v_and_b32 v73, s85, v84
v_lshlrev_b32 v74, 16, v85
v_and_b32 v75, s85, v85
s_waitcnt lgkmcnt(0)
v_lshlrev_b32 v76, 16, v86
v_and_b32 v77, s85, v86
v_lshlrev_b32 v78, 16, v87
v_and_b32 v79, s85, v87
v_lshlrev_b32 v16, 16, v20
v_and_b32 v17, s85, v20
v_lshlrev_b32 v18, 16, v21
s_add_u32 s98, s33, 40960
buffer_load_dwordx4 a[168:171], v2, s[24:27], s98 offen offset:0 sc1
v_and_b32 v19, s85, v21
v_lshlrev_b32 v20, 16, v22
v_and_b32 v21, s85, v22
v_lshlrev_b32 v22, 16, v23
v_and_b32 v23, s85, v23
v_bfe_u32 v3, v0, 4, 1
v_lshlrev_b32 v3, 14, v3
v_and_b32 v7, 15, v0
v_lshl_add_u32 v3, v7, 4, v3
v_lshl_add_u32 v3, v1, 8, v3
buffer_load_dwordx4 a[180:183], v2, s[24:27], s98 offen offset:1024 sc1
v_and_b32 v5, 31, v0
v_lshlrev_b32 v10, 2, v5
v_lshlrev_b32 v6, 3, v5
v_mov_b32 v9, v6
v_lshl_add_u32 v7, v1, 2, v6
s_lshl_b32 s99, s73, 8
v_add_u32 v7, s99, v7
v_lshlrev_b32 v5, 4, v5
v_lshl_add_u32 v11, v1, 12, v5
v_lshl_add_u32 v5, v1, 25, v5
s_add_u32 s98, s32, 8192
buffer_load_dwordx4 a[184:187], v2, s[24:27], s98 offen offset:2048 sc1
s_waitcnt vmcnt(6)
v_cmp_ne_u32 vcc, s72, v8
s_nop 0
s_cbranch_vccnz L_poll_3088
L_ret_3089:
buffer_store_dword v15, v14, s[24:27], s19 offen offset:128 sc1
s_add_u32 s99, s35, 73728
v_add_u32 v142, s99, v2
ds_read_b128 a[4:7], v142 offset:1024
ds_read_b128 a[12:15], v142 offset:3072
ds_read_b128 a[20:23], v142 offset:5120
s_add_u32 s101, s9, 0
buffer_load_dwordx4 v[144:147], v2, s[24:27], s101 offen offset:0 sc1
buffer_load_dwordx4 v[148:151], v2, s[24:27], s101 offen offset:1024 sc1
buffer_load_dwordx4 v[152:155], v2, s[24:27], s101 offen offset:2048 sc1
buffer_load_dwordx4 v[156:159], v2, s[24:27], s101 offen offset:3072 sc1
s_waitcnt vmcnt(3) lgkmcnt(2)
v_mfma_f32_32x32x16_bf16 v[48:63], a[4:7], v[144:147], 0
s_add_u32 s101, s9, 4096
buffer_load_dwordx4 v[160:163], v2, s[24:27], s101 offen offset:0 sc1
ds_read_b128 a[28:31], v142 offset:7168
s_waitcnt vmcnt(3) lgkmcnt(2)
v_mfma_f32_32x32x16_bf16 v[48:63], a[12:15], v[148:151], v[48:63]
buffer_load_dwordx4 v[164:167], v2, s[24:27], s101 offen offset:1024 sc1
ds_read_b128 a[36:39], v142 offset:9216
s_waitcnt vmcnt(3) lgkmcnt(2)
v_mfma_f32_32x32x16_bf16 v[48:63], a[20:23], v[152:155], v[48:63]
buffer_load_dwordx4 v[168:171], v2, s[24:27], s101 offen offset:2048 sc1
ds_read_b128 a[44:47], v142 offset:11264
s_waitcnt vmcnt(3) lgkmcnt(2)
v_mfma_f32_32x32x16_bf16 v[48:63], a[28:31], v[156:159], v[48:63]
buffer_load_dwordx4 v[172:175], v2, s[24:27], s101 offen offset:3072 sc1
ds_read_b128 a[52:55], v142 offset:13312
buffer_load_dwordx4 a[196:199], v2, s[24:27], s98 offen offset:3072 sc1
s_add_u32 s98, s33, 24576
buffer_load_dwordx4 a[188:191], v2, s[24:27], s98 offen offset:2048 sc1
buffer_load_dwordx4 a[200:203], v2, s[24:27], s98 offen offset:3072 sc1
s_add_u32 s98, s33, 40960
buffer_load_dwordx4 a[192:195], v2, s[24:27], s98 offen offset:2048 sc1
buffer_load_dwordx4 a[204:207], v2, s[24:27], s98 offen offset:3072 sc1
s_waitcnt vmcnt(8) lgkmcnt(2)
v_mfma_f32_32x32x16_bf16 v[48:63], a[36:39], v[160:163], v[48:63]
buffer_load_dword v4, v13, s[24:27], s20 offen offset:128 sc1
ds_read_b128 a[60:63], v142 offset:15360
s_waitcnt vmcnt(8) lgkmcnt(2)
v_mfma_f32_32x32x16_bf16 v[48:63], a[44:47], v[164:167], v[48:63]
s_add_u32 s98, s32, 12288
buffer_load_dwordx4 a[208:211], v2, s[24:27], s98 offen offset:0 sc1
ds_read_b128 a[0:3], v142 offset:0
s_waitcnt vmcnt(8) lgkmcnt(2)
v_mfma_f32_32x32x16_bf16 v[48:63], a[52:55], v[168:171], v[48:63]
buffer_load_dwordx4 a[220:223], v2, s[24:27], s98 offen offset:1024 sc1
ds_read_b128 a[8:11], v142 offset:2048
s_waitcnt vmcnt(8) lgkmcnt(2)
v_mfma_f32_32x32x16_bf16 v[48:63], a[60:63], v[172:175], v[48:63]
buffer_load_dwordx4 a[232:235], v2, s[24:27], s98 offen offset:2048 sc1
ds_read_b128 a[16:19], v142 offset:4096
s_waitcnt lgkmcnt(2)
v_mfma_f32_32x32x16_bf16 v[32:47], a[0:3], v[144:147], 0
ds_read_b128 a[24:27], v142 offset:6144
s_waitcnt lgkmcnt(2)
v_mfma_f32_32x32x16_bf16 v[32:47], a[8:11], v[148:151], v[32:47]
buffer_load_dwordx4 a[244:247], v2, s[24:27], s98 offen offset:3072 sc1
ds_read_b128 a[32:35], v142 offset:8192
s_waitcnt lgkmcnt(2)
v_mfma_f32_32x32x16_bf16 v[32:47], a[16:19], v[152:155], v[32:47]
s_add_u32 s98, s33, 28672
buffer_load_dwordx4 a[212:215], v2, s[24:27], s98 offen offset:0 sc1
ds_read_b128 a[40:43], v142 offset:10240
ds_write_b128 v110, v[48:51] offset:2048
buffer_load_dwordx4 a[224:227], v2, s[24:27], s98 offen offset:1024 sc1
s_waitcnt lgkmcnt(3)
v_mfma_f32_32x32x16_bf16 v[32:47], a[24:27], v[156:159], v[32:47]
ds_read_b128 a[48:51], v142 offset:12288
s_waitcnt lgkmcnt(3)
v_mfma_f32_32x32x16_bf16 v[32:47], a[32:35], v[160:163], v[32:47]
buffer_load_dwordx4 a[236:239], v2, s[24:27], s98 offen offset:2048 sc1
ds_read_b128 a[56:59], v142 offset:14336
ds_write_b128 v110, v[52:55] offset:3072
buffer_load_dwordx4 a[248:251], v2, s[24:27], s98 offen offset:3072 sc1
s_waitcnt lgkmcnt(4)
v_mfma_f32_32x32x16_bf16 v[32:47], a[40:43], v[164:167], v[32:47]
s_waitcnt lgkmcnt(2)
v_mfma_f32_32x32x16_bf16 v[32:47], a[48:51], v[168:171], v[32:47]
ds_write_b128 v111, v[56:59] offset:4096
s_add_u32 s98, s33, 45056
buffer_load_dwordx4 a[216:219], v2, s[24:27], s98 offen offset:0 sc1
s_waitcnt lgkmcnt(2)
v_mfma_f32_32x32x16_bf16 v[32:47], a[56:59], v[172:175], v[32:47]
ds_write_b128 v111, v[60:63] offset:5120
buffer_load_dwordx4 a[228:231], v2, s[24:27], s98 offen offset:1024 sc1
s_nop 9
ds_write_b128 v109, v[40:43] offset:0
ds_write_b128 v109, v[44:47] offset:1024
s_waitcnt lgkmcnt(0)
s_barrier
s_waitcnt vmcnt(10)
v_cmp_ne_u32 vcc, s72, v4
s_nop 0
s_cbranch_vccnz L_poll_4107
L_ret_4108:
ds_read_b128 v[80:83], v108 offset:0
ds_read_b128 v[84:87], v108 offset:1024
ds_read_b128 v[88:91], v108 offset:2048
ds_read_b128 v[92:95], v108 offset:3072
s_add_u32 s101, s9, 32768
buffer_load_dwordx4 v[144:147], v2, s[24:27], s101 offen offset:0 sc1
ds_read_b128 v[96:99], v108 offset:4096
ds_read_b128 v[100:103], v108 offset:5120
s_waitcnt lgkmcnt(5)
v_pk_add_f32 v[32:33], v[32:33], v[80:81]
v_pk_add_f32 v[34:35], v[34:35], v[82:83]
buffer_load_dwordx4 v[148:151], v2, s[24:27], s101 offen offset:1024 sc1
s_waitcnt lgkmcnt(4)
v_pk_add_f32 v[36:37], v[36:37], v[84:85]
v_pk_add_f32 v[38:39], v[38:39], v[86:87]
s_waitcnt lgkmcnt(1)
v_pk_add_f32 v[88:89], v[88:89], v[96:97]
v_pk_add_f32 v[90:91], v[90:91], v[98:99]
s_waitcnt lgkmcnt(0)
v_pk_add_f32 v[92:93], v[92:93], v[100:101]
buffer_load_dwordx4 v[152:155], v2, s[24:27], s101 offen offset:2048 sc1
v_pk_add_f32 v[94:95], v[94:95], v[102:103]
v_pk_add_f32 v[32:33], v[32:33], v[88:89]
v_pk_add_f32 v[34:35], v[34:35], v[90:91]
v_pk_add_f32 v[36:37], v[36:37], v[92:93]
v_pk_add_f32 v[38:39], v[38:39], v[94:95]
v_pk_fma_f32 v[16:17], v[64:65], v[32:33], v[16:17]
v_pk_fma_f32 v[18:19], v[66:67], v[34:35], v[18:19]
v_pk_fma_f32 v[20:21], v[68:69], v[36:37], v[20:21]
v_pk_fma_f32 v[22:23], v[70:71], v[38:39], v[22:23]
v_pk_mul_f32 v[32:33], v[72:73], v[16:17]
v_pk_mul_f32 v[34:35], v[74:75], v[18:19]
v_pk_mul_f32 v[36:37], v[76:77], v[20:21]
v_pk_mul_f32 v[38:39], v[78:79], v[22:23]
v_cvt_pk_bf16_f32 v104, v32, v33
v_cvt_pk_bf16_f32 v105, v34, v35
buffer_load_dwordx4 v[156:159], v2, s[24:27], s101 offen offset:3072 sc1
v_cvt_pk_bf16_f32 v106, v36, v37
v_cvt_pk_bf16_f32 v107, v38, v39
buffer_store_dwordx4 v[104:107], v3, s[24:27], s10 offen sc1
v_add_f32 v40, v16, v17
v_mul_f32 v41, v16, v16
v_fmac_f32 v41, v17, v17
v_add_f32 v40, v40, v18
v_fmac_f32 v41, v18, v18
v_add_f32 v40, v40, v19
v_fmac_f32 v41, v19, v19
v_add_f32 v40, v40, v20
v_fmac_f32 v41, v20, v20
v_add_f32 v40, v40, v21
v_fmac_f32 v41, v21, v21
v_add_f32 v40, v40, v22
v_fmac_f32 v41, v22, v22
v_add_f32 v40, v40, v23
v_fmac_f32 v41, v23, v23
s_add_u32 s101, s9, 36864
buffer_load_dwordx4 v[160:163], v2, s[24:27], s101 offen offset:0 sc1
v_permlane32_swap_b32 v40, v41
v_add_f32 v40, v40, v41
ds_write_b32 v7, v40 offset:6144
s_add_u32 s10, s10, 32768
s_waitcnt lgkmcnt(0)
s_barrier
buffer_load_dwordx4 v[164:167], v2, s[24:27], s101 offen offset:1024 sc1
ds_read_b64 v[32:33], v6 offset:6144
ds_read_b64 v[34:35], v6 offset:6400
ds_read_b64 v[36:37], v6 offset:6656
ds_read_b64 v[38:39], v6 offset:6912
s_waitcnt lgkmcnt(2)
v_pk_add_f32 v[32:33], v[32:33], v[34:35]
buffer_load_dwordx4 v[168:171], v2, s[24:27], s101 offen offset:2048 sc1
s_waitcnt lgkmcnt(0)
v_pk_add_f32 v[36:37], v[36:37], v[38:39]
v_pk_add_f32 v[32:33], v[32:33], v[36:37]
v_mov_b32 v34, v15
v_mov_b32 v35, v15
buffer_store_dwordx4 v[32:35], v5, s[24:27], s22 offen offset:0 sc1
v_lshlrev_b32 v24, 16, v28
v_and_b32 v25, s85, v28
v_lshlrev_b32 v26, 16, v29
v_and_b32 v27, s85, v29
v_lshlrev_b32 v28, 16, v30
v_and_b32 v29, s85, v30
v_lshlrev_b32 v30, 16, v31
v_and_b32 v31, s85, v31
v_and_b32 v141, 1, v0
v_lshlrev_b32 v141, 10, v141
buffer_load_dwordx4 v[172:175], v2, s[24:27], s101 offen offset:3072 sc1
v_sub_u32 v141, 4096, v141
v_lshrrev_b32 v140, 5, v0
v_lshl_add_u32 v141, v140, 5, v141
v_bfe_u32 v140, v0, 4, 1
v_lshl_add_u32 v141, v140, 3, v141
ds_read2_b64 v[124:127], v141 offset0:0 offset1:2
ds_read2_b64 v[128:131], v141 offset0:8 offset1:10
ds_read2_b64 v[132:135], v141 offset0:16 offset1:18
s_waitcnt lgkmcnt(2)
v_mfma_f32_16x16x32_bf16 v[112:115], a[64:67], v[124:127], 0
buffer_load_dwordx4 a[240:243], v2, s[24:27], s98 offen offset:2048 sc1
ds_read2_b64 v[136:139], v141 offset0:24 offset1:26
v_mfma_f32_16x16x32_bf16 v[116:119], a[68:71], v[124:127], 0
v_mfma_f32_16x16x32_bf16 v[120:123], a[72:75], v[124:127], 0
s_waitcnt lgkmcnt(2)
v_mfma_f32_16x16x32_bf16 v[112:115], a[76:79], v[128:131], v[112:115]
buffer_load_dwordx4 a[252:255], v2, s[24:27], s98 offen offset:3072 sc1
ds_read2_b64 v[124:127], v141 offset0:32 offset1:34
v_mfma_f32_16x16x32_bf16 v[116:119], a[80:83], v[128:131], v[116:119]
v_mfma_f32_16x16x32_bf16 v[120:123], a[84:87], v[128:131], v[120:123]
s_waitcnt lgkmcnt(2)
v_mfma_f32_16x16x32_bf16 v[112:115], a[88:91], v[132:135], v[112:115]
ds_read2_b64 v[128:131], v141 offset0:40 offset1:42
v_mfma_f32_16x16x32_bf16 v[116:119], a[92:95], v[132:135], v[116:119]
v_mfma_f32_16x16x32_bf16 v[120:123], a[96:99], v[132:135], v[120:123]
s_waitcnt lgkmcnt(2)
v_mfma_f32_16x16x32_bf16 v[112:115], a[100:103], v[136:139], v[112:115]
v_mfma_f32_16x16x32_bf16 v[116:119], a[104:107], v[136:139], v[116:119]
v_mfma_f32_16x16x32_bf16 v[120:123], a[108:111], v[136:139], v[120:123]
s_waitcnt lgkmcnt(1)
v_mfma_f32_16x16x32_bf16 v[112:115], a[112:115], v[124:127], v[112:115]
v_mfma_f32_16x16x32_bf16 v[116:119], a[116:119], v[124:127], v[116:119]
v_mfma_f32_16x16x32_bf16 v[120:123], a[120:123], v[124:127], v[120:123]
s_waitcnt lgkmcnt(0)
v_mfma_f32_16x16x32_bf16 v[112:115], a[124:127], v[128:131], v[112:115]
v_mfma_f32_16x16x32_bf16 v[116:119], a[128:131], v[128:131], v[116:119]
v_mfma_f32_16x16x32_bf16 v[120:123], a[132:135], v[128:131], v[120:123]
s_waitcnt vmcnt(11)
v_mfma_f32_32x32x16_bf16 v[48:63], a[4:7], v[144:147], 0
s_waitcnt vmcnt(10)
v_mfma_f32_32x32x16_bf16 v[48:63], a[12:15], v[148:151], v[48:63]
s_waitcnt vmcnt(9)
v_mfma_f32_32x32x16_bf16 v[48:63], a[20:23], v[152:155], v[48:63]
s_waitcnt vmcnt(8)
v_mfma_f32_32x32x16_bf16 v[48:63], a[28:31], v[156:159], v[48:63]
s_waitcnt vmcnt(7)
buffer_store_dword v15, v14, s[24:27], s19 offen offset:256 sc1
s_waitcnt vmcnt(7)
v_mfma_f32_32x32x16_bf16 v[48:63], a[36:39], v[160:163], v[48:63]
s_waitcnt vmcnt(6)
v_mfma_f32_32x32x16_bf16 v[48:63], a[44:47], v[164:167], v[48:63]
s_waitcnt vmcnt(5)
v_mfma_f32_32x32x16_bf16 v[48:63], a[52:55], v[168:171], v[48:63]
s_waitcnt vmcnt(3)
v_mfma_f32_32x32x16_bf16 v[48:63], a[60:63], v[172:175], v[48:63]
v_mfma_f32_32x32x16_bf16 v[32:47], a[0:3], v[144:147], 0
v_mfma_f32_32x32x16_bf16 v[32:47], a[8:11], v[148:151], v[32:47]
v_mfma_f32_32x32x16_bf16 v[32:47], a[16:19], v[152:155], v[32:47]
s_nop 8
ds_write_b128 v110, v[48:51] offset:2048
v_mfma_f32_32x32x16_bf16 v[32:47], a[24:27], v[156:159], v[32:47]
v_mfma_f32_32x32x16_bf16 v[32:47], a[32:35], v[160:163], v[32:47]
ds_write_b128 v110, v[52:55] offset:3072
v_mfma_f32_32x32x16_bf16 v[32:47], a[40:43], v[164:167], v[32:47]
v_mfma_f32_32x32x16_bf16 v[32:47], a[48:51], v[168:171], v[32:47]
ds_write_b128 v111, v[56:59] offset:4096
v_mfma_f32_32x32x16_bf16 v[32:47], a[56:59], v[172:175], v[32:47]
ds_write_b128 v111, v[60:63] offset:5120
s_nop 10
ds_write_b128 v109, v[40:43] offset:0
ds_write_b128 v109, v[44:47] offset:1024
s_waitcnt lgkmcnt(0)
s_barrier
ds_read_b128 v[80:83], v108 offset:0
ds_read_b128 v[84:87], v108 offset:1024
ds_read_b128 v[88:91], v108 offset:2048
ds_read_b128 v[92:95], v108 offset:3072
ds_read_b128 v[96:99], v108 offset:4096
ds_read_b128 v[100:103], v108 offset:5120
s_waitcnt lgkmcnt(5)
v_pk_add_f32 v[32:33], v[32:33], v[80:81]
v_pk_add_f32 v[34:35], v[34:35], v[82:83]
s_waitcnt lgkmcnt(4)
v_pk_add_f32 v[36:37], v[36:37], v[84:85]
v_pk_add_f32 v[38:39], v[38:39], v[86:87]
s_waitcnt lgkmcnt(1)
v_pk_add_f32 v[88:89], v[88:89], v[96:97]
v_pk_add_f32 v[90:91], v[90:91], v[98:99]
s_waitcnt lgkmcnt(0)
v_pk_add_f32 v[92:93], v[92:93], v[100:101]
v_pk_add_f32 v[94:95], v[94:95], v[102:103]
v_pk_add_f32 v[32:33], v[32:33], v[88:89]
v_pk_add_f32 v[34:35], v[34:35], v[90:91]
v_pk_add_f32 v[36:37], v[36:37], v[92:93]
v_pk_add_f32 v[38:39], v[38:39], v[94:95]
v_pk_fma_f32 v[24:25], v[64:65], v[32:33], v[24:25]
v_pk_fma_f32 v[26:27], v[66:67], v[34:35], v[26:27]
v_pk_fma_f32 v[28:29], v[68:69], v[36:37], v[28:29]
v_pk_fma_f32 v[30:31], v[70:71], v[38:39], v[30:31]
v_pk_mul_f32 v[32:33], v[72:73], v[24:25]
v_pk_mul_f32 v[34:35], v[74:75], v[26:27]
v_pk_mul_f32 v[36:37], v[76:77], v[28:29]
buffer_load_dword v8, v13, s[24:27], s20 offen offset:256 sc1
v_pk_mul_f32 v[38:39], v[78:79], v[30:31]
v_cvt_pk_bf16_f32 v104, v32, v33
v_cvt_pk_bf16_f32 v105, v34, v35
v_cvt_pk_bf16_f32 v106, v36, v37
v_cvt_pk_bf16_f32 v107, v38, v39
buffer_store_dwordx4 v[104:107], v3, s[24:27], s10 offen sc1
v_add_f32 v40, v24, v25
v_mul_f32 v41, v24, v24
v_fmac_f32 v41, v25, v25
v_add_f32 v40, v40, v26
v_fmac_f32 v41, v26, v26
v_add_f32 v40, v40, v27
v_fmac_f32 v41, v27, v27
v_add_f32 v40, v40, v28
v_fmac_f32 v41, v28, v28
v_add_f32 v40, v40, v29
s_add_u32 s98, s39, 24576
buffer_load_dwordx4 v[176:179], v2, s[24:27], s98 offen offset:0 sc1
v_fmac_f32 v41, v29, v29
v_add_f32 v40, v40, v30
v_fmac_f32 v41, v30, v30
v_add_f32 v40, v40, v31
v_fmac_f32 v41, v31, v31
s_nop 1
v_permlane32_swap_b32 v40, v41
v_add_f32 v40, v40, v41
ds_write_b32 v7, v40 offset:6144
s_waitcnt lgkmcnt(0)
s_barrier
buffer_load_dwordx4 v[180:183], v2, s[24:27], s98 offen offset:1024 sc1
ds_read_b64 v[32:33], v6 offset:6144
ds_read_b64 v[34:35], v6 offset:6400
ds_read_b64 v[36:37], v6 offset:6656
ds_read_b64 v[38:39], v6 offset:6912
buffer_load_dwordx4 v[184:187], v2, s[24:27], s98 offen offset:2048 sc1
s_waitcnt lgkmcnt(2)
v_pk_add_f32 v[32:33], v[32:33], v[34:35]
buffer_load_dwordx4 v[188:191], v2, s[24:27], s98 offen offset:3072 sc1
s_waitcnt lgkmcnt(0)
v_pk_add_f32 v[36:37], v[36:37], v[38:39]
v_pk_add_f32 v[32:33], v[32:33], v[36:37]
v_mov_b32 v34, v15
v_mov_b32 v35, v15
buffer_store_dwordx4 v[32:35], v5, s[24:27], s22 offen offset:512 sc1
ds_read2_b64 v[132:135], v141 offset0:48 offset1:50
ds_read2_b64 v[136:139], v141 offset0:56 offset1:58
ds_read2_b64 v[124:127], v141 offset0:64 offset1:66
s_waitcnt lgkmcnt(2)
v_mfma_f32_16x16x32_bf16 v[112:115], a[136:139], v[132:135], v[112:115]
s_waitcnt vmcnt(6)
v_cmp_ne_u32 vcc, s72, v8
s_nop 0
s_cbranch_vccnz L_poll_4112
L_ret_4113:
s_cmp_lg_u32 s73, 0
s_cbranch_scc1 L_nost_4109a
buffer_load_dwordx4 v[240:243], v11, s[24:27], s23 offen offset:0 sc1
buffer_load_dwordx4 v[244:247], v11, s[24:27], s23 offen offset:1024 sc1
buffer_load_dwordx4 v[248:251], v11, s[24:27], s23 offen offset:2048 sc1
buffer_load_dwordx4 v[252:255], v11, s[24:27], s23 offen offset:3072 sc1
L_nost_4109a:
ds_read2_b64 v[128:131], v141 offset0:72 offset1:74
v_mfma_f32_16x16x32_bf16 v[116:119], a[140:143], v[132:135], v[116:119]
v_mfma_f32_16x16x32_bf16 v[120:123], a[144:147], v[132:135], v[120:123]
s_waitcnt lgkmcnt(2)
v_mfma_f32_16x16x32_bf16 v[112:115], a[148:151], v[136:139], v[112:115]
ds_read2_b64 v[132:135], v141 offset0:80 offset1:82
v_mfma_f32_16x16x32_bf16 v[116:119], a[152:155], v[136:139], v[116:119]
v_mfma_f32_16x16x32_bf16 v[120:123], a[156:159], v[136:139], v[120:123]
s_waitcnt lgkmcnt(2)
v_mfma_f32_16x16x32_bf16 v[112:115], a[160:163], v[124:127], v[112:115]
ds_read2_b64 v[136:139], v141 offset0:88 offset1:90
v_mfma_f32_16x16x32_bf16 v[116:119], a[164:167], v[124:127], v[116:119]
v_mfma_f32_16x16x32_bf16 v[120:123], a[168:171], v[124:127], v[120:123]
s_waitcnt lgkmcnt(2)
v_mfma_f32_16x16x32_bf16 v[112:115], a[172:175], v[128:131], v[112:115]
ds_read2_b64 v[124:127], v141 offset0:96 offset1:98
v_mfma_f32_16x16x32_bf16 v[116:119], a[176:179], v[128:131], v[116:119]
v_mfma_f32_16x16x32_bf16 v[120:123], a[180:183], v[128:131], v[120:123]
s_waitcnt lgkmcnt(2)
v_mfma_f32_16x16x32_bf16 v[112:115], a[184:187], v[132:135], v[112:115]
ds_read2_b64 v[128:131], v141 offset0:104 offset1:106
v_mfma_f32_16x16x32_bf16 v[116:119], a[188:191], v[132:135], v[116:119]
v_mfma_f32_16x16x32_bf16 v[120:123], a[192:195], v[132:135], v[120:123]
s_waitcnt lgkmcnt(2)
v_mfma_f32_16x16x32_bf16 v[112:115], a[196:199], v[136:139], v[112:115]
ds_read2_b64 v[132:135], v141 offset0:112 offset1:114
v_mfma_f32_16x16x32_bf16 v[116:119], a[200:203], v[136:139], v[116:119]
v_mfma_f32_16x16x32_bf16 v[120:123], a[204:207], v[136:139], v[120:123]
s_waitcnt lgkmcnt(2)
v_mfma_f32_16x16x32_bf16 v[112:115], a[208:211], v[124:127], v[112:115]
s_waitcnt vmcnt(5)
buffer_store_dword v15, v14, s[24:27], s19 offen offset:384 sc1
ds_read2_b64 v[136:139], v141 offset0:120 offset1:122
v_mfma_f32_16x16x32_bf16 v[116:119], a[212:215], v[124:127], v[116:119]
v_mfma_f32_16x16x32_bf16 v[120:123], a[216:219], v[124:127], v[120:123]
s_waitcnt lgkmcnt(2)
v_mfma_f32_16x16x32_bf16 v[112:115], a[220:223], v[128:131], v[112:115]
v_mfma_f32_16x16x32_bf16 v[116:119], a[224:227], v[128:131], v[116:119]
s_add_u32 m0, s38, 8192
s_add_u32 s101, s11, 0
buffer_load_dwordx4 v2, s[24:27], s101 offen offset:0 sc1 lds
v_mfma_f32_16x16x32_bf16 v[120:123], a[228:231], v[128:131], v[120:123]
s_waitcnt lgkmcnt(1)
v_mfma_f32_16x16x32_bf16 v[112:115], a[232:235], v[132:135], v[112:115]
v_mfma_f32_16x16x32_bf16 v[116:119], a[236:239], v[132:135], v[116:119]
buffer_load_dwordx4 v2, s[24:27], s101 offen offset:1024 sc1 lds
v_mfma_f32_16x16x32_bf16 v[120:123], a[240:243], v[132:135], v[120:123]
s_waitcnt lgkmcnt(0)
v_mfma_f32_16x16x32_bf16 v[112:115], a[244:247], v[136:139], v[112:115]
v_mfma_f32_16x16x32_bf16 v[116:119], a[248:251], v[136:139], v[116:119]
v_mfma_f32_16x16x32_bf16 v[120:123], a[252:255], v[136:139], v[120:123]
v_mov_b32 v140, 0xbfb8aa3b
s_nop 4
v_mul_f32_dpp v124, v112, v140 quad_perm:[1,1,3,3] row_mask:0xf bank_mask:0xf
v_mul_f32_dpp v125, v113, v140 quad_perm:[1,1,3,3] row_mask:0xf bank_mask:0xf
buffer_load_dwordx4 v2, s[24:27], s101 offen offset:2048 sc1 lds
v_mul_f32_dpp v126, v114, v140 quad_perm:[1,1,3,3] row_mask:0xf bank_mask:0xf
v_mul_f32_dpp v127, v115, v140 quad_perm:[1,1,3,3] row_mask:0xf bank_mask:0xf
v_mul_f32_dpp v128, v116, v140 quad_perm:[1,1,3,3] row_mask:0xf bank_mask:0xf
v_mul_f32_dpp v129, v117, v140 quad_perm:[1,1,3,3] row_mask:0xf bank_mask:0xf
v_mul_f32_dpp v130, v118, v140 quad_perm:[1,1,3,3] row_mask:0xf bank_mask:0xf
v_mul_f32_dpp v131, v119, v140 quad_perm:[1,1,3,3] row_mask:0xf bank_mask:0xf
v_mul_f32_dpp v132, v120, v140 quad_perm:[1,1,3,3] row_mask:0xf bank_mask:0xf
v_mul_f32_dpp v133, v121, v140 quad_perm:[1,1,3,3] row_mask:0xf bank_mask:0xf
v_mul_f32_dpp v134, v122, v140 quad_perm:[1,1,3,3] row_mask:0xf bank_mask:0xf
v_mul_f32_dpp v135, v123, v140 quad_perm:[1,1,3,3] row_mask:0xf bank_mask:0xf
v_mov_b32_dpp v112, v112 quad_perm:[0,0,2,2] row_mask:0xf bank_mask:0xf
v_mov_b32_dpp v113, v113 quad_perm:[0,0,2,2] row_mask:0xf bank_mask:0xf
v_mov_b32_dpp v114, v114 quad_perm:[0,0,2,2] row_mask:0xf bank_mask:0xf
v_mov_b32_dpp v115, v115 quad_perm:[0,0,2,2] row_mask:0xf bank_mask:0xf
v_mov_b32_dpp v116, v116 quad_perm:[0,0,2,2] row_mask:0xf bank_mask:0xf
buffer_load_dwordx4 v2, s[24:27], s101 offen offset:3072 sc1 lds
v_mov_b32_dpp v117, v117 quad_perm:[0,0,2,2] row_mask:0xf bank_mask:0xf
v_mov_b32_dpp v118, v118 quad_perm:[0,0,2,2] row_mask:0xf bank_mask:0xf
v_mov_b32_dpp v119, v119 quad_perm:[0,0,2,2] row_mask:0xf bank_mask:0xf
v_mov_b32_dpp v120, v120 quad_perm:[0,0,2,2] row_mask:0xf bank_mask:0xf
v_mov_b32_dpp v121, v121 quad_perm:[0,0,2,2] row_mask:0xf bank_mask:0xf
v_mov_b32_dpp v122, v122 quad_perm:[0,0,2,2] row_mask:0xf bank_mask:0xf
v_mov_b32_dpp v123, v123 quad_perm:[0,0,2,2] row_mask:0xf bank_mask:0xf
v_add_u32 v6, 8192, v2
v_and_b32 v7, 15, v0
v_lshlrev_b32 v7, 3, v7
s_cmp_lg_u32 s73, 0
s_cbranch_scc1 L_nost_4109b
s_waitcnt vmcnt(8)
v_cmp_ne_u32 vcc, s72, v242
s_waitcnt vmcnt(7)
v_cmp_ne_u32 s[86:87], s72, v246
s_nop 0
s_or_b64 vcc, vcc, s[86:87]
s_waitcnt vmcnt(6)
v_cmp_ne_u32 s[86:87], s72, v250
s_nop 0
s_or_b64 vcc, vcc, s[86:87]
s_waitcnt vmcnt(5)
v_cmp_ne_u32 s[86:87], s72, v254
s_nop 0
s_or_b64 vcc, vcc, s[86:87]
s_cbranch_vccnz L_poll_4110
L_ret_4111:
v_pk_add_f32 v[240:241], v[240:241], v[244:245]
v_pk_add_f32 v[248:249], v[248:249], v[252:253]
v_pk_add_f32 v[240:241], v[240:241], v[248:249]
s_nop 1
v_permlane32_swap_b32 v240, v241
v_add_f32 v240, v240, v241
v_mov_b32 v241, v240
s_nop 1
v_permlane32_swap_b32 v240, v241
s_mov_b32 s78, 0x3b000000
v_mul_f32 v240, s78, v240
v_mul_f32 v242, v240, v240
v_fma_f32 v241, v241, s78, -v242
v_max_f32 v241, 0, v241
v_add_f32 v241, 0x3727c5ac, v241
v_rsq_f32 v241, v241
s_nop 0
v_mul_f32 v241, 0xbfb8aa3b, v241
ds_write_b64 v9, v[240:241] offset:7168
s_waitcnt lgkmcnt(0)
L_nost_4109b:
s_add_u32 m0, s38, 24576
s_add_u32 s101, s11, 16384
buffer_load_dwordx4 v2, s[24:27], s101 offen offset:0 sc1 lds
buffer_load_dwordx4 v2, s[24:27], s101 offen offset:1024 sc1 lds
buffer_load_dwordx4 v2, s[24:27], s101 offen offset:2048 sc1 lds
buffer_load_dwordx4 v2, s[24:27], s101 offen offset:3072 sc1 lds
s_add_u32 s98, s39, 28672
buffer_load_dwordx4 v[192:195], v2, s[24:27], s98 offen offset:0 sc1
s_waitcnt vmcnt(1)
s_barrier
buffer_load_dword v4, v13, s[24:27], s20 offen offset:384 sc1
ds_read_b64 v[72:73], v7 offset:7168
ds_read_b64 v[74:75], v7 offset:7296
ds_read_b128 v[56:59], v6 offset:0
ds_read_b128 v[60:63], v6 offset:1024
buffer_load_dwordx4 v[196:199], v2, s[24:27], s98 offen offset:1024 sc1
ds_read_b128 v[64:67], v6 offset:2048
s_waitcnt lgkmcnt(2)
v_mfma_f32_16x16x32_bf16 v[32:35], a[64:67], v[56:59], 0
buffer_load_dwordx4 v[200:203], v2, s[24:27], s98 offen offset:2048 sc1
ds_read_b128 v[68:71], v6 offset:3072
v_mfma_f32_16x16x32_bf16 v[36:39], a[68:71], v[56:59], 0
v_mfma_f32_16x16x32_bf16 v[40:43], a[72:75], v[56:59], 0
s_waitcnt lgkmcnt(2)
v_mfma_f32_16x16x32_bf16 v[32:35], a[76:79], v[60:63], v[32:35]
buffer_load_dwordx4 v[204:207], v2, s[24:27], s98 offen offset:3072 sc1
ds_read_b128 v[56:59], v6 offset:4096
v_mfma_f32_16x16x32_bf16 v[36:39], a[80:83], v[60:63], v[36:39]
v_mfma_f32_16x16x32_bf16 v[40:43], a[84:87], v[60:63], v[40:43]
s_waitcnt lgkmcnt(2)
v_mfma_f32_16x16x32_bf16 v[32:35], a[88:91], v[64:67], v[32:35]
s_add_u32 s98, s39, 32768
buffer_load_dwordx4 v[208:211], v2, s[24:27], s98 offen offset:0 sc1
ds_read_b128 v[60:63], v6 offset:5120
v_mfma_f32_16x16x32_bf16 v[36:39], a[92:95], v[64:67], v[36:39]
v_mfma_f32_16x16x32_bf16 v[40:43], a[96:99], v[64:67], v[40:43]
s_waitcnt lgkmcnt(2)
v_mfma_f32_16x16x32_bf16 v[32:35], a[100:103], v[68:71], v[32:35]
buffer_load_dwordx4 v[212:215], v2, s[24:27], s98 offen offset:1024 sc1
ds_read_b128 v[64:67], v6 offset:6144
v_mfma_f32_16x16x32_bf16 v[36:39], a[104:107], v[68:71], v[36:39]
v_mfma_f32_16x16x32_bf16 v[40:43], a[108:111], v[68:71], v[40:43]
s_waitcnt lgkmcnt(2)
v_mfma_f32_16x16x32_bf16 v[32:35], a[112:115], v[56:59], v[32:35]
buffer_load_dwordx4 v[216:219], v2, s[24:27], s98 offen offset:2048 sc1
ds_read_b128 v[68:71], v6 offset:7168
v_mfma_f32_16x16x32_bf16 v[36:39], a[116:119], v[56:59], v[36:39]
s_waitcnt vmcnt(6)
v_cmp_ne_u32 vcc, s72, v4
s_nop 0
s_cbranch_vccnz L_poll_4117
L_ret_4118:
s_cmp_lg_u32 s73, 0
s_cbranch_scc1 L_nost_4114a
buffer_load_dwordx4 v[240:243], v11, s[24:27], s23 offen offset:512 sc1
buffer_load_dwordx4 v[244:247], v11, s[24:27], s23 offen offset:1536 sc1
buffer_load_dwordx4 v[248:251], v11, s[24:27], s23 offen offset:2560 sc1
buffer_load_dwordx4 v[252:255], v11, s[24:27], s23 offen offset:3584 sc1
L_nost_4114a:
v_mfma_f32_16x16x32_bf16 v[40:43], a[120:123], v[56:59], v[40:43]
s_waitcnt lgkmcnt(2)
v_mfma_f32_16x16x32_bf16 v[32:35], a[124:127], v[60:63], v[32:35]
ds_read_b128 v[56:59], v6 offset:8192
v_mfma_f32_16x16x32_bf16 v[36:39], a[128:131], v[60:63], v[36:39]
v_mfma_f32_16x16x32_bf16 v[40:43], a[132:135], v[60:63], v[40:43]
s_waitcnt lgkmcnt(2)
v_mfma_f32_16x16x32_bf16 v[32:35], a[136:139], v[64:67], v[32:35]
ds_read_b128 v[60:63], v6 offset:9216
v_mfma_f32_16x16x32_bf16 v[36:39], a[140:143], v[64:67], v[36:39]
v_mfma_f32_16x16x32_bf16 v[40:43], a[144:147], v[64:67], v[40:43]
s_waitcnt lgkmcnt(2)
v_mfma_f32_16x16x32_bf16 v[32:35], a[148:151], v[68:71], v[32:35]
ds_read_b128 v[64:67], v6 offset:10240
v_mfma_f32_16x16x32_bf16 v[36:39], a[152:155], v[68:71], v[36:39]
v_mfma_f32_16x16x32_bf16 v[40:43], a[156:159], v[68:71], v[40:43]
s_waitcnt lgkmcnt(2)
v_mfma_f32_16x16x32_bf16 v[32:35], a[160:163], v[56:59], v[32:35]
ds_read_b128 v[68:71], v6 offset:11264
v_mfma_f32_16x16x32_bf16 v[36:39], a[164:167], v[56:59], v[36:39]
v_mfma_f32_16x16x32_bf16 v[40:43], a[168:171], v[56:59], v[40:43]
s_waitcnt lgkmcnt(2)
v_mfma_f32_16x16x32_bf16 v[32:35], a[172:175], v[60:63], v[32:35]
ds_read_b128 v[56:59], v6 offset:12288
v_mfma_f32_16x16x32_bf16 v[36:39], a[176:179], v[60:63], v[36:39]
v_mfma_f32_16x16x32_bf16 v[40:43], a[180:183], v[60:63], v[40:43]
s_waitcnt lgkmcnt(2)
v_mfma_f32_16x16x32_bf16 v[32:35], a[184:187], v[64:67], v[32:35]
ds_read_b128 v[60:63], v6 offset:13312
v_mfma_f32_16x16x32_bf16 v[36:39], a[188:191], v[64:67], v[36:39]
v_mfma_f32_16x16x32_bf16 v[40:43], a[192:195], v[64:67], v[40:43]
s_waitcnt lgkmcnt(2)
v_mfma_f32_16x16x32_bf16 v[32:35], a[196:199], v[68:71], v[32:35]
ds_read_b128 v[64:67], v6 offset:14336
v_mfma_f32_16x16x32_bf16 v[36:39], a[200:203], v[68:71], v[36:39]
s_add_u32 m0, s38, 40960
s_add_u32 s101, s11, 32768
buffer_load_dwordx4 v2, s[24:27], s101 offen offset:0 sc1 lds
v_mfma_f32_16x16x32_bf16 v[40:43], a[204:207], v[68:71], v[40:43]
s_waitcnt lgkmcnt(2)
v_mfma_f32_16x16x32_bf16 v[32:35], a[208:211], v[56:59], v[32:35]
ds_read_b128 v[68:71], v6 offset:15360
v_mfma_f32_16x16x32_bf16 v[36:39], a[212:215], v[56:59], v[36:39]
v_mfma_f32_16x16x32_bf16 v[40:43], a[216:219], v[56:59], v[40:43]
s_waitcnt lgkmcnt(2)
v_mfma_f32_16x16x32_bf16 v[32:35], a[220:223], v[60:63], v[32:35]
buffer_load_dwordx4 v2, s[24:27], s101 offen offset:1024 sc1 lds
v_mfma_f32_16x16x32_bf16 v[36:39], a[224:227], v[60:63], v[36:39]
v_mfma_f32_16x16x32_bf16 v[40:43], a[228:231], v[60:63], v[40:43]
s_waitcnt lgkmcnt(1)
v_mfma_f32_16x16x32_bf16 v[32:35], a[232:235], v[64:67], v[32:35]
v_mfma_f32_16x16x32_bf16 v[36:39], a[236:239], v[64:67], v[36:39]
buffer_load_dwordx4 v2, s[24:27], s101 offen offset:2048 sc1 lds
v_mfma_f32_16x16x32_bf16 v[40:43], a[240:243], v[64:67], v[40:43]
s_waitcnt lgkmcnt(0)
v_mfma_f32_16x16x32_bf16 v[32:35], a[244:247], v[68:71], v[32:35]
v_mfma_f32_16x16x32_bf16 v[36:39], a[248:251], v[68:71], v[36:39]
v_mfma_f32_16x16x32_bf16 v[40:43], a[252:255], v[68:71], v[40:43]
ds_read_b128 v[56:59], v6 offset:16384
ds_read_b128 v[60:63], v6 offset:17408
buffer_load_dwordx4 v2, s[24:27], s101 offen offset:3072 sc1 lds
ds_read_b128 v[64:67], v6 offset:18432
s_waitcnt lgkmcnt(2)
v_mfma_f32_16x16x32_bf16 v[44:47], a[64:67], v[56:59], 0
s_add_u32 m0, s38, 57344
s_add_u32 s101, s11, 49152
buffer_load_dwordx4 v2, s[24:27], s101 offen offset:0 sc1 lds
ds_read_b128 v[68:71], v6 offset:19456
v_mfma_f32_16x16x32_bf16 v[48:51], a[68:71], v[56:59], 0
v_fma_f32 v32, -v72, v112, v32
v_fma_f32 v33, -v72, v113, v33
v_mfma_f32_16x16x32_bf16 v[52:55], a[72:75], v[56:59], 0
v_fma_f32 v34, -v72, v114, v34
v_fma_f32 v35, -v72, v115, v35
s_waitcnt lgkmcnt(2)
v_mfma_f32_16x16x32_bf16 v[44:47], a[76:79], v[60:63], v[44:47]
buffer_load_dwordx4 v2, s[24:27], s101 offen offset:1024 sc1 lds
ds_read_b128 v[56:59], v6 offset:20480
v_mfma_f32_16x16x32_bf16 v[48:51], a[80:83], v[60:63], v[48:51]
v_fma_f32 v36, -v72, v116, v36
v_fma_f32 v37, -v72, v117, v37
v_mfma_f32_16x16x32_bf16 v[52:55], a[84:87], v[60:63], v[52:55]
v_fma_f32 v38, -v72, v118, v38
v_fma_f32 v39, -v72, v119, v39
s_waitcnt lgkmcnt(2)
v_mfma_f32_16x16x32_bf16 v[44:47], a[88:91], v[64:67], v[44:47]
buffer_load_dwordx4 v2, s[24:27], s101 offen offset:2048 sc1 lds
ds_read_b128 v[60:63], v6 offset:21504
v_mfma_f32_16x16x32_bf16 v[48:51], a[92:95], v[64:67], v[48:51]
v_fma_f32 v40, -v72, v120, v40
v_fma_f32 v41, -v72, v121, v41
v_mfma_f32_16x16x32_bf16 v[52:55], a[96:99], v[64:67], v[52:55]
v_fma_f32 v42, -v72, v122, v42
v_fma_f32 v43, -v72, v123, v43
s_waitcnt lgkmcnt(2)
v_mfma_f32_16x16x32_bf16 v[44:47], a[100:103], v[68:71], v[44:47]
buffer_load_dwordx4 v2, s[24:27], s101 offen offset:3072 sc1 lds
ds_read_b128 v[64:67], v6 offset:22528
v_mfma_f32_16x16x32_bf16 v[48:51], a[104:107], v[68:71], v[48:51]
v_fma_f32 v32, v32, v73, v124
v_fma_f32 v33, v33, v73, v125
v_mfma_f32_16x16x32_bf16 v[52:55], a[108:111], v[68:71], v[52:55]
v_fma_f32 v34, v34, v73, v126
v_fma_f32 v35, v35, v73, v127
s_waitcnt lgkmcnt(2)
v_mfma_f32_16x16x32_bf16 v[44:47], a[112:115], v[56:59], v[44:47]
buffer_load_dwordx4 v[220:223], v2, s[24:27], s98 offen offset:3072 sc1
ds_read_b128 v[68:71], v6 offset:23552
v_mfma_f32_16x16x32_bf16 v[48:51], a[116:119], v[56:59], v[48:51]
v_fma_f32 v36, v36, v73, v128
v_fma_f32 v37, v37, v73, v129
v_mfma_f32_16x16x32_bf16 v[52:55], a[120:123], v[56:59], v[52:55]
v_fma_f32 v38, v38, v73, v130
v_fma_f32 v39, v39, v73, v131
s_waitcnt lgkmcnt(2)
v_mfma_f32_16x16x32_bf16 v[44:47], a[124:127], v[60:63], v[44:47]
s_add_u32 s98, s39, 36864
buffer_load_dwordx4 v[224:227], v2, s[24:27], s98 offen offset:0 sc1
ds_read_b128 v[56:59], v6 offset:24576
v_mfma_f32_16x16x32_bf16 v[48:51], a[128:131], v[60:63], v[48:51]
v_fma_f32 v40, v40, v73, v132
v_fma_f32 v41, v41, v73, v133
v_mfma_f32_16x16x32_bf16 v[52:55], a[132:135], v[60:63], v[52:55]
v_fma_f32 v42, v42, v73, v134
v_fma_f32 v43, v43, v73, v135
s_waitcnt lgkmcnt(2)
v_mfma_f32_16x16x32_bf16 v[44:47], a[136:139], v[64:67], v[44:47]
ds_read_b128 v[60:63], v6 offset:25600
v_mfma_f32_16x16x32_bf16 v[48:51], a[140:143], v[64:67], v[48:51]
v_exp_f32 v80, v32
v_mfma_f32_16x16x32_bf16 v[52:55], a[144:147], v[64:67], v[52:55]
v_exp_f32 v81, v33
s_waitcnt lgkmcnt(2)
v_mfma_f32_16x16x32_bf16 v[44:47], a[148:151], v[68:71], v[44:47]
ds_read_b128 v[64:67], v6 offset:26624
buffer_load_dwordx4 v[228:231], v2, s[24:27], s98 offen offset:1024 sc1
v_mfma_f32_16x16x32_bf16 v[48:51], a[152:155], v[68:71], v[48:51]
v_exp_f32 v82, v34
v_mfma_f32_16x16x32_bf16 v[52:55], a[156:159], v[68:71], v[52:55]
v_exp_f32 v83, v35
s_waitcnt lgkmcnt(2)
v_mfma_f32_16x16x32_bf16 v[44:47], a[160:163], v[56:59], v[44:47]
ds_read_b128 v[68:71], v6 offset:27648
v_mfma_f32_16x16x32_bf16 v[48:51], a[164:167], v[56:59], v[48:51]
v_exp_f32 v84, v36
v_mfma_f32_16x16x32_bf16 v[52:55], a[168:171], v[56:59], v[52:55]
buffer_load_dwordx4 v[232:235], v2, s[24:27], s98 offen offset:2048 sc1
s_waitcnt lgkmcnt(2)
v_mfma_f32_16x16x32_bf16 v[44:47], a[172:175], v[60:63], v[44:47]
ds_read_b128 v[56:59], v6 offset:28672
v_mfma_f32_16x16x32_bf16 v[48:51], a[176:179], v[60:63], v[48:51]
v_exp_f32 v85, v37
v_mfma_f32_16x16x32_bf16 v[52:55], a[180:183], v[60:63], v[52:55]
v_exp_f32 v86, v38
s_waitcnt lgkmcnt(2)
v_mfma_f32_16x16x32_bf16 v[44:47], a[184:187], v[64:67], v[44:47]
ds_read_b128 v[60:63], v6 offset:29696
buffer_load_dwordx4 v[236:239], v2, s[24:27], s98 offen offset:3072 sc1
v_mfma_f32_16x16x32_bf16 v[48:51], a[188:191], v[64:67], v[48:51]
v_exp_f32 v87, v39
v_mfma_f32_16x16x32_bf16 v[52:55], a[192:195], v[64:67], v[52:55]
v_exp_f32 v88, v40
s_waitcnt lgkmcnt(2)
v_mfma_f32_16x16x32_bf16 v[44:47], a[196:199], v[68:71], v[44:47]
ds_read_b128 v[64:67], v6 offset:30720
v_mfma_f32_16x16x32_bf16 v[48:51], a[200:203], v[68:71], v[48:51]
v_exp_f32 v89, v41
v_mfma_f32_16x16x32_bf16 v[52:55], a[204:207], v[68:71], v[52:55]
s_add_u32 s98, s39, 0
buffer_load_dwordx4 a[0:3], v2, s[24:27], s98 offen offset:0 sc1
s_waitcnt lgkmcnt(2)
v_mfma_f32_16x16x32_bf16 v[44:47], a[208:211], v[56:59], v[44:47]
ds_read_b128 v[68:71], v6 offset:31744
v_mfma_f32_16x16x32_bf16 v[48:51], a[212:215], v[56:59], v[48:51]
v_exp_f32 v90, v42
v_mfma_f32_16x16x32_bf16 v[52:55], a[216:219], v[56:59], v[52:55]
v_exp_f32 v91, v43
s_waitcnt lgkmcnt(2)
v_mfma_f32_16x16x32_bf16 v[44:47], a[220:223], v[60:63], v[44:47]
v_add_f32 v80, 1.0, v80
v_add_f32 v81, 1.0, v81
v_mfma_f32_16x16x32_bf16 v[48:51], a[224:227], v[60:63], v[48:51]
v_add_f32 v82, 1.0, v82
v_add_f32 v83, 1.0, v83
v_mfma_f32_16x16x32_bf16 v[52:55], a[228:231], v[60:63], v[52:55]
buffer_load_dwordx4 a[4:7], v2, s[24:27], s98 offen offset:1024 sc1
s_waitcnt lgkmcnt(1)
v_mfma_f32_16x16x32_bf16 v[44:47], a[232:235], v[64:67], v[44:47]
v_add_f32 v84, 1.0, v84
v_add_f32 v85, 1.0, v85
v_mfma_f32_16x16x32_bf16 v[48:51], a[236:239], v[64:67], v[48:51]
v_add_f32 v86, 1.0, v86
v_add_f32 v87, 1.0, v87
v_mfma_f32_16x16x32_bf16 v[52:55], a[240:243], v[64:67], v[52:55]
v_add_f32 v88, 1.0, v88
v_add_f32 v89, 1.0, v89
s_waitcnt lgkmcnt(0)
v_mfma_f32_16x16x32_bf16 v[44:47], a[244:247], v[68:71], v[44:47]
buffer_load_dwordx4 a[8:11], v2, s[24:27], s98 offen offset:2048 sc1
v_mfma_f32_16x16x32_bf16 v[48:51], a[248:251], v[68:71], v[48:51]
v_add_f32 v90, 1.0, v90
v_add_f32 v91, 1.0, v91
v_mfma_f32_16x16x32_bf16 v[52:55], a[252:255], v[68:71], v[52:55]
v_rcp_f32 v80, v80
v_rcp_f32 v81, v81
v_rcp_f32 v82, v82
v_rcp_f32 v83, v83
v_rcp_f32 v84, v84
v_rcp_f32 v85, v85
v_rcp_f32 v86, v86
v_rcp_f32 v87, v87
v_rcp_f32 v88, v88
v_rcp_f32 v89, v89
v_rcp_f32 v90, v90
v_rcp_f32 v91, v91
v_mul_f32 v80, v80, v32
v_mul_f32 v81, v81, v33
v_mul_f32 v82, v82, v34
v_mul_f32 v83, v83, v35
v_mul_f32 v84, v84, v36
v_mul_f32 v85, v85, v37
v_mul_f32 v86, v86, v38
v_mul_f32 v87, v87, v39
v_mul_f32 v88, v88, v40
v_mul_f32 v89, v89, v41
v_mul_f32 v90, v90, v42
v_mul_f32 v91, v91, v43
v_cvt_pk_bf16_f32 v96, v80, v81
v_cvt_pk_bf16_f32 v97, v82, v83
v_cvt_pk_bf16_f32 v100, v84, v85
v_cvt_pk_bf16_f32 v101, v86, v87
v_cvt_pk_bf16_f32 v104, v88, v89
v_cvt_pk_bf16_f32 v105, v90, v91
buffer_load_dwordx4 a[12:15], v2, s[24:27], s98 offen offset:3072 sc1
v_pk_fma_f32 v[44:45], v[74:75], v[112:113], v[44:45] op_sel_hi:[0,1,1] neg_lo:[1,0,0] neg_hi:[1,0,0]
v_pk_fma_f32 v[46:47], v[74:75], v[114:115], v[46:47] op_sel_hi:[0,1,1] neg_lo:[1,0,0] neg_hi:[1,0,0]
v_pk_fma_f32 v[44:45], v[44:45], v[74:75], v[124:125] op_sel:[0,1,0] op_sel_hi:[1,1,1]
v_pk_fma_f32 v[46:47], v[46:47], v[74:75], v[126:127] op_sel:[0,1,0] op_sel_hi:[1,1,1]
v_exp_f32 v80, v44
v_exp_f32 v81, v45
v_exp_f32 v82, v46
s_add_u32 s98, s39, 4096
buffer_load_dwordx4 a[16:19], v2, s[24:27], s98 offen offset:0 sc1
v_exp_f32 v83, v47
v_pk_add_f32 v[80:81], v[80:81], 1.0 op_sel_hi:[1,0]
v_pk_add_f32 v[82:83], v[82:83], 1.0 op_sel_hi:[1,0]
v_rcp_f32 v80, v80
v_rcp_f32 v81, v81
v_rcp_f32 v82, v82
buffer_load_dwordx4 a[20:23], v2, s[24:27], s98 offen offset:1024 sc1
v_rcp_f32 v83, v83
v_pk_mul_f32 v[80:81], v[80:81], v[44:45]
v_pk_mul_f32 v[82:83], v[82:83], v[46:47]
v_cvt_pk_bf16_f32 v98, v80, v81
v_cvt_pk_bf16_f32 v99, v82, v83
v_pk_fma_f32 v[48:49], v[74:75], v[116:117], v[48:49] op_sel_hi:[0,1,1] neg_lo:[1,0,0] neg_hi:[1,0,0]
v_pk_fma_f32 v[50:51], v[74:75], v[118:119], v[50:51] op_sel_hi:[0,1,1] neg_lo:[1,0,0] neg_hi:[1,0,0]
v_pk_fma_f32 v[48:49], v[48:49], v[74:75], v[128:129] op_sel:[0,1,0] op_sel_hi:[1,1,1]
v_pk_fma_f32 v[50:51], v[50:51], v[74:75], v[130:131] op_sel:[0,1,0] op_sel_hi:[1,1,1]
buffer_load_dwordx4 a[24:27], v2, s[24:27], s98 offen offset:2048 sc1
v_exp_f32 v84, v48
v_exp_f32 v85, v49
v_exp_f32 v86, v50
v_exp_f32 v87, v51
v_pk_add_f32 v[84:85], v[84:85], 1.0 op_sel_hi:[1,0]
v_pk_add_f32 v[86:87], v[86:87], 1.0 op_sel_hi:[1,0]
buffer_load_dwordx4 a[28:31], v2, s[24:27], s98 offen offset:3072 sc1
v_rcp_f32 v84, v84
v_rcp_f32 v85, v85
v_rcp_f32 v86, v86
v_rcp_f32 v87, v87
v_pk_mul_f32 v[84:85], v[84:85], v[48:49]
v_pk_mul_f32 v[86:87], v[86:87], v[50:51]
v_cvt_pk_bf16_f32 v102, v84, v85
v_cvt_pk_bf16_f32 v103, v86, v87
v_permlane16_swap_b32 v96, v98
v_permlane16_swap_b32 v97, v99
buffer_store_dwordx4 v[96:99], v2, s[24:27], s16 offen offset:0 sc1
v_pk_fma_f32 v[52:53], v[74:75], v[120:121], v[52:53] op_sel_hi:[0,1,1] neg_lo:[1,0,0] neg_hi:[1,0,0]
v_pk_fma_f32 v[54:55], v[74:75], v[122:123], v[54:55] op_sel_hi:[0,1,1] neg_lo:[1,0,0] neg_hi:[1,0,0]
v_pk_fma_f32 v[52:53], v[52:53], v[74:75], v[132:133] op_sel:[0,1,0] op_sel_hi:[1,1,1]
v_pk_fma_f32 v[54:55], v[54:55], v[74:75], v[134:135] op_sel:[0,1,0] op_sel_hi:[1,1,1]
v_exp_f32 v88, v52
v_exp_f32 v89, v53
v_exp_f32 v90, v54
v_exp_f32 v91, v55
v_pk_add_f32 v[88:89], v[88:89], 1.0 op_sel_hi:[1,0]
v_pk_add_f32 v[90:91], v[90:91], 1.0 op_sel_hi:[1,0]
v_rcp_f32 v88, v88
v_rcp_f32 v89, v89
v_rcp_f32 v90, v90
v_rcp_f32 v91, v91
v_pk_mul_f32 v[88:89], v[88:89], v[52:53]
v_pk_mul_f32 v[90:91], v[90:91], v[54:55]
v_cvt_pk_bf16_f32 v106, v88, v89
v_cvt_pk_bf16_f32 v107, v90, v91
v_permlane16_swap_b32 v100, v102
v_permlane16_swap_b32 v101, v103
buffer_store_dwordx4 v[100:103], v2, s[24:27], s17 offen offset:1024 sc1
v_permlane16_swap_b32 v104, v106
v_permlane16_swap_b32 v105, v107
buffer_store_dwordx4 v[104:107], v2, s[24:27], s17 offen offset:2048 sc1
s_add_u32 s16, s16, 90112
s_add_u32 s17, s17, 90112
s_cmp_lg_u32 s73, 0
s_cbranch_scc1 L_nost_4114b
s_waitcnt vmcnt(27)
v_cmp_ne_u32 vcc, s72, v242
s_waitcnt vmcnt(26)
v_cmp_ne_u32 s[86:87], s72, v246
s_nop 0
s_or_b64 vcc, vcc, s[86:87]
s_waitcnt vmcnt(25)
v_cmp_ne_u32 s[86:87], s72, v250
s_nop 0
s_or_b64 vcc, vcc, s[86:87]
s_waitcnt vmcnt(24)
v_cmp_ne_u32 s[86:87], s72, v254
s_nop 0
s_or_b64 vcc, vcc, s[86:87]
s_cbranch_vccnz L_poll_4115
L_ret_4116:
v_pk_add_f32 v[240:241], v[240:241], v[244:245]
v_pk_add_f32 v[248:249], v[248:249], v[252:253]
v_pk_add_f32 v[240:241], v[240:241], v[248:249]
s_nop 1
v_permlane32_swap_b32 v240, v241
v_add_f32 v240, v240, v241
v_mov_b32 v241, v240
s_nop 1
v_permlane32_swap_b32 v240, v241
s_mov_b32 s78, 0x3b000000
v_mul_f32 v240, s78, v240
v_mul_f32 v242, v240, v240
v_fma_f32 v241, v241, s78, -v242
v_max_f32 v241, 0, v241
v_add_f32 v241, 0x3727c5ac, v241
v_rsq_f32 v241, v241
s_nop 0
v_mul_f32 v241, 0xbfb8aa3b, v241
ds_write_b64 v9, v[240:241] offset:7424
s_waitcnt lgkmcnt(0)
L_nost_4114b:
s_waitcnt vmcnt(16)
s_barrier
ds_read_b64 v[76:77], v7 offset:7424
ds_read_b64 v[78:79], v7 offset:7552
ds_read_b128 v[56:59], v6 offset:32768
ds_read_b128 v[60:63], v6 offset:33792
s_add_u32 s98, s39, 8192
buffer_load_dwordx4 a[32:35], v2, s[24:27], s98 offen offset:0 sc1
ds_read_b128 v[64:67], v6 offset:34816
s_waitcnt lgkmcnt(2)
v_mfma_f32_16x16x32_bf16 v[32:35], a[64:67], v[56:59], 0
buffer_load_dwordx4 a[36:39], v2, s[24:27], s98 offen offset:1024 sc1
ds_read_b128 v[68:71], v6 offset:35840
v_mfma_f32_16x16x32_bf16 v[36:39], a[68:71], v[56:59], 0
v_mfma_f32_16x16x32_bf16 v[40:43], a[72:75], v[56:59], 0
s_waitcnt lgkmcnt(2)
v_mfma_f32_16x16x32_bf16 v[32:35], a[76:79], v[60:63], v[32:35]
buffer_load_dwordx4 a[40:43], v2, s[24:27], s98 offen offset:2048 sc1
ds_read_b128 v[56:59], v6 offset:36864
v_mfma_f32_16x16x32_bf16 v[36:39], a[80:83], v[60:63], v[36:39]
v_mfma_f32_16x16x32_bf16 v[40:43], a[84:87], v[60:63], v[40:43]
s_waitcnt lgkmcnt(2)
v_mfma_f32_16x16x32_bf16 v[32:35], a[88:91], v[64:67], v[32:35]
ds_read_b128 v[60:63], v6 offset:37888
buffer_load_dwordx4 a[44:47], v2, s[24:27], s98 offen offset:3072 sc1
v_mfma_f32_16x16x32_bf16 v[36:39], a[92:95], v[64:67], v[36:39]
v_mfma_f32_16x16x32_bf16 v[40:43], a[96:99], v[64:67], v[40:43]
s_waitcnt lgkmcnt(2)
v_mfma_f32_16x16x32_bf16 v[32:35], a[100:103], v[68:71], v[32:35]
ds_read_b128 v[64:67], v6 offset:38912
v_mfma_f32_16x16x32_bf16 v[36:39], a[104:107], v[68:71], v[36:39]
v_mfma_f32_16x16x32_bf16 v[40:43], a[108:111], v[68:71], v[40:43]
s_add_u32 s98, s39, 12288
buffer_load_dwordx4 a[48:51], v2, s[24:27], s98 offen offset:0 sc1
s_waitcnt lgkmcnt(2)
v_mfma_f32_16x16x32_bf16 v[32:35], a[112:115], v[56:59], v[32:35]
ds_read_b128 v[68:71], v6 offset:39936
v_mfma_f32_16x16x32_bf16 v[36:39], a[116:119], v[56:59], v[36:39]
v_mfma_f32_16x16x32_bf16 v[40:43], a[120:123], v[56:59], v[40:43]
s_waitcnt lgkmcnt(2)
v_mfma_f32_16x16x32_bf16 v[32:35], a[124:127], v[60:63], v[32:35]
buffer_load_dwordx4 a[52:55], v2, s[24:27], s98 offen offset:1024 sc1
ds_read_b128 v[56:59], v6 offset:40960
v_mfma_f32_16x16x32_bf16 v[36:39], a[128:131], v[60:63], v[36:39]
v_mfma_f32_16x16x32_bf16 v[40:43], a[132:135], v[60:63], v[40:43]
s_waitcnt lgkmcnt(2)
v_mfma_f32_16x16x32_bf16 v[32:35], a[136:139], v[64:67], v[32:35]
ds_read_b128 v[60:63], v6 offset:41984
buffer_load_dwordx4 a[56:59], v2, s[24:27], s98 offen offset:2048 sc1
v_mfma_f32_16x16x32_bf16 v[36:39], a[140:143], v[64:67], v[36:39]
v_mfma_f32_16x16x32_bf16 v[40:43], a[144:147], v[64:67], v[40:43]
s_waitcnt lgkmcnt(2)
v_mfma_f32_16x16x32_bf16 v[32:35], a[148:151], v[68:71], v[32:35]
ds_read_b128 v[64:67], v6 offset:43008
v_mfma_f32_16x16x32_bf16 v[36:39], a[152:155], v[68:71], v[36:39]
v_mfma_f32_16x16x32_bf16 v[40:43], a[156:159], v[68:71], v[40:43]
s_waitcnt lgkmcnt(2)
v_mfma_f32_16x16x32_bf16 v[32:35], a[160:163], v[56:59], v[32:35]
ds_read_b128 v[68:71], v6 offset:44032
v_mfma_f32_16x16x32_bf16 v[36:39], a[164:167], v[56:59], v[36:39]
v_mfma_f32_16x16x32_bf16 v[40:43], a[168:171], v[56:59], v[40:43]
s_waitcnt lgkmcnt(2)
v_mfma_f32_16x16x32_bf16 v[32:35], a[172:175], v[60:63], v[32:35]
ds_read_b128 v[56:59], v6 offset:45056
v_mfma_f32_16x16x32_bf16 v[36:39], a[176:179], v[60:63], v[36:39]
v_mfma_f32_16x16x32_bf16 v[40:43], a[180:183], v[60:63], v[40:43]
s_waitcnt lgkmcnt(2)
v_mfma_f32_16x16x32_bf16 v[32:35], a[184:187], v[64:67], v[32:35]
ds_read_b128 v[60:63], v6 offset:46080
buffer_load_dwordx4 a[60:63], v2, s[24:27], s98 offen offset:3072 sc1
v_mfma_f32_16x16x32_bf16 v[36:39], a[188:191], v[64:67], v[36:39]
v_mfma_f32_16x16x32_bf16 v[40:43], a[192:195], v[64:67], v[40:43]
s_waitcnt lgkmcnt(2)
v_mfma_f32_16x16x32_bf16 v[32:35], a[196:199], v[68:71], v[32:35]
ds_read_b128 v[64:67], v6 offset:47104
v_mfma_f32_16x16x32_bf16 v[36:39], a[200:203], v[68:71], v[36:39]
v_mfma_f32_16x16x32_bf16 v[40:43], a[204:207], v[68:71], v[40:43]
s_waitcnt lgkmcnt(2)
v_mfma_f32_16x16x32_bf16 v[32:35], a[208:211], v[56:59], v[32:35]
ds_read_b128 v[68:71], v6 offset:48128
v_mfma_f32_16x16x32_bf16 v[36:39], a[212:215], v[56:59], v[36:39]
v_mfma_f32_16x16x32_bf16 v[40:43], a[216:219], v[56:59], v[40:43]
s_waitcnt lgkmcnt(2)
v_mfma_f32_16x16x32_bf16 v[32:35], a[220:223], v[60:63], v[32:35]
v_mfma_f32_16x16x32_bf16 v[36:39], a[224:227], v[60:63], v[36:39]
v_mfma_f32_16x16x32_bf16 v[40:43], a[228:231], v[60:63], v[40:43]
s_waitcnt lgkmcnt(1)
v_mfma_f32_16x16x32_bf16 v[32:35], a[232:235], v[64:67], v[32:35]
v_mfma_f32_16x16x32_bf16 v[36:39], a[236:239], v[64:67], v[36:39]
v_mfma_f32_16x16x32_bf16 v[40:43], a[240:243], v[64:67], v[40:43]
s_waitcnt lgkmcnt(0)
v_mfma_f32_16x16x32_bf16 v[32:35], a[244:247], v[68:71], v[32:35]
v_mfma_f32_16x16x32_bf16 v[36:39], a[248:251], v[68:71], v[36:39]
s_add_u32 s98, s39, 16384
buffer_load_dwordx4 v[144:147], v2, s[24:27], s98 offen offset:0 sc1
v_mfma_f32_16x16x32_bf16 v[40:43], a[252:255], v[68:71], v[40:43]
ds_read_b128 v[56:59], v6 offset:49152
ds_read_b128 v[60:63], v6 offset:50176
ds_read_b128 v[64:67], v6 offset:51200
s_waitcnt lgkmcnt(2)
v_mfma_f32_16x16x32_bf16 v[44:47], a[64:67], v[56:59], 0
ds_read_b128 v[68:71], v6 offset:52224
v_mfma_f32_16x16x32_bf16 v[48:51], a[68:71], v[56:59], 0
v_fma_f32 v32, -v76, v112, v32
v_fma_f32 v33, -v76, v113, v33
v_mfma_f32_16x16x32_bf16 v[52:55], a[72:75], v[56:59], 0
v_fma_f32 v34, -v76, v114, v34
v_fma_f32 v35, -v76, v115, v35
s_waitcnt lgkmcnt(2)
v_mfma_f32_16x16x32_bf16 v[44:47], a[76:79], v[60:63], v[44:47]
ds_read_b128 v[56:59], v6 offset:53248
v_mfma_f32_16x16x32_bf16 v[48:51], a[80:83], v[60:63], v[48:51]
v_fma_f32 v36, -v76, v116, v36
v_fma_f32 v37, -v76, v117, v37
v_mfma_f32_16x16x32_bf16 v[52:55], a[84:87], v[60:63], v[52:55]
v_fma_f32 v38, -v76, v118, v38
v_fma_f32 v39, -v76, v119, v39
s_waitcnt lgkmcnt(2)
v_mfma_f32_16x16x32_bf16 v[44:47], a[88:91], v[64:67], v[44:47]
ds_read_b128 v[60:63], v6 offset:54272
v_mfma_f32_16x16x32_bf16 v[48:51], a[92:95], v[64:67], v[48:51]
s_waitcnt vmcnt(9)
buffer_store_dword v15, v14, s[24:27], s19 offen offset:512 sc1
v_mfma_f32_16x16x32_bf16 v[52:55], a[96:99], v[64:67], v[52:55]
v_fma_f32 v40, -v76, v120, v40
v_fma_f32 v41, -v76, v121, v41
s_waitcnt lgkmcnt(2)
v_mfma_f32_16x16x32_bf16 v[44:47], a[100:103], v[68:71], v[44:47]
ds_read_b128 v[64:67], v6 offset:55296
v_mfma_f32_16x16x32_bf16 v[48:51], a[104:107], v[68:71], v[48:51]
v_fma_f32 v42, -v76, v122, v42
v_fma_f32 v43, -v76, v123, v43
v_mfma_f32_16x16x32_bf16 v[52:55], a[108:111], v[68:71], v[52:55]
v_fma_f32 v32, v32, v77, v124
v_fma_f32 v33, v33, v77, v125
s_waitcnt lgkmcnt(2)
v_mfma_f32_16x16x32_bf16 v[44:47], a[112:115], v[56:59], v[44:47]
buffer_load_dwordx4 v[148:151], v2, s[24:27], s98 offen offset:1024 sc1
ds_read_b128 v[68:71], v6 offset:56320
v_mfma_f32_16x16x32_bf16 v[48:51], a[116:119], v[56:59], v[48:51]
v_fma_f32 v34, v34, v77, v126
v_fma_f32 v35, v35, v77, v127
v_mfma_f32_16x16x32_bf16 v[52:55], a[120:123], v[56:59], v[52:55]
v_fma_f32 v36, v36, v77, v128
v_fma_f32 v37, v37, v77, v129
s_waitcnt lgkmcnt(2)
v_mfma_f32_16x16x32_bf16 v[44:47], a[124:127], v[60:63], v[44:47]
ds_read_b128 v[56:59], v6 offset:57344
buffer_load_dwordx4 v[152:155], v2, s[24:27], s98 offen offset:2048 sc1
v_mfma_f32_16x16x32_bf16 v[48:51], a[128:131], v[60:63], v[48:51]
v_fma_f32 v38, v38, v77, v130
v_fma_f32 v39, v39, v77, v131
v_mfma_f32_16x16x32_bf16 v[52:55], a[132:135], v[60:63], v[52:55]
v_fma_f32 v40, v40, v77, v132
v_fma_f32 v41, v41, v77, v133
s_waitcnt lgkmcnt(2)
v_mfma_f32_16x16x32_bf16 v[44:47], a[136:139], v[64:67], v[44:47]
ds_read_b128 v[60:63], v6 offset:58368
v_mfma_f32_16x16x32_bf16 v[48:51], a[140:143], v[64:67], v[48:51]
v_fma_f32 v42, v42, v77, v134
v_fma_f32 v43, v43, v77, v135
v_mfma_f32_16x16x32_bf16 v[52:55], a[144:147], v[64:67], v[52:55]
buffer_load_dwordx4 v[156:159], v2, s[24:27], s98 offen offset:3072 sc1
s_waitcnt lgkmcnt(2)
v_mfma_f32_16x16x32_bf16 v[44:47], a[148:151], v[68:71], v[44:47]
ds_read_b128 v[64:67], v6 offset:59392
v_mfma_f32_16x16x32_bf16 v[48:51], a[152:155], v[68:71], v[48:51]
v_exp_f32 v80, v32
v_mfma_f32_16x16x32_bf16 v[52:55], a[156:159], v[68:71], v[52:55]
v_exp_f32 v81, v33
s_waitcnt lgkmcnt(2)
v_mfma_f32_16x16x32_bf16 v[44:47], a[160:163], v[56:59], v[44:47]
s_add_u32 s98, s39, 20480
buffer_load_dwordx4 v[160:163], v2, s[24:27], s98 offen offset:0 sc1
ds_read_b128 v[68:71], v6 offset:60416
v_mfma_f32_16x16x32_bf16 v[48:51], a[164:167], v[56:59], v[48:51]
v_exp_f32 v82, v34
v_mfma_f32_16x16x32_bf16 v[52:55], a[168:171], v[56:59], v[52:55]
v_exp_f32 v83, v35
s_waitcnt lgkmcnt(2)
v_mfma_f32_16x16x32_bf16 v[44:47], a[172:175], v[60:63], v[44:47]
ds_read_b128 v[56:59], v6 offset:61440
buffer_load_dwordx4 v[164:167], v2, s[24:27], s98 offen offset:1024 sc1
v_mfma_f32_16x16x32_bf16 v[48:51], a[176:179], v[60:63], v[48:51]
v_exp_f32 v84, v36
v_mfma_f32_16x16x32_bf16 v[52:55], a[180:183], v[60:63], v[52:55]
v_exp_f32 v85, v37
s_waitcnt lgkmcnt(2)
v_mfma_f32_16x16x32_bf16 v[44:47], a[184:187], v[64:67], v[44:47]
ds_read_b128 v[60:63], v6 offset:62464
v_mfma_f32_16x16x32_bf16 v[48:51], a[188:191], v[64:67], v[48:51]
v_exp_f32 v86, v38
v_mfma_f32_16x16x32_bf16 v[52:55], a[192:195], v[64:67], v[52:55]
buffer_load_dwordx4 v[168:171], v2, s[24:27], s98 offen offset:2048 sc1
s_waitcnt lgkmcnt(2)
v_mfma_f32_16x16x32_bf16 v[44:47], a[196:199], v[68:71], v[44:47]
ds_read_b128 v[64:67], v6 offset:63488
v_mfma_f32_16x16x32_bf16 v[48:51], a[200:203], v[68:71], v[48:51]
v_exp_f32 v87, v39
v_mfma_f32_16x16x32_bf16 v[52:55], a[204:207], v[68:71], v[52:55]
v_exp_f32 v88, v40
s_waitcnt lgkmcnt(2)
v_mfma_f32_16x16x32_bf16 v[44:47], a[208:211], v[56:59], v[44:47]
buffer_load_dwordx4 v[172:175], v2, s[24:27], s98 offen offset:3072 sc1
ds_read_b128 v[68:71], v6 offset:64512
v_mfma_f32_16x16x32_bf16 v[48:51], a[212:215], v[56:59], v[48:51]
v_exp_f32 v89, v41
v_mfma_f32_16x16x32_bf16 v[52:55], a[216:219], v[56:59], v[52:55]
v_exp_f32 v90, v42
s_waitcnt lgkmcnt(2)
v_mfma_f32_16x16x32_bf16 v[44:47], a[220:223], v[60:63], v[44:47]
v_exp_f32 v91, v43
v_mfma_f32_16x16x32_bf16 v[48:51], a[224:227], v[60:63], v[48:51]
s_add_u32 s98, s39, 40960
s_cmp_eq_u32 s73, 3
s_cselect_b32 s98, 0x2000000, s98
buffer_load_dwordx4 v[240:243], v2, s[24:27], s98 offen offset:0 sc1
v_mfma_f32_16x16x32_bf16 v[52:55], a[228:231], v[60:63], v[52:55]
v_add_f32 v80, 1.0, v80
v_add_f32 v81, 1.0, v81
s_waitcnt lgkmcnt(1)
v_mfma_f32_16x16x32_bf16 v[44:47], a[232:235], v[64:67], v[44:47]
v_add_f32 v82, 1.0, v82
v_add_f32 v83, 1.0, v83
v_mfma_f32_16x16x32_bf16 v[48:51], a[236:239], v[64:67], v[48:51]
v_add_f32 v84, 1.0, v84
v_add_f32 v85, 1.0, v85
v_mfma_f32_16x16x32_bf16 v[52:55], a[240:243], v[64:67], v[52:55]
buffer_load_dwordx4 v[244:247], v2, s[24:27], s98 offen offset:1024 sc1
s_waitcnt lgkmcnt(0)
v_mfma_f32_16x16x32_bf16 v[44:47], a[244:247], v[68:71], v[44:47]
v_add_f32 v86, 1.0, v86
v_add_f32 v87, 1.0, v87
v_mfma_f32_16x16x32_bf16 v[48:51], a[248:251], v[68:71], v[48:51]
v_add_f32 v88, 1.0, v88
v_add_f32 v89, 1.0, v89
v_mfma_f32_16x16x32_bf16 v[52:55], a[252:255], v[68:71], v[52:55]
v_add_f32 v90, 1.0, v90
v_add_f32 v91, 1.0, v91
v_rcp_f32 v80, v80
v_rcp_f32 v81, v81
v_rcp_f32 v82, v82
v_rcp_f32 v83, v83
v_rcp_f32 v84, v84
v_rcp_f32 v85, v85
v_rcp_f32 v86, v86
v_rcp_f32 v87, v87
v_rcp_f32 v88, v88
v_rcp_f32 v89, v89
v_rcp_f32 v90, v90
v_rcp_f32 v91, v91
v_mul_f32 v80, v80, v32
v_mul_f32 v81, v81, v33
v_mul_f32 v82, v82, v34
v_mul_f32 v83, v83, v35
v_mul_f32 v84, v84, v36
v_mul_f32 v85, v85, v37
v_mul_f32 v86, v86, v38
v_mul_f32 v87, v87, v39
v_mul_f32 v88, v88, v40
v_mul_f32 v89, v89, v41
v_mul_f32 v90, v90, v42
v_mul_f32 v91, v91, v43
v_cvt_pk_bf16_f32 v96, v80, v81
v_cvt_pk_bf16_f32 v97, v82, v83
v_cvt_pk_bf16_f32 v100, v84, v85
v_cvt_pk_bf16_f32 v101, v86, v87
v_cvt_pk_bf16_f32 v104, v88, v89
v_cvt_pk_bf16_f32 v105, v90, v91
buffer_load_dword v8, v10, s[24:27], s21 offen offset:512 sc1
v_pk_fma_f32 v[44:45], v[78:79], v[112:113], v[44:45] op_sel_hi:[0,1,1] neg_lo:[1,0,0] neg_hi:[1,0,0]
v_pk_fma_f32 v[46:47], v[78:79], v[114:115], v[46:47] op_sel_hi:[0,1,1] neg_lo:[1,0,0] neg_hi:[1,0,0]
v_pk_fma_f32 v[44:45], v[44:45], v[78:79], v[124:125] op_sel:[0,1,0] op_sel_hi:[1,1,1]
v_pk_fma_f32 v[46:47], v[46:47], v[78:79], v[126:127] op_sel:[0,1,0] op_sel_hi:[1,1,1]
v_exp_f32 v80, v44
v_exp_f32 v81, v45
v_exp_f32 v82, v46
buffer_load_dwordx4 v[248:251], v2, s[24:27], s98 offen offset:2048 sc1
v_exp_f32 v83, v47
v_pk_add_f32 v[80:81], v[80:81], 1.0 op_sel_hi:[1,0]
v_pk_add_f32 v[82:83], v[82:83], 1.0 op_sel_hi:[1,0]
v_rcp_f32 v80, v80
v_rcp_f32 v81, v81
v_rcp_f32 v82, v82
buffer_load_dwordx4 v[252:255], v2, s[24:27], s98 offen offset:3072 sc1
v_rcp_f32 v83, v83
v_pk_mul_f32 v[80:81], v[80:81], v[44:45]
v_pk_mul_f32 v[82:83], v[82:83], v[46:47]
v_cvt_pk_bf16_f32 v98, v80, v81
v_cvt_pk_bf16_f32 v99, v82, v83
v_pk_fma_f32 v[48:49], v[78:79], v[116:117], v[48:49] op_sel_hi:[0,1,1] neg_lo:[1,0,0] neg_hi:[1,0,0]
v_pk_fma_f32 v[50:51], v[78:79], v[118:119], v[50:51] op_sel_hi:[0,1,1] neg_lo:[1,0,0] neg_hi:[1,0,0]
v_pk_fma_f32 v[48:49], v[48:49], v[78:79], v[128:129] op_sel:[0,1,0] op_sel_hi:[1,1,1]
v_pk_fma_f32 v[50:51], v[50:51], v[78:79], v[130:131] op_sel:[0,1,0] op_sel_hi:[1,1,1]
v_exp_f32 v84, v48
v_exp_f32 v85, v49
v_exp_f32 v86, v50
v_exp_f32 v87, v51
v_pk_add_f32 v[84:85], v[84:85], 1.0 op_sel_hi:[1,0]
v_pk_add_f32 v[86:87], v[86:87], 1.0 op_sel_hi:[1,0]
v_rcp_f32 v84, v84
v_rcp_f32 v85, v85
v_rcp_f32 v86, v86
v_rcp_f32 v87, v87
v_pk_mul_f32 v[84:85], v[84:85], v[48:49]
v_pk_mul_f32 v[86:87], v[86:87], v[50:51]
v_cvt_pk_bf16_f32 v102, v84, v85
v_cvt_pk_bf16_f32 v103, v86, v87
v_permlane16_swap_b32 v96, v98
v_permlane16_swap_b32 v97, v99
buffer_store_dwordx4 v[96:99], v2, s[24:27], s16 offen offset:0 sc1
v_pk_fma_f32 v[52:53], v[78:79], v[120:121], v[52:53] op_sel_hi:[0,1,1] neg_lo:[1,0,0] neg_hi:[1,0,0]
v_pk_fma_f32 v[54:55], v[78:79], v[122:123], v[54:55] op_sel_hi:[0,1,1] neg_lo:[1,0,0] neg_hi:[1,0,0]
v_pk_fma_f32 v[52:53], v[52:53], v[78:79], v[132:133] op_sel:[0,1,0] op_sel_hi:[1,1,1]
v_pk_fma_f32 v[54:55], v[54:55], v[78:79], v[134:135] op_sel:[0,1,0] op_sel_hi:[1,1,1]
v_exp_f32 v88, v52
v_exp_f32 v89, v53
v_exp_f32 v90, v54
v_exp_f32 v91, v55
v_pk_add_f32 v[88:89], v[88:89], 1.0 op_sel_hi:[1,0]
v_pk_add_f32 v[90:91], v[90:91], 1.0 op_sel_hi:[1,0]
v_rcp_f32 v88, v88
v_rcp_f32 v89, v89
v_rcp_f32 v90, v90
v_rcp_f32 v91, v91
v_pk_mul_f32 v[88:89], v[88:89], v[52:53]
v_pk_mul_f32 v[90:91], v[90:91], v[54:55]
v_cvt_pk_bf16_f32 v106, v88, v89
v_cvt_pk_bf16_f32 v107, v90, v91
v_permlane16_swap_b32 v100, v102
v_permlane16_swap_b32 v101, v103
buffer_store_dwordx4 v[100:103], v2, s[24:27], s17 offen offset:1024 sc1
v_permlane16_swap_b32 v104, v106
v_permlane16_swap_b32 v105, v107
buffer_store_dwordx4 v[104:107], v2, s[24:27], s17 offen offset:2048 sc1
s_waitcnt vmcnt(5)
v_cmp_ne_u32 vcc, s72, v8
s_nop 0
s_cbranch_vccnz L_poll_4119
L_ret_4120:
s_add_u32 s101, s18, 0
s_add_u32 m0, s35, 73728
s_nop 0
buffer_load_dwordx4 v2, s[24:27], s101 offen offset:0 sc1 lds
s_add_u32 s99, s35, 73728
v_add_u32 v6, s99, v2
buffer_load_dwordx4 v2, s[24:27], s101 offen offset:1024 sc1 lds
buffer_load_dwordx4 v2, s[24:27], s101 offen offset:2048 sc1 lds
buffer_load_dwordx4 v2, s[24:27], s101 offen offset:3072 sc1 lds
s_add_u32 s101, s18, 4096
s_add_u32 m0, s35, 77824
s_nop 0
buffer_load_dwordx4 v2, s[24:27], s101 offen offset:0 sc1 lds
buffer_load_dwordx4 v2, s[24:27], s101 offen offset:1024 sc1 lds
buffer_load_dwordx4 v2, s[24:27], s101 offen offset:2048 sc1 lds
buffer_load_dwordx4 v2, s[24:27], s101 offen offset:3072 sc1 lds
s_add_u32 s101, s18, 8192
s_add_u32 m0, s35, 81920
s_nop 0
buffer_load_dwordx4 v2, s[24:27], s101 offen offset:0 sc1 lds
buffer_load_dwordx4 v2, s[24:27], s101 offen offset:1024 sc1 lds
buffer_load_dwordx4 v2, s[24:27], s101 offen offset:2048 sc1 lds
buffer_load_dwordx4 v2, s[24:27], s101 offen offset:3072 sc1 lds
s_waitcnt vmcnt(12)
buffer_store_dword v15, v14, s[24:27], s19 offen offset:640 sc1
s_waitcnt vmcnt(9)
s_add_u32 s101, s18, 12288
s_add_u32 m0, s35, 86016
s_nop 0
buffer_load_dwordx4 v2, s[24:27], s101 offen offset:0 sc1 lds
ds_read_b128 a[64:67], v6 offset:0
ds_read_b128 a[68:71], v6 offset:1024
ds_read_b128 a[72:75], v6 offset:2048
s_waitcnt lgkmcnt(2)
v_mfma_f32_32x32x16_bf16 v[32:47], a[0:3], a[64:67], 0
buffer_load_dwordx4 v2, s[24:27], s101 offen offset:1024 sc1 lds
v_add_u32 v108, 0xfffe0000, v108
v_add_u32 v109, 0xfffe0000, v109
v_add_u32 v110, 0xfffe0000, v110
v_add_u32 v111, 0xfffe0000, v111
v_mfma_f32_32x32x16_bf16 v[48:63], a[4:7], a[64:67], 0
ds_read_b128 a[76:79], v6 offset:3072
ds_read_b64 v[80:81], v12 offset:5120
ds_read_b64 v[82:83], v12 offset:5136
s_waitcnt lgkmcnt(1)
v_lshlrev_b32 v64, 16, v80
v_mfma_f32_32x32x16_bf16 v[32:47], a[8:11], a[68:71], v[32:47]
buffer_load_dwordx4 v2, s[24:27], s101 offen offset:2048 sc1 lds
v_and_b32 v65, s85, v80
v_lshlrev_b32 v66, 16, v81
v_and_b32 v67, s85, v81
s_waitcnt lgkmcnt(0)
v_lshlrev_b32 v68, 16, v82
v_and_b32 v69, s85, v82
v_mfma_f32_32x32x16_bf16 v[48:63], a[12:15], a[68:71], v[48:63]
buffer_load_dwordx4 v2, s[24:27], s101 offen offset:3072 sc1 lds
s_waitcnt vmcnt(9)
ds_read_b128 a[80:83], v6 offset:4096
v_lshlrev_b32 v70, 16, v83
v_and_b32 v71, s85, v83
s_mov_b32 s99, 0xbf317218
v_mfma_f32_32x32x16_bf16 v[32:47], a[16:19], a[72:75], v[32:47]
v_mul_f32 v64, s99, v64
v_mul_f32 v65, s99, v65
v_mul_f32 v66, s99, v66
v_mul_f32 v67, s99, v67
v_mul_f32 v68, s99, v68
v_mul_f32 v69, s99, v69
v_mul_f32 v70, s99, v70
v_mul_f32 v71, s99, v71
v_mfma_f32_32x32x16_bf16 v[48:63], a[20:23], a[72:75], v[48:63]
s_add_u32 s101, s18, 16384
buffer_load_dwordx4 a[128:131], v2, s[24:27], s101 offen offset:0 sc1
ds_read_b128 a[84:87], v6 offset:5120
v_and_b32 v3, 31, v0
v_lshlrev_b32 v3, 10, v3
v_mfma_f32_32x32x16_bf16 v[32:47], a[24:27], a[76:79], v[32:47]
v_lshrrev_b32 v1, 5, v0
v_lshl_add_u32 v3, v1, 4, v3
v_mfma_f32_32x32x16_bf16 v[48:63], a[28:31], a[76:79], v[48:63]
buffer_load_dwordx4 a[132:135], v2, s[24:27], s101 offen offset:1024 sc1
ds_read_b128 a[88:91], v6 offset:6144
s_waitcnt lgkmcnt(2)
v_mfma_f32_32x32x16_bf16 v[32:47], a[32:35], a[80:83], v[32:47]
v_mfma_f32_32x32x16_bf16 v[48:63], a[36:39], a[80:83], v[48:63]
buffer_load_dwordx4 a[136:139], v2, s[24:27], s101 offen offset:2048 sc1
ds_read_b128 a[92:95], v6 offset:7168
s_waitcnt lgkmcnt(2)
v_mfma_f32_32x32x16_bf16 v[32:47], a[40:43], a[84:87], v[32:47]
v_mfma_f32_32x32x16_bf16 v[48:63], a[44:47], a[84:87], v[48:63]
s_waitcnt vmcnt(8)
buffer_load_dwordx4 a[140:143], v2, s[24:27], s101 offen offset:3072 sc1
ds_read_b128 a[96:99], v6 offset:8192
s_waitcnt lgkmcnt(2)
v_mfma_f32_32x32x16_bf16 v[32:47], a[48:51], a[88:91], v[32:47]
v_mfma_f32_32x32x16_bf16 v[48:63], a[52:55], a[88:91], v[48:63]
s_add_u32 s101, s18, 20480
s_cmp_eq_u32 s73, 3
s_cselect_b32 s101, 0x2000000, s101
buffer_load_dwordx4 a[144:147], v2, s[24:27], s101 offen offset:0 sc1
ds_read_b128 a[100:103], v6 offset:9216
s_waitcnt lgkmcnt(2)
v_mfma_f32_32x32x16_bf16 v[32:47], a[56:59], a[92:95], v[32:47]
v_mfma_f32_32x32x16_bf16 v[48:63], a[60:63], a[92:95], v[48:63]
buffer_load_dword v4, v10, s[24:27], s21 offen offset:640 sc1
ds_read_b128 a[104:107], v6 offset:10240
s_waitcnt lgkmcnt(2)
v_mfma_f32_32x32x16_bf16 v[32:47], v[144:147], a[96:99], v[32:47]
v_mfma_f32_32x32x16_bf16 v[48:63], v[148:151], a[96:99], v[48:63]
ds_read_b128 a[108:111], v6 offset:11264
buffer_load_dwordx4 a[148:151], v2, s[24:27], s101 offen offset:1024 sc1
s_waitcnt lgkmcnt(2)
v_mfma_f32_32x32x16_bf16 v[32:47], v[152:155], a[100:103], v[32:47]
v_mfma_f32_32x32x16_bf16 v[48:63], v[156:159], a[100:103], v[48:63]
s_waitcnt vmcnt(7)
ds_read_b128 a[112:115], v6 offset:12288
s_waitcnt lgkmcnt(2)
v_mfma_f32_32x32x16_bf16 v[32:47], v[160:163], a[104:107], v[32:47]
v_mfma_f32_32x32x16_bf16 v[48:63], v[164:167], a[104:107], v[48:63]
ds_read_b128 a[116:119], v6 offset:13312
s_waitcnt lgkmcnt(2)
v_mfma_f32_32x32x16_bf16 v[32:47], v[168:171], a[108:111], v[32:47]
v_mfma_f32_32x32x16_bf16 v[48:63], v[172:175], a[108:111], v[48:63]
ds_read_b128 a[120:123], v6 offset:14336
s_waitcnt lgkmcnt(2)
v_mfma_f32_32x32x16_bf16 v[32:47], v[176:179], a[112:115], v[32:47]
v_mfma_f32_32x32x16_bf16 v[48:63], v[180:183], a[112:115], v[48:63]
ds_read_b128 a[124:127], v6 offset:15360
s_waitcnt lgkmcnt(2)
v_mfma_f32_32x32x16_bf16 v[32:47], v[184:187], a[116:119], v[32:47]
v_mfma_f32_32x32x16_bf16 v[48:63], v[188:191], a[116:119], v[48:63]
s_waitcnt lgkmcnt(1)
v_mfma_f32_32x32x16_bf16 v[32:47], v[192:195], a[120:123], v[32:47]
v_mfma_f32_32x32x16_bf16 v[48:63], v[196:199], a[120:123], v[48:63]
s_waitcnt lgkmcnt(0)
v_mfma_f32_32x32x16_bf16 v[32:47], v[200:203], a[124:127], v[32:47]
v_mfma_f32_32x32x16_bf16 v[48:63], v[204:207], a[124:127], v[48:63]
s_waitcnt vmcnt(6)
v_mfma_f32_32x32x16_bf16 v[48:63], v[212:215], a[128:131], v[48:63]
s_waitcnt vmcnt(5)
v_mfma_f32_32x32x16_bf16 v[48:63], v[220:223], a[132:135], v[48:63]
s_waitcnt vmcnt(1)
v_cmp_ne_u32 vcc, s72, v4
s_nop 0
s_cbranch_vccnz L_poll_4121
L_ret_4122:
s_add_u32 s101, s18, 90112
buffer_load_dwordx4 a[152:155], v2, s[24:27], s101 offen offset:0 sc1
v_mfma_f32_32x32x16_bf16 v[48:63], v[228:231], a[136:139], v[48:63]
v_mfma_f32_32x32x16_bf16 v[48:63], v[236:239], a[140:143], v[48:63]
v_mfma_f32_32x32x16_bf16 v[48:63], v[244:247], a[144:147], v[48:63]
buffer_load_dwordx4 a[156:159], v2, s[24:27], s101 offen offset:1024 sc1
s_waitcnt vmcnt(2)
v_mfma_f32_32x32x16_bf16 v[48:63], v[252:255], a[148:151], v[48:63]
v_mfma_f32_32x32x16_bf16 v[32:47], v[208:211], a[128:131], v[32:47]
buffer_load_dwordx4 a[160:163], v2, s[24:27], s101 offen offset:2048 sc1
v_mfma_f32_32x32x16_bf16 v[32:47], v[216:219], a[132:135], v[32:47]
v_mfma_f32_32x32x16_bf16 v[32:47], v[224:227], a[136:139], v[32:47]
buffer_load_dwordx4 a[164:167], v2, s[24:27], s101 offen offset:3072 sc1
s_nop 6
ds_write_b128 v110, v[48:51] offset:2048
v_mfma_f32_32x32x16_bf16 v[32:47], v[232:235], a[140:143], v[32:47]
s_add_u32 s101, s18, 94208
buffer_load_dwordx4 a[168:171], v2, s[24:27], s101 offen offset:0 sc1
ds_write_b128 v110, v[52:55] offset:3072
v_mfma_f32_32x32x16_bf16 v[32:47], v[240:243], a[144:147], v[32:47]
buffer_load_dwordx4 a[172:175], v2, s[24:27], s101 offen offset:1024 sc1
ds_write_b128 v111, v[56:59] offset:4096
v_mfma_f32_32x32x16_bf16 v[32:47], v[248:251], a[148:151], v[32:47]
buffer_load_dwordx4 a[176:179], v2, s[24:27], s101 offen offset:2048 sc1
ds_write_b128 v111, v[60:63] offset:5120
s_nop 9
ds_write_b128 v109, v[40:43] offset:0
buffer_load_dwordx4 a[180:183], v2, s[24:27], s101 offen offset:3072 sc1
ds_write_b128 v109, v[44:47] offset:1024
s_waitcnt lgkmcnt(0)
s_barrier
s_add_u32 s101, s18, 98304
buffer_load_dwordx4 a[184:187], v2, s[24:27], s101 offen offset:0 sc1
ds_read_b128 v[80:83], v108 offset:0
ds_read_b128 v[84:87], v108 offset:1024
ds_read_b128 v[88:91], v108 offset:2048
ds_read_b128 v[92:95], v108 offset:3072
buffer_load_dwordx4 a[188:191], v2, s[24:27], s101 offen offset:1024 sc1
ds_read_b128 v[96:99], v108 offset:4096
ds_read_b128 v[100:103], v108 offset:5120
s_waitcnt lgkmcnt(5)
v_pk_add_f32 v[32:33], v[32:33], v[80:81]
v_pk_add_f32 v[34:35], v[34:35], v[82:83]
s_waitcnt lgkmcnt(4)
v_pk_add_f32 v[36:37], v[36:37], v[84:85]
v_pk_add_f32 v[38:39], v[38:39], v[86:87]
s_waitcnt lgkmcnt(1)
v_pk_add_f32 v[88:89], v[88:89], v[96:97]
v_pk_add_f32 v[90:91], v[90:91], v[98:99]
s_waitcnt lgkmcnt(0)
v_pk_add_f32 v[92:93], v[92:93], v[100:101]
v_pk_add_f32 v[94:95], v[94:95], v[102:103]
v_pk_add_f32 v[32:33], v[32:33], v[88:89]
v_pk_add_f32 v[34:35], v[34:35], v[90:91]
v_pk_add_f32 v[36:37], v[36:37], v[92:93]
v_pk_add_f32 v[38:39], v[38:39], v[94:95]
buffer_load_dwordx4 a[192:195], v2, s[24:27], s101 offen offset:2048 sc1
v_pk_fma_f32 v[16:17], v[64:65], v[32:33], v[16:17]
v_pk_fma_f32 v[18:19], v[66:67], v[34:35], v[18:19]
v_pk_fma_f32 v[20:21], v[68:69], v[36:37], v[20:21]
v_pk_fma_f32 v[22:23], v[70:71], v[38:39], v[22:23]
s_lshl_b32 s78, s75, 11
s_add_u32 s78, s78, s76
s_add_u32 s78, s78, 0
s_lshl_b32 s78, s78, 5
v_cvt_pk_bf16_f32 v104, v16, v17
v_cvt_pk_bf16_f32 v105, v18, v19
v_cvt_pk_bf16_f32 v106, v20, v21
v_cvt_pk_bf16_f32 v107, v22, v23
s_nop 0
v_permlane32_swap_b32 v104, v106
v_permlane32_swap_b32 v105, v107
buffer_store_dwordx4 v[104:107], v3, s[28:31], s78 offen
s_waitcnt vmcnt(11)
v_mfma_f32_32x32x16_bf16 v[32:47], a[0:3], a[152:155], 0
v_mfma_f32_32x32x16_bf16 v[48:63], a[4:7], a[152:155], 0
s_waitcnt vmcnt(10)
v_mfma_f32_32x32x16_bf16 v[32:47], a[8:11], a[156:159], v[32:47]
buffer_load_dwordx4 a[196:199], v2, s[24:27], s101 offen offset:3072 sc1
v_mfma_f32_32x32x16_bf16 v[48:63], a[12:15], a[156:159], v[48:63]
s_waitcnt vmcnt(10)
v_mfma_f32_32x32x16_bf16 v[32:47], a[16:19], a[160:163], v[32:47]
v_mfma_f32_32x32x16_bf16 v[48:63], a[20:23], a[160:163], v[48:63]
s_add_u32 s101, s18, 102400
buffer_load_dwordx4 a[200:203], v2, s[24:27], s101 offen offset:0 sc1
s_waitcnt vmcnt(10)
v_mfma_f32_32x32x16_bf16 v[32:47], a[24:27], a[164:167], v[32:47]
v_mfma_f32_32x32x16_bf16 v[48:63], a[28:31], a[164:167], v[48:63]
buffer_load_dwordx4 a[204:207], v2, s[24:27], s101 offen offset:1024 sc1
s_waitcnt vmcnt(10)
v_mfma_f32_32x32x16_bf16 v[32:47], a[32:35], a[168:171], v[32:47]
v_mfma_f32_32x32x16_bf16 v[48:63], a[36:39], a[168:171], v[48:63]
buffer_load_dwordx4 a[208:211], v2, s[24:27], s101 offen offset:2048 sc1
s_waitcnt vmcnt(10)
v_mfma_f32_32x32x16_bf16 v[32:47], a[40:43], a[172:175], v[32:47]
v_mfma_f32_32x32x16_bf16 v[48:63], a[44:47], a[172:175], v[48:63]
s_waitcnt vmcnt(9)
v_mfma_f32_32x32x16_bf16 v[32:47], a[48:51], a[176:179], v[32:47]
buffer_load_dwordx4 a[212:215], v2, s[24:27], s101 offen offset:3072 sc1
v_mfma_f32_32x32x16_bf16 v[48:63], a[52:55], a[176:179], v[48:63]
s_waitcnt vmcnt(9)
v_mfma_f32_32x32x16_bf16 v[32:47], a[56:59], a[180:183], v[32:47]
s_add_u32 s101, s18, 106496
buffer_load_dwordx4 a[216:219], v2, s[24:27], s101 offen offset:0 sc1
v_mfma_f32_32x32x16_bf16 v[48:63], a[60:63], a[180:183], v[48:63]
s_waitcnt vmcnt(9)
v_mfma_f32_32x32x16_bf16 v[32:47], v[144:147], a[184:187], v[32:47]
buffer_load_dwordx4 a[220:223], v2, s[24:27], s101 offen offset:1024 sc1
v_mfma_f32_32x32x16_bf16 v[48:63], v[148:151], a[184:187], v[48:63]
s_waitcnt vmcnt(9)
v_mfma_f32_32x32x16_bf16 v[32:47], v[152:155], a[188:191], v[32:47]
buffer_load_dwordx4 a[224:227], v2, s[24:27], s101 offen offset:2048 sc1
v_mfma_f32_32x32x16_bf16 v[48:63], v[156:159], a[188:191], v[48:63]
s_waitcnt vmcnt(9)
v_mfma_f32_32x32x16_bf16 v[32:47], v[160:163], a[192:195], v[32:47]
buffer_load_dwordx4 a[228:231], v2, s[24:27], s101 offen offset:3072 sc1
v_mfma_f32_32x32x16_bf16 v[48:63], v[164:167], a[192:195], v[48:63]
s_waitcnt vmcnt(8)
v_mfma_f32_32x32x16_bf16 v[32:47], v[168:171], a[196:199], v[32:47]
s_add_u32 s101, s18, 110592
s_cmp_eq_u32 s73, 3
s_cselect_b32 s101, 0x2000000, s101
buffer_load_dwordx4 a[232:235], v2, s[24:27], s101 offen offset:0 sc1
v_mfma_f32_32x32x16_bf16 v[48:63], v[172:175], a[196:199], v[48:63]
s_waitcnt vmcnt(8)
v_mfma_f32_32x32x16_bf16 v[32:47], v[176:179], a[200:203], v[32:47]
buffer_load_dwordx4 a[236:239], v2, s[24:27], s101 offen offset:1024 sc1
v_mfma_f32_32x32x16_bf16 v[48:63], v[180:183], a[200:203], v[48:63]
s_waitcnt vmcnt(8)
v_mfma_f32_32x32x16_bf16 v[32:47], v[184:187], a[204:207], v[32:47]
v_mfma_f32_32x32x16_bf16 v[48:63], v[188:191], a[204:207], v[48:63]
s_waitcnt vmcnt(7)
v_mfma_f32_32x32x16_bf16 v[32:47], v[192:195], a[208:211], v[32:47]
v_mfma_f32_32x32x16_bf16 v[48:63], v[196:199], a[208:211], v[48:63]
s_waitcnt vmcnt(6)
v_mfma_f32_32x32x16_bf16 v[32:47], v[200:203], a[212:215], v[32:47]
v_mfma_f32_32x32x16_bf16 v[48:63], v[204:207], a[212:215], v[48:63]
s_waitcnt vmcnt(5)
v_mfma_f32_32x32x16_bf16 v[48:63], v[212:215], a[216:219], v[48:63]
s_waitcnt vmcnt(4)
v_mfma_f32_32x32x16_bf16 v[48:63], v[220:223], a[220:223], v[48:63]
s_waitcnt vmcnt(3)
v_mfma_f32_32x32x16_bf16 v[48:63], v[228:231], a[224:227], v[48:63]
s_waitcnt vmcnt(2)
v_mfma_f32_32x32x16_bf16 v[48:63], v[236:239], a[228:231], v[48:63]
s_waitcnt vmcnt(1)
v_mfma_f32_32x32x16_bf16 v[48:63], v[244:247], a[232:235], v[48:63]
s_waitcnt vmcnt(0)
v_mfma_f32_32x32x16_bf16 v[48:63], v[252:255], a[236:239], v[48:63]
v_mfma_f32_32x32x16_bf16 v[32:47], v[208:211], a[216:219], v[32:47]
v_mfma_f32_32x32x16_bf16 v[32:47], v[216:219], a[220:223], v[32:47]
v_mfma_f32_32x32x16_bf16 v[32:47], v[224:227], a[224:227], v[32:47]
s_nop 8
ds_write_b128 v110, v[48:51] offset:26624
v_mfma_f32_32x32x16_bf16 v[32:47], v[232:235], a[228:231], v[32:47]
ds_write_b128 v110, v[52:55] offset:27648
v_mfma_f32_32x32x16_bf16 v[32:47], v[240:243], a[232:235], v[32:47]
ds_write_b128 v111, v[56:59] offset:28672
v_mfma_f32_32x32x16_bf16 v[32:47], v[248:251], a[236:239], v[32:47]
ds_write_b128 v111, v[60:63] offset:29696
s_nop 10
ds_write_b128 v109, v[40:43] offset:24576
ds_write_b128 v109, v[44:47] offset:25600
s_waitcnt lgkmcnt(0)
s_barrier
ds_read_b128 v[80:83], v108 offset:24576
ds_read_b128 v[84:87], v108 offset:25600
ds_read_b128 v[88:91], v108 offset:26624
ds_read_b128 v[92:95], v108 offset:27648
ds_read_b128 v[96:99], v108 offset:28672
ds_read_b128 v[100:103], v108 offset:29696
s_waitcnt lgkmcnt(5)
v_pk_add_f32 v[32:33], v[32:33], v[80:81]
v_pk_add_f32 v[34:35], v[34:35], v[82:83]
s_waitcnt lgkmcnt(4)
v_pk_add_f32 v[36:37], v[36:37], v[84:85]
v_pk_add_f32 v[38:39], v[38:39], v[86:87]
s_waitcnt lgkmcnt(1)
v_pk_add_f32 v[88:89], v[88:89], v[96:97]
v_pk_add_f32 v[90:91], v[90:91], v[98:99]
s_waitcnt lgkmcnt(0)
v_pk_add_f32 v[92:93], v[92:93], v[100:101]
v_pk_add_f32 v[94:95], v[94:95], v[102:103]
v_pk_add_f32 v[32:33], v[32:33], v[88:89]
v_pk_add_f32 v[34:35], v[34:35], v[90:91]
v_pk_add_f32 v[36:37], v[36:37], v[92:93]
v_pk_add_f32 v[38:39], v[38:39], v[94:95]
v_pk_fma_f32 v[24:25], v[64:65], v[32:33], v[24:25]
v_pk_fma_f32 v[26:27], v[66:67], v[34:35], v[26:27]
v_pk_fma_f32 v[28:29], v[68:69], v[36:37], v[28:29]
v_pk_fma_f32 v[30:31], v[70:71], v[38:39], v[30:31]
s_lshl_b32 s78, s75, 11
s_add_u32 s78, s78, s76
s_add_u32 s78, s78, 1024
s_lshl_b32 s78, s78, 5
v_cvt_pk_bf16_f32 v104, v24, v25
v_cvt_pk_bf16_f32 v105, v26, v27
v_cvt_pk_bf16_f32 v106, v28, v29
v_cvt_pk_bf16_f32 v107, v30, v31
s_nop 0
v_permlane32_swap_b32 v104, v106
v_permlane32_swap_b32 v105, v107
buffer_store_dwordx4 v[104:107], v3, s[28:31], s78 offen
s_endpgm
L_end:
s_endpgm
L_poll_2:
s_mov_b32 s84, 0
L_poll_2_l:
s_sleep 2
buffer_load_dwordx4 v[144:147], v2, s[24:27], s83 offen offset:0 sc1
buffer_load_dwordx4 v[148:151], v2, s[24:27], s83 offen offset:1024 sc1
buffer_load_dwordx4 v[152:155], v2, s[24:27], s67 offen offset:0 sc1
buffer_load_dwordx4 v[156:159], v2, s[24:27], s67 offen offset:1024 sc1
buffer_load_dwordx4 v[160:163], v2, s[24:27], s54 offen offset:0 sc1
buffer_load_dwordx4 v[164:167], v2, s[24:27], s54 offen offset:1024 sc1
buffer_load_dwordx4 v[168:171], v2, s[24:27], s55 offen offset:0 sc1
buffer_load_dwordx4 v[172:175], v2, s[24:27], s55 offen offset:1024 sc1
s_waitcnt vmcnt(0)
v_min3_u32 v6, v145, v147, v149
v_max3_u32 v7, v145, v147, v149
v_min3_u32 v6, v6, v151, v153
v_max3_u32 v7, v7, v151, v153
v_min3_u32 v6, v6, v155, v157
v_max3_u32 v7, v7, v155, v157
v_min3_u32 v6, v6, v159, v161
v_max3_u32 v7, v7, v159, v161
v_min3_u32 v6, v6, v163, v165
v_max3_u32 v7, v7, v163, v165
v_min3_u32 v6, v6, v167, v169
v_max3_u32 v7, v7, v167, v169
v_min3_u32 v6, v6, v171, v173
v_max3_u32 v7, v7, v171, v173
v_min3_u32 v6, v6, v175, v175
v_max3_u32 v7, v7, v175, v175
v_cmp_ne_u32 vcc, s72, v6
v_cmp_ne_u32 s[86:87], s72, v7
s_nop 0
s_or_b64 vcc, vcc, s[86:87]
s_nop 1
s_cbranch_vccz L_ret_3
s_add_u32 s84, s84, 1
s_cmp_lt_u32 s84, 0x40000
s_cbranch_scc1 L_poll_2_l
s_endpgm
L_poll_4:
s_mov_b32 s84, 0
L_poll_4_l:
s_sleep 4
buffer_load_dword v32, v3, s[24:27], s81 offen sc1
s_waitcnt vmcnt(0)
v_cmp_ne_u32 vcc, s72, v32
s_nop 1
s_cbranch_vccz L_ret_5
s_add_u32 s84, s84, 1
s_cmp_lt_u32 s84, 0x40000
s_cbranch_scc1 L_poll_4_l
s_endpgm
L_poll_7:
s_mov_b32 s84, 0
L_poll_7_l:
s_sleep 2
buffer_load_dwordx4 v[40:43], v48, s[24:27], s99 offen sc1
s_waitcnt vmcnt(0)
v_cmp_ne_u32 vcc, s72, v41
v_cmp_ne_u32 s[86:87], s72, v43
s_nop 0
s_or_b64 vcc, vcc, s[86:87]
s_nop 1
s_cbranch_vccz L_ret_8
s_add_u32 s84, s84, 1
s_cmp_lt_u32 s84, 0x40000
s_cbranch_scc1 L_poll_7_l
s_endpgm
L_poll_9:
s_mov_b32 s84, 0
L_poll_9_l:
s_sleep 8
buffer_load_dwordx2 v[6:7], v4, s[24:27], s78 offen sc1
s_waitcnt vmcnt(0)
v_cmp_ne_u32 vcc, s72, v6
v_cmp_ne_u32 s[86:87], s72, v7
s_nop 0
s_or_b64 vcc, vcc, s[86:87]
s_nop 1
s_cbranch_vccz L_ret_10
s_add_u32 s84, s84, 1
s_cmp_lt_u32 s84, 0x40000
s_cbranch_scc1 L_poll_9_l
s_endpgm
L_poll_11:
s_mov_b32 s84, 0
L_poll_11_l:
s_sleep 2
buffer_load_dwordx2 v[34:35], v33, s[24:27], s80 offen sc1
s_waitcnt vmcnt(0)
v_cmp_ne_u32 vcc, s72, v35
s_nop 1
s_cbranch_vccz L_ret_12
s_add_u32 s84, s84, 1
s_cmp_lt_u32 s84, 0x40000
s_cbranch_scc1 L_poll_11_l
s_endpgm
L_poll_14:
s_mov_b32 s84, 0
L_poll_14_l:
s_sleep 2
buffer_load_dwordx4 v[32:35], v2, s[24:27], s83 offen offset:0 sc1
buffer_load_dwordx4 v[36:39], v2, s[24:27], s83 offen offset:1024 sc1
s_waitcnt vmcnt(0)
v_cmp_ne_u32 vcc, s72, v33
v_cmp_ne_u32 s[86:87], s72, v35
s_nop 0
s_or_b64 vcc, vcc, s[86:87]
v_cmp_ne_u32 s[86:87], s72, v37
s_nop 0
s_or_b64 vcc, vcc, s[86:87]
v_cmp_ne_u32 s[86:87], s72, v39
s_nop 0
s_or_b64 vcc, vcc, s[86:87]
s_nop 1
s_cbranch_vccz L_ret_15
s_add_u32 s84, s84, 1
s_cmp_lt_u32 s84, 0x40000
s_cbranch_scc1 L_poll_14_l
s_endpgm
L_fb_16:
s_nop 7
v_mfma_f32_32x32x16_bf16 v[32:47], v[176:179], v[200:203], 0
v_mfma_f32_32x32x16_bf16 v[48:63], v[208:211], v[200:203], 0
s_cmp_ge_u32 s36, 8
s_cbranch_scc1 L_old_1018
s_nop 9
v_mov_b32 v48, 0xff800000
v_mov_b32 v49, 0xff800000
v_mov_b32 v50, 0xff800000
v_mov_b32 v51, 0xff800000
v_mov_b32 v52, 0xff800000
v_mov_b32 v53, 0xff800000
v_mov_b32 v54, 0xff800000
v_mov_b32 v55, 0xff800000
v_mov_b32 v56, 0xff800000
v_mov_b32 v57, 0xff800000
v_mov_b32 v58, 0xff800000
v_mov_b32 v59, 0xff800000
v_mov_b32 v60, 0xff800000
v_mov_b32 v61, 0xff800000
v_mov_b32 v62, 0xff800000
v_mov_b32 v63, 0xff800000
L_old_1018:
s_nop 9
v_cndmask_b32 v64, v48, v32, s[40:41]
v_cndmask_b32 v65, v49, v33, s[42:43]
v_cndmask_b32 v66, v50, v34, s[44:45]
v_cndmask_b32 v67, v51, v35, s[46:47]
v_cndmask_b32 v68, v52, v36, s[48:49]
v_cndmask_b32 v69, v53, v37, s[50:51]
v_cndmask_b32 v70, v54, v38, s[52:53]
v_cndmask_b32 v71, v55, v39, s[54:55]
v_cndmask_b32 v72, v56, v40, s[56:57]
v_cndmask_b32 v73, v57, v41, s[58:59]
v_cndmask_b32 v74, v58, v42, s[60:61]
v_cndmask_b32 v75, v59, v43, s[62:63]
v_cndmask_b32 v76, v60, v44, s[64:65]
v_cndmask_b32 v77, v61, v45, s[66:67]
v_cndmask_b32 v78, v62, v46, s[68:69]
v_cndmask_b32 v79, v63, v47, s[70:71]
v_max_f32 v80, v64, v65
v_max3_f32 v80, v80, v66, v67
v_max3_f32 v80, v80, v68, v69
v_max3_f32 v80, v80, v70, v71
v_max3_f32 v80, v80, v72, v73
v_max3_f32 v80, v80, v74, v75
v_max3_f32 v80, v80, v76, v77
v_max3_f32 v80, v80, v78, v79
s_cmp_lt_u32 s36, 1
s_cbranch_scc1 L_skip_1019
v_mfma_f32_32x32x16_bf16 v[48:63], v[236:239], v[200:203], 0
s_nop 11
v_max3_f32 v80, v80, v48, v49
v_max3_f32 v80, v80, v50, v51
v_max3_f32 v80, v80, v52, v53
v_max3_f32 v80, v80, v54, v55
v_max3_f32 v80, v80, v56, v57
v_max3_f32 v80, v80, v58, v59
v_max3_f32 v80, v80, v60, v61
v_max3_f32 v80, v80, v62, v63
L_skip_1019:
s_cmp_lt_u32 s36, 2
s_cbranch_scc1 L_skip_1020
v_mfma_f32_32x32x16_bf16 v[32:47], v[232:235], v[200:203], 0
s_nop 11
v_max3_f32 v80, v80, v32, v33
v_max3_f32 v80, v80, v34, v35
v_max3_f32 v80, v80, v36, v37
v_max3_f32 v80, v80, v38, v39
v_max3_f32 v80, v80, v40, v41
v_max3_f32 v80, v80, v42, v43
v_max3_f32 v80, v80, v44, v45
v_max3_f32 v80, v80, v46, v47
L_skip_1020:
s_cmp_lt_u32 s36, 3
s_cbranch_scc1 L_skip_1021
v_mfma_f32_32x32x16_bf16 v[48:63], v[228:231], v[200:203], 0
s_nop 11
v_max3_f32 v80, v80, v48, v49
v_max3_f32 v80, v80, v50, v51
v_max3_f32 v80, v80, v52, v53
v_max3_f32 v80, v80, v54, v55
v_max3_f32 v80, v80, v56, v57
v_max3_f32 v80, v80, v58, v59
v_max3_f32 v80, v80, v60, v61
v_max3_f32 v80, v80, v62, v63
L_skip_1021:
s_cmp_lt_u32 s36, 4
s_cbranch_scc1 L_skip_1022
v_mfma_f32_32x32x16_bf16 v[32:47], v[224:227], v[200:203], 0
s_nop 11
v_max3_f32 v80, v80, v32, v33
v_max3_f32 v80, v80, v34, v35
v_max3_f32 v80, v80, v36, v37
v_max3_f32 v80, v80, v38, v39
v_max3_f32 v80, v80, v40, v41
v_max3_f32 v80, v80, v42, v43
v_max3_f32 v80, v80, v44, v45
v_max3_f32 v80, v80, v46, v47
L_skip_1022:
s_cmp_lt_u32 s36, 5
s_cbranch_scc1 L_skip_1023
v_mfma_f32_32x32x16_bf16 v[48:63], v[220:223], v[200:203], 0
s_nop 11
v_max3_f32 v80, v80, v48, v49
v_max3_f32 v80, v80, v50, v51
v_max3_f32 v80, v80, v52, v53
v_max3_f32 v80, v80, v54, v55
v_max3_f32 v80, v80, v56, v57
v_max3_f32 v80, v80, v58, v59
v_max3_f32 v80, v80, v60, v61
v_max3_f32 v80, v80, v62, v63
L_skip_1023:
s_cmp_lt_u32 s36, 6
s_cbranch_scc1 L_skip_1024
v_mfma_f32_32x32x16_bf16 v[32:47], v[216:219], v[200:203], 0
s_nop 11
v_max3_f32 v80, v80, v32, v33
v_max3_f32 v80, v80, v34, v35
v_max3_f32 v80, v80, v36, v37
v_max3_f32 v80, v80, v38, v39
v_max3_f32 v80, v80, v40, v41
v_max3_f32 v80, v80, v42, v43
v_max3_f32 v80, v80, v44, v45
v_max3_f32 v80, v80, v46, v47
L_skip_1024:
s_cmp_lt_u32 s36, 7
s_cbranch_scc1 L_skip_1025
v_mfma_f32_32x32x16_bf16 v[48:63], v[212:215], v[200:203], 0
s_nop 11
v_max3_f32 v80, v80, v48, v49
v_max3_f32 v80, v80, v50, v51
v_max3_f32 v80, v80, v52, v53
v_max3_f32 v80, v80, v54, v55
v_max3_f32 v80, v80, v56, v57
v_max3_f32 v80, v80, v58, v59
v_max3_f32 v80, v80, v60, v61
v_max3_f32 v80, v80, v62, v63
L_skip_1025:
v_mov_b32 v81, v80
s_nop 1
v_permlane32_swap_b32 v80, v81
v_max_f32 v80, v80, v81
v_sub_f32 v80, 0, v80
v_mov_b32 v81, v80
v_mov_b32 v82, v80
v_mov_b32 v83, v80
v_mov_b32 v84, v80
v_mov_b32 v85, v80
v_mov_b32 v86, v80
v_mov_b32 v87, v80
v_mov_b32 v88, v80
v_mov_b32 v89, v80
v_mov_b32 v90, v80
v_mov_b32 v91, v80
v_mov_b32 v92, v80
v_mov_b32 v93, v80
v_mov_b32 v94, v80
v_mov_b32 v95, v80
v_add_f32 v64, v64, v80
v_add_f32 v65, v65, v80
v_add_f32 v66, v66, v80
v_add_f32 v67, v67, v80
v_add_f32 v68, v68, v80
v_add_f32 v69, v69, v80
v_add_f32 v70, v70, v80
v_add_f32 v71, v71, v80
v_add_f32 v72, v72, v80
v_add_f32 v73, v73, v80
v_add_f32 v74, v74, v80
v_add_f32 v75, v75, v80
v_add_f32 v76, v76, v80
v_add_f32 v77, v77, v80
v_add_f32 v78, v78, v80
v_add_f32 v79, v79, v80
v_exp_f32 v64, v64
v_exp_f32 v65, v65
v_exp_f32 v66, v66
v_exp_f32 v67, v67
v_exp_f32 v68, v68
v_exp_f32 v69, v69
v_exp_f32 v70, v70
v_exp_f32 v71, v71
v_exp_f32 v72, v72
v_exp_f32 v73, v73
v_exp_f32 v74, v74
v_exp_f32 v75, v75
v_exp_f32 v76, v76
v_exp_f32 v77, v77
v_exp_f32 v78, v78
v_exp_f32 v79, v79
v_cvt_pk_bf16_f32 v112, v64, v65
v_cvt_pk_bf16_f32 v113, v66, v67
v_cvt_pk_bf16_f32 v114, v68, v69
v_cvt_pk_bf16_f32 v115, v70, v71
v_cvt_pk_bf16_f32 v116, v72, v73
v_cvt_pk_bf16_f32 v117, v74, v75
v_cvt_pk_bf16_f32 v118, v76, v77
v_cvt_pk_bf16_f32 v119, v78, v79
v_and_b32 v120, v112, v248
v_and_b32 v121, v113, v249
v_and_b32 v122, v114, v250
v_and_b32 v123, v115, v251
v_and_b32 v124, v116, v252
v_and_b32 v125, v117, v253
v_and_b32 v126, v118, v254
v_and_b32 v127, v119, v255
v_xor_b32 v112, v112, v120
v_xor_b32 v113, v113, v121
v_xor_b32 v114, v114, v122
v_xor_b32 v115, v115, v123
v_xor_b32 v116, v116, v124
v_xor_b32 v117, v117, v125
v_xor_b32 v118, v118, v126
v_xor_b32 v119, v119, v127
v_mfma_f32_32x32x16_bf16 v[96:111], v[184:187], v[120:123], 0
v_mfma_f32_32x32x16_bf16 v[96:111], v[188:191], v[124:127], v[96:111]
v_mfma_f32_32x32x16_bf16 v[96:111], a[192:195], v[112:115], v[96:111]
v_mfma_f32_32x32x16_bf16 v[96:111], a[196:199], v[116:119], v[96:111]
s_cmp_lt_u32 s36, 1
s_cbranch_scc1 L_skip_1026
v_mfma_f32_32x32x16_bf16 v[48:63], v[236:239], v[200:203], v[80:95]
s_nop 11
v_exp_f32 v48, v48
v_exp_f32 v49, v49
v_exp_f32 v50, v50
v_exp_f32 v51, v51
v_exp_f32 v52, v52
v_exp_f32 v53, v53
v_exp_f32 v54, v54
v_exp_f32 v55, v55
v_exp_f32 v56, v56
v_exp_f32 v57, v57
v_exp_f32 v58, v58
v_exp_f32 v59, v59
v_exp_f32 v60, v60
v_exp_f32 v61, v61
v_exp_f32 v62, v62
v_exp_f32 v63, v63
v_cvt_pk_bf16_f32 v120, v48, v49
v_cvt_pk_bf16_f32 v121, v50, v51
v_cvt_pk_bf16_f32 v122, v52, v53
v_cvt_pk_bf16_f32 v123, v54, v55
v_cvt_pk_bf16_f32 v124, v56, v57
v_cvt_pk_bf16_f32 v125, v58, v59
v_cvt_pk_bf16_f32 v126, v60, v61
v_cvt_pk_bf16_f32 v127, v62, v63
v_mfma_f32_32x32x16_bf16 v[96:111], a[248:251], v[120:123], v[96:111]
s_nop 0
v_mfma_f32_32x32x16_bf16 v[96:111], a[252:255], v[124:127], v[96:111]
L_skip_1026:
s_cmp_lt_u32 s36, 2
s_cbranch_scc1 L_skip_1027
v_mfma_f32_32x32x16_bf16 v[32:47], v[232:235], v[200:203], v[80:95]
s_nop 11
v_exp_f32 v32, v32
v_exp_f32 v33, v33
v_exp_f32 v34, v34
v_exp_f32 v35, v35
v_exp_f32 v36, v36
v_exp_f32 v37, v37
v_exp_f32 v38, v38
v_exp_f32 v39, v39
v_exp_f32 v40, v40
v_exp_f32 v41, v41
v_exp_f32 v42, v42
v_exp_f32 v43, v43
v_exp_f32 v44, v44
v_exp_f32 v45, v45
v_exp_f32 v46, v46
v_exp_f32 v47, v47
v_cvt_pk_bf16_f32 v128, v32, v33
v_cvt_pk_bf16_f32 v129, v34, v35
v_cvt_pk_bf16_f32 v130, v36, v37
v_cvt_pk_bf16_f32 v131, v38, v39
v_cvt_pk_bf16_f32 v132, v40, v41
v_cvt_pk_bf16_f32 v133, v42, v43
v_cvt_pk_bf16_f32 v134, v44, v45
v_cvt_pk_bf16_f32 v135, v46, v47
v_mfma_f32_32x32x16_bf16 v[96:111], a[240:243], v[128:131], v[96:111]
s_nop 0
v_mfma_f32_32x32x16_bf16 v[96:111], a[244:247], v[132:135], v[96:111]
L_skip_1027:
s_cmp_lt_u32 s36, 3
s_cbranch_scc1 L_skip_1028
v_mfma_f32_32x32x16_bf16 v[48:63], v[228:231], v[200:203], v[80:95]
s_nop 11
v_exp_f32 v48, v48
v_exp_f32 v49, v49
v_exp_f32 v50, v50
v_exp_f32 v51, v51
v_exp_f32 v52, v52
v_exp_f32 v53, v53
v_exp_f32 v54, v54
v_exp_f32 v55, v55
v_exp_f32 v56, v56
v_exp_f32 v57, v57
v_exp_f32 v58, v58
v_exp_f32 v59, v59
v_exp_f32 v60, v60
v_exp_f32 v61, v61
v_exp_f32 v62, v62
v_exp_f32 v63, v63
v_cvt_pk_bf16_f32 v120, v48, v49
v_cvt_pk_bf16_f32 v121, v50, v51
v_cvt_pk_bf16_f32 v122, v52, v53
v_cvt_pk_bf16_f32 v123, v54, v55
v_cvt_pk_bf16_f32 v124, v56, v57
v_cvt_pk_bf16_f32 v125, v58, v59
v_cvt_pk_bf16_f32 v126, v60, v61
v_cvt_pk_bf16_f32 v127, v62, v63
v_mfma_f32_32x32x16_bf16 v[96:111], a[232:235], v[120:123], v[96:111]
s_nop 0
v_mfma_f32_32x32x16_bf16 v[96:111], a[236:239], v[124:127], v[96:111]
L_skip_1028:
s_cmp_lt_u32 s36, 4
s_cbranch_scc1 L_skip_1029
v_mfma_f32_32x32x16_bf16 v[32:47], v[224:227], v[200:203], v[80:95]
s_nop 11
v_exp_f32 v32, v32
v_exp_f32 v33, v33
v_exp_f32 v34, v34
v_exp_f32 v35, v35
v_exp_f32 v36, v36
v_exp_f32 v37, v37
v_exp_f32 v38, v38
v_exp_f32 v39, v39
v_exp_f32 v40, v40
v_exp_f32 v41, v41
v_exp_f32 v42, v42
v_exp_f32 v43, v43
v_exp_f32 v44, v44
v_exp_f32 v45, v45
v_exp_f32 v46, v46
v_exp_f32 v47, v47
v_cvt_pk_bf16_f32 v128, v32, v33
v_cvt_pk_bf16_f32 v129, v34, v35
v_cvt_pk_bf16_f32 v130, v36, v37
v_cvt_pk_bf16_f32 v131, v38, v39
v_cvt_pk_bf16_f32 v132, v40, v41
v_cvt_pk_bf16_f32 v133, v42, v43
v_cvt_pk_bf16_f32 v134, v44, v45
v_cvt_pk_bf16_f32 v135, v46, v47
v_mfma_f32_32x32x16_bf16 v[96:111], a[224:227], v[128:131], v[96:111]
s_nop 0
v_mfma_f32_32x32x16_bf16 v[96:111], a[228:231], v[132:135], v[96:111]
L_skip_1029:
s_cmp_lt_u32 s36, 5
s_cbranch_scc1 L_skip_1030
v_mfma_f32_32x32x16_bf16 v[48:63], v[220:223], v[200:203], v[80:95]
s_nop 11
v_exp_f32 v48, v48
v_exp_f32 v49, v49
v_exp_f32 v50, v50
v_exp_f32 v51, v51
v_exp_f32 v52, v52
v_exp_f32 v53, v53
v_exp_f32 v54, v54
v_exp_f32 v55, v55
v_exp_f32 v56, v56
v_exp_f32 v57, v57
v_exp_f32 v58, v58
v_exp_f32 v59, v59
v_exp_f32 v60, v60
v_exp_f32 v61, v61
v_exp_f32 v62, v62
v_exp_f32 v63, v63
v_cvt_pk_bf16_f32 v120, v48, v49
v_cvt_pk_bf16_f32 v121, v50, v51
v_cvt_pk_bf16_f32 v122, v52, v53
v_cvt_pk_bf16_f32 v123, v54, v55
v_cvt_pk_bf16_f32 v124, v56, v57
v_cvt_pk_bf16_f32 v125, v58, v59
v_cvt_pk_bf16_f32 v126, v60, v61
v_cvt_pk_bf16_f32 v127, v62, v63
v_mfma_f32_32x32x16_bf16 v[96:111], a[216:219], v[120:123], v[96:111]
s_nop 0
v_mfma_f32_32x32x16_bf16 v[96:111], a[220:223], v[124:127], v[96:111]
L_skip_1030:
s_cmp_lt_u32 s36, 6
s_cbranch_scc1 L_skip_1031
v_mfma_f32_32x32x16_bf16 v[32:47], v[216:219], v[200:203], v[80:95]
s_nop 11
v_exp_f32 v32, v32
v_exp_f32 v33, v33
v_exp_f32 v34, v34
v_exp_f32 v35, v35
v_exp_f32 v36, v36
v_exp_f32 v37, v37
v_exp_f32 v38, v38
v_exp_f32 v39, v39
v_exp_f32 v40, v40
v_exp_f32 v41, v41
v_exp_f32 v42, v42
v_exp_f32 v43, v43
v_exp_f32 v44, v44
v_exp_f32 v45, v45
v_exp_f32 v46, v46
v_exp_f32 v47, v47
v_cvt_pk_bf16_f32 v128, v32, v33
v_cvt_pk_bf16_f32 v129, v34, v35
v_cvt_pk_bf16_f32 v130, v36, v37
v_cvt_pk_bf16_f32 v131, v38, v39
v_cvt_pk_bf16_f32 v132, v40, v41
v_cvt_pk_bf16_f32 v133, v42, v43
v_cvt_pk_bf16_f32 v134, v44, v45
v_cvt_pk_bf16_f32 v135, v46, v47
v_mfma_f32_32x32x16_bf16 v[96:111], a[208:211], v[128:131], v[96:111]
s_nop 0
v_mfma_f32_32x32x16_bf16 v[96:111], a[212:215], v[132:135], v[96:111]
L_skip_1031:
s_cmp_lt_u32 s36, 7
s_cbranch_scc1 L_skip_1032
v_mfma_f32_32x32x16_bf16 v[48:63], v[212:215], v[200:203], v[80:95]
s_nop 11
v_exp_f32 v48, v48
v_exp_f32 v49, v49
v_exp_f32 v50, v50
v_exp_f32 v51, v51
v_exp_f32 v52, v52
v_exp_f32 v53, v53
v_exp_f32 v54, v54
v_exp_f32 v55, v55
v_exp_f32 v56, v56
v_exp_f32 v57, v57
v_exp_f32 v58, v58
v_exp_f32 v59, v59
v_exp_f32 v60, v60
v_exp_f32 v61, v61
v_exp_f32 v62, v62
v_exp_f32 v63, v63
v_cvt_pk_bf16_f32 v120, v48, v49
v_cvt_pk_bf16_f32 v121, v50, v51
v_cvt_pk_bf16_f32 v122, v52, v53
v_cvt_pk_bf16_f32 v123, v54, v55
v_cvt_pk_bf16_f32 v124, v56, v57
v_cvt_pk_bf16_f32 v125, v58, v59
v_cvt_pk_bf16_f32 v126, v60, v61
v_cvt_pk_bf16_f32 v127, v62, v63
v_mfma_f32_32x32x16_bf16 v[96:111], a[200:203], v[120:123], v[96:111]
s_nop 0
v_mfma_f32_32x32x16_bf16 v[96:111], a[204:207], v[124:127], v[96:111]
L_skip_1032:
s_nop 7
s_nop 7
s_branch L_fbret_17
L_poll_1033:
s_mov_b32 s84, 0
L_poll_1033_l:
buffer_load_dword v8, v13, s[24:27], s20 offen offset:0 sc1
s_waitcnt vmcnt(0)
v_cmp_ne_u32 vcc, s72, v8
s_nop 1
s_cbranch_vccz L_ret_1034
s_add_u32 s84, s84, 1
s_cmp_lt_u32 s84, 0x40000
s_cbranch_scc1 L_poll_1033_l
s_endpgm
L_poll_1035:
s_mov_b32 s84, 0
L_poll_1035_l:
s_sleep 2
buffer_load_dwordx4 v[136:139], v2, s[24:27], s81 offen offset:0 sc1
buffer_load_dwordx4 v[140:143], v2, s[24:27], s81 offen offset:1024 sc1
s_waitcnt vmcnt(0)
v_cmp_ne_u32 vcc, s72, v137
v_cmp_ne_u32 s[86:87], s72, v139
s_nop 0
s_or_b64 vcc, vcc, s[86:87]
v_cmp_ne_u32 s[86:87], s72, v141
s_nop 0
s_or_b64 vcc, vcc, s[86:87]
v_cmp_ne_u32 s[86:87], s72, v143
s_nop 0
s_or_b64 vcc, vcc, s[86:87]
s_nop 1
s_cbranch_vccz L_ret_1036
s_add_u32 s84, s84, 1
s_cmp_lt_u32 s84, 0x40000
s_cbranch_scc1 L_poll_1035_l
s_endpgm
L_fb_1037:
s_nop 7
v_mfma_f32_32x32x16_bf16 v[32:47], v[180:183], v[204:207], 0
v_mfma_f32_32x32x16_bf16 v[48:63], v[212:215], v[204:207], 0
s_cmp_ge_u32 s36, 7
s_cbranch_scc1 L_old_2039
s_nop 9
v_mov_b32 v48, 0xff800000
v_mov_b32 v49, 0xff800000
v_mov_b32 v50, 0xff800000
v_mov_b32 v51, 0xff800000
v_mov_b32 v52, 0xff800000
v_mov_b32 v53, 0xff800000
v_mov_b32 v54, 0xff800000
v_mov_b32 v55, 0xff800000
v_mov_b32 v56, 0xff800000
v_mov_b32 v57, 0xff800000
v_mov_b32 v58, 0xff800000
v_mov_b32 v59, 0xff800000
v_mov_b32 v60, 0xff800000
v_mov_b32 v61, 0xff800000
v_mov_b32 v62, 0xff800000
v_mov_b32 v63, 0xff800000
L_old_2039:
s_nop 9
v_cndmask_b32 v64, v48, v32, s[40:41]
v_cndmask_b32 v65, v49, v33, s[42:43]
v_cndmask_b32 v66, v50, v34, s[44:45]
v_cndmask_b32 v67, v51, v35, s[46:47]
v_cndmask_b32 v68, v52, v36, s[48:49]
v_cndmask_b32 v69, v53, v37, s[50:51]
v_cndmask_b32 v70, v54, v38, s[52:53]
v_cndmask_b32 v71, v55, v39, s[54:55]
v_cndmask_b32 v72, v56, v40, s[56:57]
v_cndmask_b32 v73, v57, v41, s[58:59]
v_cndmask_b32 v74, v58, v42, s[60:61]
v_cndmask_b32 v75, v59, v43, s[62:63]
v_cndmask_b32 v76, v60, v44, s[64:65]
v_cndmask_b32 v77, v61, v45, s[66:67]
v_cndmask_b32 v78, v62, v46, s[68:69]
v_cndmask_b32 v79, v63, v47, s[70:71]
v_max_f32 v80, v64, v65
v_max3_f32 v80, v80, v66, v67
v_max3_f32 v80, v80, v68, v69
v_max3_f32 v80, v80, v70, v71
v_max3_f32 v80, v80, v72, v73
v_max3_f32 v80, v80, v74, v75
v_max3_f32 v80, v80, v76, v77
v_max3_f32 v80, v80, v78, v79
v_mfma_f32_32x32x16_bf16 v[48:63], v[176:179], v[204:207], 0
s_nop 11
v_max3_f32 v80, v80, v48, v49
v_max3_f32 v80, v80, v50, v51
v_max3_f32 v80, v80, v52, v53
v_max3_f32 v80, v80, v54, v55
v_max3_f32 v80, v80, v56, v57
v_max3_f32 v80, v80, v58, v59
v_max3_f32 v80, v80, v60, v61
v_max3_f32 v80, v80, v62, v63
s_cmp_lt_u32 s36, 1
s_cbranch_scc1 L_skip_2040
v_mfma_f32_32x32x16_bf16 v[32:47], v[236:239], v[204:207], 0
s_nop 11
v_max3_f32 v80, v80, v32, v33
v_max3_f32 v80, v80, v34, v35
v_max3_f32 v80, v80, v36, v37
v_max3_f32 v80, v80, v38, v39
v_max3_f32 v80, v80, v40, v41
v_max3_f32 v80, v80, v42, v43
v_max3_f32 v80, v80, v44, v45
v_max3_f32 v80, v80, v46, v47
L_skip_2040:
s_cmp_lt_u32 s36, 2
s_cbranch_scc1 L_skip_2041
v_mfma_f32_32x32x16_bf16 v[48:63], v[232:235], v[204:207], 0
s_nop 11
v_max3_f32 v80, v80, v48, v49
v_max3_f32 v80, v80, v50, v51
v_max3_f32 v80, v80, v52, v53
v_max3_f32 v80, v80, v54, v55
v_max3_f32 v80, v80, v56, v57
v_max3_f32 v80, v80, v58, v59
v_max3_f32 v80, v80, v60, v61
v_max3_f32 v80, v80, v62, v63
L_skip_2041:
s_cmp_lt_u32 s36, 3
s_cbranch_scc1 L_skip_2042
v_mfma_f32_32x32x16_bf16 v[32:47], v[228:231], v[204:207], 0
s_nop 11
v_max3_f32 v80, v80, v32, v33
v_max3_f32 v80, v80, v34, v35
v_max3_f32 v80, v80, v36, v37
v_max3_f32 v80, v80, v38, v39
v_max3_f32 v80, v80, v40, v41
v_max3_f32 v80, v80, v42, v43
v_max3_f32 v80, v80, v44, v45
v_max3_f32 v80, v80, v46, v47
L_skip_2042:
s_cmp_lt_u32 s36, 4
s_cbranch_scc1 L_skip_2043
v_mfma_f32_32x32x16_bf16 v[48:63], v[224:227], v[204:207], 0
s_nop 11
v_max3_f32 v80, v80, v48, v49
v_max3_f32 v80, v80, v50, v51
v_max3_f32 v80, v80, v52, v53
v_max3_f32 v80, v80, v54, v55
v_max3_f32 v80, v80, v56, v57
v_max3_f32 v80, v80, v58, v59
v_max3_f32 v80, v80, v60, v61
v_max3_f32 v80, v80, v62, v63
L_skip_2043:
s_cmp_lt_u32 s36, 5
s_cbranch_scc1 L_skip_2044
v_mfma_f32_32x32x16_bf16 v[32:47], v[220:223], v[204:207], 0
s_nop 11
v_max3_f32 v80, v80, v32, v33
v_max3_f32 v80, v80, v34, v35
v_max3_f32 v80, v80, v36, v37
v_max3_f32 v80, v80, v38, v39
v_max3_f32 v80, v80, v40, v41
v_max3_f32 v80, v80, v42, v43
v_max3_f32 v80, v80, v44, v45
v_max3_f32 v80, v80, v46, v47
L_skip_2044:
s_cmp_lt_u32 s36, 6
s_cbranch_scc1 L_skip_2045
v_mfma_f32_32x32x16_bf16 v[48:63], v[216:219], v[204:207], 0
s_nop 11
v_max3_f32 v80, v80, v48, v49
v_max3_f32 v80, v80, v50, v51
v_max3_f32 v80, v80, v52, v53
v_max3_f32 v80, v80, v54, v55
v_max3_f32 v80, v80, v56, v57
v_max3_f32 v80, v80, v58, v59
v_max3_f32 v80, v80, v60, v61
v_max3_f32 v80, v80, v62, v63
L_skip_2045:
v_mov_b32 v81, v80
s_nop 1
v_permlane32_swap_b32 v80, v81
v_max_f32 v80, v80, v81
v_sub_f32 v80, 0, v80
v_mov_b32 v81, v80
v_mov_b32 v82, v80
v_mov_b32 v83, v80
v_mov_b32 v84, v80
v_mov_b32 v85, v80
v_mov_b32 v86, v80
v_mov_b32 v87, v80
v_mov_b32 v88, v80
v_mov_b32 v89, v80
v_mov_b32 v90, v80
v_mov_b32 v91, v80
v_mov_b32 v92, v80
v_mov_b32 v93, v80
v_mov_b32 v94, v80
v_mov_b32 v95, v80
v_add_f32 v64, v64, v80
v_add_f32 v65, v65, v80
v_add_f32 v66, v66, v80
v_add_f32 v67, v67, v80
v_add_f32 v68, v68, v80
v_add_f32 v69, v69, v80
v_add_f32 v70, v70, v80
v_add_f32 v71, v71, v80
v_add_f32 v72, v72, v80
v_add_f32 v73, v73, v80
v_add_f32 v74, v74, v80
v_add_f32 v75, v75, v80
v_add_f32 v76, v76, v80
v_add_f32 v77, v77, v80
v_add_f32 v78, v78, v80
v_add_f32 v79, v79, v80
v_exp_f32 v64, v64
v_exp_f32 v65, v65
v_exp_f32 v66, v66
v_exp_f32 v67, v67
v_exp_f32 v68, v68
v_exp_f32 v69, v69
v_exp_f32 v70, v70
v_exp_f32 v71, v71
v_exp_f32 v72, v72
v_exp_f32 v73, v73
v_exp_f32 v74, v74
v_exp_f32 v75, v75
v_exp_f32 v76, v76
v_exp_f32 v77, v77
v_exp_f32 v78, v78
v_exp_f32 v79, v79
v_cvt_pk_bf16_f32 v112, v64, v65
v_cvt_pk_bf16_f32 v113, v66, v67
v_cvt_pk_bf16_f32 v114, v68, v69
v_cvt_pk_bf16_f32 v115, v70, v71
v_cvt_pk_bf16_f32 v116, v72, v73
v_cvt_pk_bf16_f32 v117, v74, v75
v_cvt_pk_bf16_f32 v118, v76, v77
v_cvt_pk_bf16_f32 v119, v78, v79
v_and_b32 v120, v112, v248
v_and_b32 v121, v113, v249
v_and_b32 v122, v114, v250
v_and_b32 v123, v115, v251
v_and_b32 v124, v116, v252
v_and_b32 v125, v117, v253
v_and_b32 v126, v118, v254
v_and_b32 v127, v119, v255
v_xor_b32 v112, v112, v120
v_xor_b32 v113, v113, v121
v_xor_b32 v114, v114, v122
v_xor_b32 v115, v115, v123
v_xor_b32 v116, v116, v124
v_xor_b32 v117, v117, v125
v_xor_b32 v118, v118, v126
v_xor_b32 v119, v119, v127
v_mfma_f32_32x32x16_bf16 v[96:111], v[192:195], v[120:123], 0
v_mfma_f32_32x32x16_bf16 v[96:111], v[196:199], v[124:127], v[96:111]
v_mfma_f32_32x32x16_bf16 v[96:111], a[200:203], v[112:115], v[96:111]
v_mfma_f32_32x32x16_bf16 v[96:111], a[204:207], v[116:119], v[96:111]
v_mfma_f32_32x32x16_bf16 v[48:63], v[176:179], v[204:207], v[80:95]
s_nop 11
v_exp_f32 v48, v48
v_exp_f32 v49, v49
v_exp_f32 v50, v50
v_exp_f32 v51, v51
v_exp_f32 v52, v52
v_exp_f32 v53, v53
v_exp_f32 v54, v54
v_exp_f32 v55, v55
v_exp_f32 v56, v56
v_exp_f32 v57, v57
v_exp_f32 v58, v58
v_exp_f32 v59, v59
v_exp_f32 v60, v60
v_exp_f32 v61, v61
v_exp_f32 v62, v62
v_exp_f32 v63, v63
v_cvt_pk_bf16_f32 v120, v48, v49
v_cvt_pk_bf16_f32 v121, v50, v51
v_cvt_pk_bf16_f32 v122, v52, v53
v_cvt_pk_bf16_f32 v123, v54, v55
v_cvt_pk_bf16_f32 v124, v56, v57
v_cvt_pk_bf16_f32 v125, v58, v59
v_cvt_pk_bf16_f32 v126, v60, v61
v_cvt_pk_bf16_f32 v127, v62, v63
v_mfma_f32_32x32x16_bf16 v[96:111], v[184:187], v[120:123], v[96:111]
s_nop 0
v_mfma_f32_32x32x16_bf16 v[96:111], v[188:191], v[124:127], v[96:111]
s_cmp_lt_u32 s36, 1
s_cbranch_scc1 L_skip_2046
v_mfma_f32_32x32x16_bf16 v[32:47], v[236:239], v[204:207], v[80:95]
s_nop 11
v_exp_f32 v32, v32
v_exp_f32 v33, v33
v_exp_f32 v34, v34
v_exp_f32 v35, v35
v_exp_f32 v36, v36
v_exp_f32 v37, v37
v_exp_f32 v38, v38
v_exp_f32 v39, v39
v_exp_f32 v40, v40
v_exp_f32 v41, v41
v_exp_f32 v42, v42
v_exp_f32 v43, v43
v_exp_f32 v44, v44
v_exp_f32 v45, v45
v_exp_f32 v46, v46
v_exp_f32 v47, v47
v_cvt_pk_bf16_f32 v128, v32, v33
v_cvt_pk_bf16_f32 v129, v34, v35
v_cvt_pk_bf16_f32 v130, v36, v37
v_cvt_pk_bf16_f32 v131, v38, v39
v_cvt_pk_bf16_f32 v132, v40, v41
v_cvt_pk_bf16_f32 v133, v42, v43
v_cvt_pk_bf16_f32 v134, v44, v45
v_cvt_pk_bf16_f32 v135, v46, v47
v_mfma_f32_32x32x16_bf16 v[96:111], a[248:251], v[128:131], v[96:111]
s_nop 0
v_mfma_f32_32x32x16_bf16 v[96:111], a[252:255], v[132:135], v[96:111]
L_skip_2046:
s_cmp_lt_u32 s36, 2
s_cbranch_scc1 L_skip_2047
v_mfma_f32_32x32x16_bf16 v[48:63], v[232:235], v[204:207], v[80:95]
s_nop 11
v_exp_f32 v48, v48
v_exp_f32 v49, v49
v_exp_f32 v50, v50
v_exp_f32 v51, v51
v_exp_f32 v52, v52
v_exp_f32 v53, v53
v_exp_f32 v54, v54
v_exp_f32 v55, v55
v_exp_f32 v56, v56
v_exp_f32 v57, v57
v_exp_f32 v58, v58
v_exp_f32 v59, v59
v_exp_f32 v60, v60
v_exp_f32 v61, v61
v_exp_f32 v62, v62
v_exp_f32 v63, v63
v_cvt_pk_bf16_f32 v120, v48, v49
v_cvt_pk_bf16_f32 v121, v50, v51
v_cvt_pk_bf16_f32 v122, v52, v53
v_cvt_pk_bf16_f32 v123, v54, v55
v_cvt_pk_bf16_f32 v124, v56, v57
v_cvt_pk_bf16_f32 v125, v58, v59
v_cvt_pk_bf16_f32 v126, v60, v61
v_cvt_pk_bf16_f32 v127, v62, v63
v_mfma_f32_32x32x16_bf16 v[96:111], a[240:243], v[120:123], v[96:111]
s_nop 0
v_mfma_f32_32x32x16_bf16 v[96:111], a[244:247], v[124:127], v[96:111]
L_skip_2047:
s_cmp_lt_u32 s36, 3
s_cbranch_scc1 L_skip_2048
v_mfma_f32_32x32x16_bf16 v[32:47], v[228:231], v[204:207], v[80:95]
s_nop 11
v_exp_f32 v32, v32
v_exp_f32 v33, v33
v_exp_f32 v34, v34
v_exp_f32 v35, v35
v_exp_f32 v36, v36
v_exp_f32 v37, v37
v_exp_f32 v38, v38
v_exp_f32 v39, v39
v_exp_f32 v40, v40
v_exp_f32 v41, v41
v_exp_f32 v42, v42
v_exp_f32 v43, v43
v_exp_f32 v44, v44
v_exp_f32 v45, v45
v_exp_f32 v46, v46
v_exp_f32 v47, v47
v_cvt_pk_bf16_f32 v128, v32, v33
v_cvt_pk_bf16_f32 v129, v34, v35
v_cvt_pk_bf16_f32 v130, v36, v37
v_cvt_pk_bf16_f32 v131, v38, v39
v_cvt_pk_bf16_f32 v132, v40, v41
v_cvt_pk_bf16_f32 v133, v42, v43
v_cvt_pk_bf16_f32 v134, v44, v45
v_cvt_pk_bf16_f32 v135, v46, v47
v_mfma_f32_32x32x16_bf16 v[96:111], a[232:235], v[128:131], v[96:111]
s_nop 0
v_mfma_f32_32x32x16_bf16 v[96:111], a[236:239], v[132:135], v[96:111]
L_skip_2048:
s_cmp_lt_u32 s36, 4
s_cbranch_scc1 L_skip_2049
v_mfma_f32_32x32x16_bf16 v[48:63], v[224:227], v[204:207], v[80:95]
s_nop 11
v_exp_f32 v48, v48
v_exp_f32 v49, v49
v_exp_f32 v50, v50
v_exp_f32 v51, v51
v_exp_f32 v52, v52
v_exp_f32 v53, v53
v_exp_f32 v54, v54
v_exp_f32 v55, v55
v_exp_f32 v56, v56
v_exp_f32 v57, v57
v_exp_f32 v58, v58
v_exp_f32 v59, v59
v_exp_f32 v60, v60
v_exp_f32 v61, v61
v_exp_f32 v62, v62
v_exp_f32 v63, v63
v_cvt_pk_bf16_f32 v120, v48, v49
v_cvt_pk_bf16_f32 v121, v50, v51
v_cvt_pk_bf16_f32 v122, v52, v53
v_cvt_pk_bf16_f32 v123, v54, v55
v_cvt_pk_bf16_f32 v124, v56, v57
v_cvt_pk_bf16_f32 v125, v58, v59
v_cvt_pk_bf16_f32 v126, v60, v61
v_cvt_pk_bf16_f32 v127, v62, v63
v_mfma_f32_32x32x16_bf16 v[96:111], a[224:227], v[120:123], v[96:111]
s_nop 0
v_mfma_f32_32x32x16_bf16 v[96:111], a[228:231], v[124:127], v[96:111]
L_skip_2049:
s_cmp_lt_u32 s36, 5
s_cbranch_scc1 L_skip_2050
v_mfma_f32_32x32x16_bf16 v[32:47], v[220:223], v[204:207], v[80:95]
s_nop 11
v_exp_f32 v32, v32
v_exp_f32 v33, v33
v_exp_f32 v34, v34
v_exp_f32 v35, v35
v_exp_f32 v36, v36
v_exp_f32 v37, v37
v_exp_f32 v38, v38
v_exp_f32 v39, v39
v_exp_f32 v40, v40
v_exp_f32 v41, v41
v_exp_f32 v42, v42
v_exp_f32 v43, v43
v_exp_f32 v44, v44
v_exp_f32 v45, v45
v_exp_f32 v46, v46
v_exp_f32 v47, v47
v_cvt_pk_bf16_f32 v128, v32, v33
v_cvt_pk_bf16_f32 v129, v34, v35
v_cvt_pk_bf16_f32 v130, v36, v37
v_cvt_pk_bf16_f32 v131, v38, v39
v_cvt_pk_bf16_f32 v132, v40, v41
v_cvt_pk_bf16_f32 v133, v42, v43
v_cvt_pk_bf16_f32 v134, v44, v45
v_cvt_pk_bf16_f32 v135, v46, v47
v_mfma_f32_32x32x16_bf16 v[96:111], a[216:219], v[128:131], v[96:111]
s_nop 0
v_mfma_f32_32x32x16_bf16 v[96:111], a[220:223], v[132:135], v[96:111]
L_skip_2050:
s_cmp_lt_u32 s36, 6
s_cbranch_scc1 L_skip_2051
v_mfma_f32_32x32x16_bf16 v[48:63], v[216:219], v[204:207], v[80:95]
s_nop 11
v_exp_f32 v48, v48
v_exp_f32 v49, v49
v_exp_f32 v50, v50
v_exp_f32 v51, v51
v_exp_f32 v52, v52
v_exp_f32 v53, v53
v_exp_f32 v54, v54
v_exp_f32 v55, v55
v_exp_f32 v56, v56
v_exp_f32 v57, v57
v_exp_f32 v58, v58
v_exp_f32 v59, v59
v_exp_f32 v60, v60
v_exp_f32 v61, v61
v_exp_f32 v62, v62
v_exp_f32 v63, v63
v_cvt_pk_bf16_f32 v120, v48, v49
v_cvt_pk_bf16_f32 v121, v50, v51
v_cvt_pk_bf16_f32 v122, v52, v53
v_cvt_pk_bf16_f32 v123, v54, v55
v_cvt_pk_bf16_f32 v124, v56, v57
v_cvt_pk_bf16_f32 v125, v58, v59
v_cvt_pk_bf16_f32 v126, v60, v61
v_cvt_pk_bf16_f32 v127, v62, v63
v_mfma_f32_32x32x16_bf16 v[96:111], a[208:211], v[120:123], v[96:111]
s_nop 0
v_mfma_f32_32x32x16_bf16 v[96:111], a[212:215], v[124:127], v[96:111]
L_skip_2051:
s_nop 7
s_nop 7
s_branch L_fbret_1038
L_poll_2052:
s_mov_b32 s84, 0
L_poll_2052_l:
buffer_load_dword v4, v13, s[24:27], s20 offen offset:128 sc1
s_waitcnt vmcnt(0)
v_cmp_ne_u32 vcc, s72, v4
s_nop 1
s_cbranch_vccz L_ret_2053
s_add_u32 s84, s84, 1
s_cmp_lt_u32 s84, 0x40000
s_cbranch_scc1 L_poll_2052_l
s_endpgm
L_poll_2055:
s_mov_b32 s84, 0
L_poll_2055_l:
s_sleep 2
buffer_load_dwordx4 v[240:243], v11, s[24:27], s23 offen offset:0 sc1
buffer_load_dwordx4 v[244:247], v11, s[24:27], s23 offen offset:1024 sc1
buffer_load_dwordx4 v[248:251], v11, s[24:27], s23 offen offset:2048 sc1
buffer_load_dwordx4 v[252:255], v11, s[24:27], s23 offen offset:3072 sc1
s_waitcnt vmcnt(0)
v_cmp_ne_u32 vcc, s72, v242
v_cmp_ne_u32 s[86:87], s72, v246
s_nop 0
s_or_b64 vcc, vcc, s[86:87]
v_cmp_ne_u32 s[86:87], s72, v250
s_nop 0
s_or_b64 vcc, vcc, s[86:87]
v_cmp_ne_u32 s[86:87], s72, v254
s_nop 0
s_or_b64 vcc, vcc, s[86:87]
s_nop 1
s_cbranch_vccz L_ret_2056
s_add_u32 s84, s84, 1
s_cmp_lt_u32 s84, 0x40000
s_cbranch_scc1 L_poll_2055_l
s_endpgm
L_poll_2057:
s_mov_b32 s84, 0
L_poll_2057_l:
buffer_load_dword v8, v13, s[24:27], s20 offen offset:256 sc1
s_waitcnt vmcnt(0)
v_cmp_ne_u32 vcc, s72, v8
s_nop 1
s_cbranch_vccz L_ret_2058
s_add_u32 s84, s84, 1
s_cmp_lt_u32 s84, 0x40000
s_cbranch_scc1 L_poll_2057_l
s_endpgm
L_poll_2060:
s_mov_b32 s84, 0
L_poll_2060_l:
s_sleep 2
buffer_load_dwordx4 v[240:243], v11, s[24:27], s23 offen offset:512 sc1
buffer_load_dwordx4 v[244:247], v11, s[24:27], s23 offen offset:1536 sc1
buffer_load_dwordx4 v[248:251], v11, s[24:27], s23 offen offset:2560 sc1
buffer_load_dwordx4 v[252:255], v11, s[24:27], s23 offen offset:3584 sc1
s_waitcnt vmcnt(0)
v_cmp_ne_u32 vcc, s72, v242
v_cmp_ne_u32 s[86:87], s72, v246
s_nop 0
s_or_b64 vcc, vcc, s[86:87]
v_cmp_ne_u32 s[86:87], s72, v250
s_nop 0
s_or_b64 vcc, vcc, s[86:87]
v_cmp_ne_u32 s[86:87], s72, v254
s_nop 0
s_or_b64 vcc, vcc, s[86:87]
s_nop 1
s_cbranch_vccz L_ret_2061
s_add_u32 s84, s84, 1
s_cmp_lt_u32 s84, 0x40000
s_cbranch_scc1 L_poll_2060_l
s_endpgm
L_poll_2062:
s_mov_b32 s84, 0
L_poll_2062_l:
buffer_load_dword v4, v13, s[24:27], s20 offen offset:384 sc1
s_waitcnt vmcnt(0)
v_cmp_ne_u32 vcc, s72, v4
s_nop 1
s_cbranch_vccz L_ret_2063
s_add_u32 s84, s84, 1
s_cmp_lt_u32 s84, 0x40000
s_cbranch_scc1 L_poll_2062_l
s_endpgm
L_poll_2064:
s_mov_b32 s84, 0
L_poll_2064_l:
buffer_load_dword v8, v10, s[24:27], s21 offen offset:512 sc1
s_waitcnt vmcnt(0)
v_cmp_ne_u32 vcc, s72, v8
s_nop 1
s_cbranch_vccz L_ret_2065
s_add_u32 s84, s84, 1
s_cmp_lt_u32 s84, 0x40000
s_cbranch_scc1 L_poll_2064_l
s_endpgm
L_poll_2066:
s_mov_b32 s84, 0
L_poll_2066_l:
buffer_load_dword v4, v10, s[24:27], s21 offen offset:640 sc1
s_waitcnt vmcnt(0)
v_cmp_ne_u32 vcc, s72, v4
s_nop 1
s_cbranch_vccz L_ret_2067
s_add_u32 s84, s84, 1
s_cmp_lt_u32 s84, 0x40000
s_cbranch_scc1 L_poll_2066_l
s_endpgm
L_poll_2069:
s_mov_b32 s84, 0
L_poll_2069_l:
s_sleep 2
buffer_load_dwordx4 v[32:35], v2, s[24:27], s83 offen offset:0 sc1
buffer_load_dwordx4 v[36:39], v2, s[24:27], s83 offen offset:1024 sc1
s_waitcnt vmcnt(0)
v_cmp_ne_u32 vcc, s72, v33
v_cmp_ne_u32 s[86:87], s72, v35
s_nop 0
s_or_b64 vcc, vcc, s[86:87]
v_cmp_ne_u32 s[86:87], s72, v37
s_nop 0
s_or_b64 vcc, vcc, s[86:87]
v_cmp_ne_u32 s[86:87], s72, v39
s_nop 0
s_or_b64 vcc, vcc, s[86:87]
s_nop 1
s_cbranch_vccz L_ret_2070
s_add_u32 s84, s84, 1
s_cmp_lt_u32 s84, 0x40000
s_cbranch_scc1 L_poll_2069_l
s_endpgm
L_fb_2071:
s_nop 7
v_mfma_f32_32x32x16_bf16 v[32:47], v[176:179], v[200:203], 0
v_mfma_f32_32x32x16_bf16 v[48:63], v[208:211], v[200:203], 0
s_cmp_ge_u32 s36, 8
s_cbranch_scc1 L_old_3073
s_nop 9
v_mov_b32 v48, 0xff800000
v_mov_b32 v49, 0xff800000
v_mov_b32 v50, 0xff800000
v_mov_b32 v51, 0xff800000
v_mov_b32 v52, 0xff800000
v_mov_b32 v53, 0xff800000
v_mov_b32 v54, 0xff800000
v_mov_b32 v55, 0xff800000
v_mov_b32 v56, 0xff800000
v_mov_b32 v57, 0xff800000
v_mov_b32 v58, 0xff800000
v_mov_b32 v59, 0xff800000
v_mov_b32 v60, 0xff800000
v_mov_b32 v61, 0xff800000
v_mov_b32 v62, 0xff800000
v_mov_b32 v63, 0xff800000
L_old_3073:
s_nop 9
v_cndmask_b32 v64, v48, v32, s[40:41]
v_cndmask_b32 v65, v49, v33, s[42:43]
v_cndmask_b32 v66, v50, v34, s[44:45]
v_cndmask_b32 v67, v51, v35, s[46:47]
v_cndmask_b32 v68, v52, v36, s[48:49]
v_cndmask_b32 v69, v53, v37, s[50:51]
v_cndmask_b32 v70, v54, v38, s[52:53]
v_cndmask_b32 v71, v55, v39, s[54:55]
v_cndmask_b32 v72, v56, v40, s[56:57]
v_cndmask_b32 v73, v57, v41, s[58:59]
v_cndmask_b32 v74, v58, v42, s[60:61]
v_cndmask_b32 v75, v59, v43, s[62:63]
v_cndmask_b32 v76, v60, v44, s[64:65]
v_cndmask_b32 v77, v61, v45, s[66:67]
v_cndmask_b32 v78, v62, v46, s[68:69]
v_cndmask_b32 v79, v63, v47, s[70:71]
v_max_f32 v80, v64, v65
v_max3_f32 v80, v80, v66, v67
v_max3_f32 v80, v80, v68, v69
v_max3_f32 v80, v80, v70, v71
v_max3_f32 v80, v80, v72, v73
v_max3_f32 v80, v80, v74, v75
v_max3_f32 v80, v80, v76, v77
v_max3_f32 v80, v80, v78, v79
s_cmp_lt_u32 s36, 1
s_cbranch_scc1 L_skip_3074
v_mfma_f32_32x32x16_bf16 v[48:63], v[236:239], v[200:203], 0
s_nop 11
v_max3_f32 v80, v80, v48, v49
v_max3_f32 v80, v80, v50, v51
v_max3_f32 v80, v80, v52, v53
v_max3_f32 v80, v80, v54, v55
v_max3_f32 v80, v80, v56, v57
v_max3_f32 v80, v80, v58, v59
v_max3_f32 v80, v80, v60, v61
v_max3_f32 v80, v80, v62, v63
L_skip_3074:
s_cmp_lt_u32 s36, 2
s_cbranch_scc1 L_skip_3075
v_mfma_f32_32x32x16_bf16 v[32:47], v[232:235], v[200:203], 0
s_nop 11
v_max3_f32 v80, v80, v32, v33
v_max3_f32 v80, v80, v34, v35
v_max3_f32 v80, v80, v36, v37
v_max3_f32 v80, v80, v38, v39
v_max3_f32 v80, v80, v40, v41
v_max3_f32 v80, v80, v42, v43
v_max3_f32 v80, v80, v44, v45
v_max3_f32 v80, v80, v46, v47
L_skip_3075:
s_cmp_lt_u32 s36, 3
s_cbranch_scc1 L_skip_3076
v_mfma_f32_32x32x16_bf16 v[48:63], v[228:231], v[200:203], 0
s_nop 11
v_max3_f32 v80, v80, v48, v49
v_max3_f32 v80, v80, v50, v51
v_max3_f32 v80, v80, v52, v53
v_max3_f32 v80, v80, v54, v55
v_max3_f32 v80, v80, v56, v57
v_max3_f32 v80, v80, v58, v59
v_max3_f32 v80, v80, v60, v61
v_max3_f32 v80, v80, v62, v63
L_skip_3076:
s_cmp_lt_u32 s36, 4
s_cbranch_scc1 L_skip_3077
v_mfma_f32_32x32x16_bf16 v[32:47], v[224:227], v[200:203], 0
s_nop 11
v_max3_f32 v80, v80, v32, v33
v_max3_f32 v80, v80, v34, v35
v_max3_f32 v80, v80, v36, v37
v_max3_f32 v80, v80, v38, v39
v_max3_f32 v80, v80, v40, v41
v_max3_f32 v80, v80, v42, v43
v_max3_f32 v80, v80, v44, v45
v_max3_f32 v80, v80, v46, v47
L_skip_3077:
s_cmp_lt_u32 s36, 5
s_cbranch_scc1 L_skip_3078
v_mfma_f32_32x32x16_bf16 v[48:63], v[220:223], v[200:203], 0
s_nop 11
v_max3_f32 v80, v80, v48, v49
v_max3_f32 v80, v80, v50, v51
v_max3_f32 v80, v80, v52, v53
v_max3_f32 v80, v80, v54, v55
v_max3_f32 v80, v80, v56, v57
v_max3_f32 v80, v80, v58, v59
v_max3_f32 v80, v80, v60, v61
v_max3_f32 v80, v80, v62, v63
L_skip_3078:
s_cmp_lt_u32 s36, 6
s_cbranch_scc1 L_skip_3079
v_mfma_f32_32x32x16_bf16 v[32:47], v[216:219], v[200:203], 0
s_nop 11
v_max3_f32 v80, v80, v32, v33
v_max3_f32 v80, v80, v34, v35
v_max3_f32 v80, v80, v36, v37
v_max3_f32 v80, v80, v38, v39
v_max3_f32 v80, v80, v40, v41
v_max3_f32 v80, v80, v42, v43
v_max3_f32 v80, v80, v44, v45
v_max3_f32 v80, v80, v46, v47
L_skip_3079:
s_cmp_lt_u32 s36, 7
s_cbranch_scc1 L_skip_3080
v_mfma_f32_32x32x16_bf16 v[48:63], v[212:215], v[200:203], 0
s_nop 11
v_max3_f32 v80, v80, v48, v49
v_max3_f32 v80, v80, v50, v51
v_max3_f32 v80, v80, v52, v53
v_max3_f32 v80, v80, v54, v55
v_max3_f32 v80, v80, v56, v57
v_max3_f32 v80, v80, v58, v59
v_max3_f32 v80, v80, v60, v61
v_max3_f32 v80, v80, v62, v63
L_skip_3080:
v_mov_b32 v81, v80
s_nop 1
v_permlane32_swap_b32 v80, v81
v_max_f32 v80, v80, v81
v_sub_f32 v80, 0, v80
v_mov_b32 v81, v80
v_mov_b32 v82, v80
v_mov_b32 v83, v80
v_mov_b32 v84, v80
v_mov_b32 v85, v80
v_mov_b32 v86, v80
v_mov_b32 v87, v80
v_mov_b32 v88, v80
v_mov_b32 v89, v80
v_mov_b32 v90, v80
v_mov_b32 v91, v80
v_mov_b32 v92, v80
v_mov_b32 v93, v80
v_mov_b32 v94, v80
v_mov_b32 v95, v80
v_add_f32 v64, v64, v80
v_add_f32 v65, v65, v80
v_add_f32 v66, v66, v80
v_add_f32 v67, v67, v80
v_add_f32 v68, v68, v80
v_add_f32 v69, v69, v80
v_add_f32 v70, v70, v80
v_add_f32 v71, v71, v80
v_add_f32 v72, v72, v80
v_add_f32 v73, v73, v80
v_add_f32 v74, v74, v80
v_add_f32 v75, v75, v80
v_add_f32 v76, v76, v80
v_add_f32 v77, v77, v80
v_add_f32 v78, v78, v80
v_add_f32 v79, v79, v80
v_exp_f32 v64, v64
v_exp_f32 v65, v65
v_exp_f32 v66, v66
v_exp_f32 v67, v67
v_exp_f32 v68, v68
v_exp_f32 v69, v69
v_exp_f32 v70, v70
v_exp_f32 v71, v71
v_exp_f32 v72, v72
v_exp_f32 v73, v73
v_exp_f32 v74, v74
v_exp_f32 v75, v75
v_exp_f32 v76, v76
v_exp_f32 v77, v77
v_exp_f32 v78, v78
v_exp_f32 v79, v79
v_cvt_pk_bf16_f32 v112, v64, v65
v_cvt_pk_bf16_f32 v113, v66, v67
v_cvt_pk_bf16_f32 v114, v68, v69
v_cvt_pk_bf16_f32 v115, v70, v71
v_cvt_pk_bf16_f32 v116, v72, v73
v_cvt_pk_bf16_f32 v117, v74, v75
v_cvt_pk_bf16_f32 v118, v76, v77
v_cvt_pk_bf16_f32 v119, v78, v79
v_and_b32 v120, v112, v248
v_and_b32 v121, v113, v249
v_and_b32 v122, v114, v250
v_and_b32 v123, v115, v251
v_and_b32 v124, v116, v252
v_and_b32 v125, v117, v253
v_and_b32 v126, v118, v254
v_and_b32 v127, v119, v255
v_xor_b32 v112, v112, v120
v_xor_b32 v113, v113, v121
v_xor_b32 v114, v114, v122
v_xor_b32 v115, v115, v123
v_xor_b32 v116, v116, v124
v_xor_b32 v117, v117, v125
v_xor_b32 v118, v118, v126
v_xor_b32 v119, v119, v127
v_mfma_f32_32x32x16_bf16 v[96:111], v[184:187], v[120:123], 0
v_mfma_f32_32x32x16_bf16 v[96:111], v[188:191], v[124:127], v[96:111]
v_mfma_f32_32x32x16_bf16 v[96:111], a[192:195], v[112:115], v[96:111]
v_mfma_f32_32x32x16_bf16 v[96:111], a[196:199], v[116:119], v[96:111]
s_cmp_lt_u32 s36, 1
s_cbranch_scc1 L_skip_3081
v_mfma_f32_32x32x16_bf16 v[48:63], v[236:239], v[200:203], v[80:95]
s_nop 11
v_exp_f32 v48, v48
v_exp_f32 v49, v49
v_exp_f32 v50, v50
v_exp_f32 v51, v51
v_exp_f32 v52, v52
v_exp_f32 v53, v53
v_exp_f32 v54, v54
v_exp_f32 v55, v55
v_exp_f32 v56, v56
v_exp_f32 v57, v57
v_exp_f32 v58, v58
v_exp_f32 v59, v59
v_exp_f32 v60, v60
v_exp_f32 v61, v61
v_exp_f32 v62, v62
v_exp_f32 v63, v63
v_cvt_pk_bf16_f32 v120, v48, v49
v_cvt_pk_bf16_f32 v121, v50, v51
v_cvt_pk_bf16_f32 v122, v52, v53
v_cvt_pk_bf16_f32 v123, v54, v55
v_cvt_pk_bf16_f32 v124, v56, v57
v_cvt_pk_bf16_f32 v125, v58, v59
v_cvt_pk_bf16_f32 v126, v60, v61
v_cvt_pk_bf16_f32 v127, v62, v63
v_mfma_f32_32x32x16_bf16 v[96:111], a[248:251], v[120:123], v[96:111]
s_nop 0
v_mfma_f32_32x32x16_bf16 v[96:111], a[252:255], v[124:127], v[96:111]
L_skip_3081:
s_cmp_lt_u32 s36, 2
s_cbranch_scc1 L_skip_3082
v_mfma_f32_32x32x16_bf16 v[32:47], v[232:235], v[200:203], v[80:95]
s_nop 11
v_exp_f32 v32, v32
v_exp_f32 v33, v33
v_exp_f32 v34, v34
v_exp_f32 v35, v35
v_exp_f32 v36, v36
v_exp_f32 v37, v37
v_exp_f32 v38, v38
v_exp_f32 v39, v39
v_exp_f32 v40, v40
v_exp_f32 v41, v41
v_exp_f32 v42, v42
v_exp_f32 v43, v43
v_exp_f32 v44, v44
v_exp_f32 v45, v45
v_exp_f32 v46, v46
v_exp_f32 v47, v47
v_cvt_pk_bf16_f32 v128, v32, v33
v_cvt_pk_bf16_f32 v129, v34, v35
v_cvt_pk_bf16_f32 v130, v36, v37
v_cvt_pk_bf16_f32 v131, v38, v39
v_cvt_pk_bf16_f32 v132, v40, v41
v_cvt_pk_bf16_f32 v133, v42, v43
v_cvt_pk_bf16_f32 v134, v44, v45
v_cvt_pk_bf16_f32 v135, v46, v47
v_mfma_f32_32x32x16_bf16 v[96:111], a[240:243], v[128:131], v[96:111]
s_nop 0
v_mfma_f32_32x32x16_bf16 v[96:111], a[244:247], v[132:135], v[96:111]
L_skip_3082:
s_cmp_lt_u32 s36, 3
s_cbranch_scc1 L_skip_3083
v_mfma_f32_32x32x16_bf16 v[48:63], v[228:231], v[200:203], v[80:95]
s_nop 11
v_exp_f32 v48, v48
v_exp_f32 v49, v49
v_exp_f32 v50, v50
v_exp_f32 v51, v51
v_exp_f32 v52, v52
v_exp_f32 v53, v53
v_exp_f32 v54, v54
v_exp_f32 v55, v55
v_exp_f32 v56, v56
v_exp_f32 v57, v57
v_exp_f32 v58, v58
v_exp_f32 v59, v59
v_exp_f32 v60, v60
v_exp_f32 v61, v61
v_exp_f32 v62, v62
v_exp_f32 v63, v63
v_cvt_pk_bf16_f32 v120, v48, v49
v_cvt_pk_bf16_f32 v121, v50, v51
v_cvt_pk_bf16_f32 v122, v52, v53
v_cvt_pk_bf16_f32 v123, v54, v55
v_cvt_pk_bf16_f32 v124, v56, v57
v_cvt_pk_bf16_f32 v125, v58, v59
v_cvt_pk_bf16_f32 v126, v60, v61
v_cvt_pk_bf16_f32 v127, v62, v63
v_mfma_f32_32x32x16_bf16 v[96:111], a[232:235], v[120:123], v[96:111]
s_nop 0
v_mfma_f32_32x32x16_bf16 v[96:111], a[236:239], v[124:127], v[96:111]
L_skip_3083:
s_cmp_lt_u32 s36, 4
s_cbranch_scc1 L_skip_3084
v_mfma_f32_32x32x16_bf16 v[32:47], v[224:227], v[200:203], v[80:95]
s_nop 11
v_exp_f32 v32, v32
v_exp_f32 v33, v33
v_exp_f32 v34, v34
v_exp_f32 v35, v35
v_exp_f32 v36, v36
v_exp_f32 v37, v37
v_exp_f32 v38, v38
v_exp_f32 v39, v39
v_exp_f32 v40, v40
v_exp_f32 v41, v41
v_exp_f32 v42, v42
v_exp_f32 v43, v43
v_exp_f32 v44, v44
v_exp_f32 v45, v45
v_exp_f32 v46, v46
v_exp_f32 v47, v47
v_cvt_pk_bf16_f32 v128, v32, v33
v_cvt_pk_bf16_f32 v129, v34, v35
v_cvt_pk_bf16_f32 v130, v36, v37
v_cvt_pk_bf16_f32 v131, v38, v39
v_cvt_pk_bf16_f32 v132, v40, v41
v_cvt_pk_bf16_f32 v133, v42, v43
v_cvt_pk_bf16_f32 v134, v44, v45
v_cvt_pk_bf16_f32 v135, v46, v47
v_mfma_f32_32x32x16_bf16 v[96:111], a[224:227], v[128:131], v[96:111]
s_nop 0
v_mfma_f32_32x32x16_bf16 v[96:111], a[228:231], v[132:135], v[96:111]
L_skip_3084:
s_cmp_lt_u32 s36, 5
s_cbranch_scc1 L_skip_3085
v_mfma_f32_32x32x16_bf16 v[48:63], v[220:223], v[200:203], v[80:95]
s_nop 11
v_exp_f32 v48, v48
v_exp_f32 v49, v49
v_exp_f32 v50, v50
v_exp_f32 v51, v51
v_exp_f32 v52, v52
v_exp_f32 v53, v53
v_exp_f32 v54, v54
v_exp_f32 v55, v55
v_exp_f32 v56, v56
v_exp_f32 v57, v57
v_exp_f32 v58, v58
v_exp_f32 v59, v59
v_exp_f32 v60, v60
v_exp_f32 v61, v61
v_exp_f32 v62, v62
v_exp_f32 v63, v63
v_cvt_pk_bf16_f32 v120, v48, v49
v_cvt_pk_bf16_f32 v121, v50, v51
v_cvt_pk_bf16_f32 v122, v52, v53
v_cvt_pk_bf16_f32 v123, v54, v55
v_cvt_pk_bf16_f32 v124, v56, v57
v_cvt_pk_bf16_f32 v125, v58, v59
v_cvt_pk_bf16_f32 v126, v60, v61
v_cvt_pk_bf16_f32 v127, v62, v63
v_mfma_f32_32x32x16_bf16 v[96:111], a[216:219], v[120:123], v[96:111]
s_nop 0
v_mfma_f32_32x32x16_bf16 v[96:111], a[220:223], v[124:127], v[96:111]
L_skip_3085:
s_cmp_lt_u32 s36, 6
s_cbranch_scc1 L_skip_3086
v_mfma_f32_32x32x16_bf16 v[32:47], v[216:219], v[200:203], v[80:95]
s_nop 11
v_exp_f32 v32, v32
v_exp_f32 v33, v33
v_exp_f32 v34, v34
v_exp_f32 v35, v35
v_exp_f32 v36, v36
v_exp_f32 v37, v37
v_exp_f32 v38, v38
v_exp_f32 v39, v39
v_exp_f32 v40, v40
v_exp_f32 v41, v41
v_exp_f32 v42, v42
v_exp_f32 v43, v43
v_exp_f32 v44, v44
v_exp_f32 v45, v45
v_exp_f32 v46, v46
v_exp_f32 v47, v47
v_cvt_pk_bf16_f32 v128, v32, v33
v_cvt_pk_bf16_f32 v129, v34, v35
v_cvt_pk_bf16_f32 v130, v36, v37
v_cvt_pk_bf16_f32 v131, v38, v39
v_cvt_pk_bf16_f32 v132, v40, v41
v_cvt_pk_bf16_f32 v133, v42, v43
v_cvt_pk_bf16_f32 v134, v44, v45
v_cvt_pk_bf16_f32 v135, v46, v47
v_mfma_f32_32x32x16_bf16 v[96:111], a[208:211], v[128:131], v[96:111]
s_nop 0
v_mfma_f32_32x32x16_bf16 v[96:111], a[212:215], v[132:135], v[96:111]
L_skip_3086:
s_cmp_lt_u32 s36, 7
s_cbranch_scc1 L_skip_3087
v_mfma_f32_32x32x16_bf16 v[48:63], v[212:215], v[200:203], v[80:95]
s_nop 11
v_exp_f32 v48, v48
v_exp_f32 v49, v49
v_exp_f32 v50, v50
v_exp_f32 v51, v51
v_exp_f32 v52, v52
v_exp_f32 v53, v53
v_exp_f32 v54, v54
v_exp_f32 v55, v55
v_exp_f32 v56, v56
v_exp_f32 v57, v57
v_exp_f32 v58, v58
v_exp_f32 v59, v59
v_exp_f32 v60, v60
v_exp_f32 v61, v61
v_exp_f32 v62, v62
v_exp_f32 v63, v63
v_cvt_pk_bf16_f32 v120, v48, v49
v_cvt_pk_bf16_f32 v121, v50, v51
v_cvt_pk_bf16_f32 v122, v52, v53
v_cvt_pk_bf16_f32 v123, v54, v55
v_cvt_pk_bf16_f32 v124, v56, v57
v_cvt_pk_bf16_f32 v125, v58, v59
v_cvt_pk_bf16_f32 v126, v60, v61
v_cvt_pk_bf16_f32 v127, v62, v63
v_mfma_f32_32x32x16_bf16 v[96:111], a[200:203], v[120:123], v[96:111]
s_nop 0
v_mfma_f32_32x32x16_bf16 v[96:111], a[204:207], v[124:127], v[96:111]
L_skip_3087:
s_nop 7
s_nop 7
s_branch L_fbret_2072
L_poll_3088:
s_mov_b32 s84, 0
L_poll_3088_l:
buffer_load_dword v8, v13, s[24:27], s20 offen offset:0 sc1
s_waitcnt vmcnt(0)
v_cmp_ne_u32 vcc, s72, v8
s_nop 1
s_cbranch_vccz L_ret_3089
s_add_u32 s84, s84, 1
s_cmp_lt_u32 s84, 0x40000
s_cbranch_scc1 L_poll_3088_l
s_endpgm
L_poll_3090:
s_mov_b32 s84, 0
L_poll_3090_l:
s_sleep 2
buffer_load_dwordx4 v[136:139], v2, s[24:27], s81 offen offset:0 sc1
buffer_load_dwordx4 v[140:143], v2, s[24:27], s81 offen offset:1024 sc1
s_waitcnt vmcnt(0)
v_cmp_ne_u32 vcc, s72, v137
v_cmp_ne_u32 s[86:87], s72, v139
s_nop 0
s_or_b64 vcc, vcc, s[86:87]
v_cmp_ne_u32 s[86:87], s72, v141
s_nop 0
s_or_b64 vcc, vcc, s[86:87]
v_cmp_ne_u32 s[86:87], s72, v143
s_nop 0
s_or_b64 vcc, vcc, s[86:87]
s_nop 1
s_cbranch_vccz L_ret_3091
s_add_u32 s84, s84, 1
s_cmp_lt_u32 s84, 0x40000
s_cbranch_scc1 L_poll_3090_l
s_endpgm
L_fb_3092:
s_nop 7
v_mfma_f32_32x32x16_bf16 v[32:47], v[180:183], v[204:207], 0
v_mfma_f32_32x32x16_bf16 v[48:63], v[212:215], v[204:207], 0
s_cmp_ge_u32 s36, 7
s_cbranch_scc1 L_old_4094
s_nop 9
v_mov_b32 v48, 0xff800000
v_mov_b32 v49, 0xff800000
v_mov_b32 v50, 0xff800000
v_mov_b32 v51, 0xff800000
v_mov_b32 v52, 0xff800000
v_mov_b32 v53, 0xff800000
v_mov_b32 v54, 0xff800000
v_mov_b32 v55, 0xff800000
v_mov_b32 v56, 0xff800000
v_mov_b32 v57, 0xff800000
v_mov_b32 v58, 0xff800000
v_mov_b32 v59, 0xff800000
v_mov_b32 v60, 0xff800000
v_mov_b32 v61, 0xff800000
v_mov_b32 v62, 0xff800000
v_mov_b32 v63, 0xff800000
L_old_4094:
s_nop 9
v_cndmask_b32 v64, v48, v32, s[40:41]
v_cndmask_b32 v65, v49, v33, s[42:43]
v_cndmask_b32 v66, v50, v34, s[44:45]
v_cndmask_b32 v67, v51, v35, s[46:47]
v_cndmask_b32 v68, v52, v36, s[48:49]
v_cndmask_b32 v69, v53, v37, s[50:51]
v_cndmask_b32 v70, v54, v38, s[52:53]
v_cndmask_b32 v71, v55, v39, s[54:55]
v_cndmask_b32 v72, v56, v40, s[56:57]
v_cndmask_b32 v73, v57, v41, s[58:59]
v_cndmask_b32 v74, v58, v42, s[60:61]
v_cndmask_b32 v75, v59, v43, s[62:63]
v_cndmask_b32 v76, v60, v44, s[64:65]
v_cndmask_b32 v77, v61, v45, s[66:67]
v_cndmask_b32 v78, v62, v46, s[68:69]
v_cndmask_b32 v79, v63, v47, s[70:71]
v_max_f32 v80, v64, v65
v_max3_f32 v80, v80, v66, v67
v_max3_f32 v80, v80, v68, v69
v_max3_f32 v80, v80, v70, v71
v_max3_f32 v80, v80, v72, v73
v_max3_f32 v80, v80, v74, v75
v_max3_f32 v80, v80, v76, v77
v_max3_f32 v80, v80, v78, v79
v_mfma_f32_32x32x16_bf16 v[48:63], v[176:179], v[204:207], 0
s_nop 11
v_max3_f32 v80, v80, v48, v49
v_max3_f32 v80, v80, v50, v51
v_max3_f32 v80, v80, v52, v53
v_max3_f32 v80, v80, v54, v55
v_max3_f32 v80, v80, v56, v57
v_max3_f32 v80, v80, v58, v59
v_max3_f32 v80, v80, v60, v61
v_max3_f32 v80, v80, v62, v63
s_cmp_lt_u32 s36, 1
s_cbranch_scc1 L_skip_4095
v_mfma_f32_32x32x16_bf16 v[32:47], v[236:239], v[204:207], 0
s_nop 11
v_max3_f32 v80, v80, v32, v33
v_max3_f32 v80, v80, v34, v35
v_max3_f32 v80, v80, v36, v37
v_max3_f32 v80, v80, v38, v39
v_max3_f32 v80, v80, v40, v41
v_max3_f32 v80, v80, v42, v43
v_max3_f32 v80, v80, v44, v45
v_max3_f32 v80, v80, v46, v47
L_skip_4095:
s_cmp_lt_u32 s36, 2
s_cbranch_scc1 L_skip_4096
v_mfma_f32_32x32x16_bf16 v[48:63], v[232:235], v[204:207], 0
s_nop 11
v_max3_f32 v80, v80, v48, v49
v_max3_f32 v80, v80, v50, v51
v_max3_f32 v80, v80, v52, v53
v_max3_f32 v80, v80, v54, v55
v_max3_f32 v80, v80, v56, v57
v_max3_f32 v80, v80, v58, v59
v_max3_f32 v80, v80, v60, v61
v_max3_f32 v80, v80, v62, v63
L_skip_4096:
s_cmp_lt_u32 s36, 3
s_cbranch_scc1 L_skip_4097
v_mfma_f32_32x32x16_bf16 v[32:47], v[228:231], v[204:207], 0
s_nop 11
v_max3_f32 v80, v80, v32, v33
v_max3_f32 v80, v80, v34, v35
v_max3_f32 v80, v80, v36, v37
v_max3_f32 v80, v80, v38, v39
v_max3_f32 v80, v80, v40, v41
v_max3_f32 v80, v80, v42, v43
v_max3_f32 v80, v80, v44, v45
v_max3_f32 v80, v80, v46, v47
L_skip_4097:
s_cmp_lt_u32 s36, 4
s_cbranch_scc1 L_skip_4098
v_mfma_f32_32x32x16_bf16 v[48:63], v[224:227], v[204:207], 0
s_nop 11
v_max3_f32 v80, v80, v48, v49
v_max3_f32 v80, v80, v50, v51
v_max3_f32 v80, v80, v52, v53
v_max3_f32 v80, v80, v54, v55
v_max3_f32 v80, v80, v56, v57
v_max3_f32 v80, v80, v58, v59
v_max3_f32 v80, v80, v60, v61
v_max3_f32 v80, v80, v62, v63
L_skip_4098:
s_cmp_lt_u32 s36, 5
s_cbranch_scc1 L_skip_4099
v_mfma_f32_32x32x16_bf16 v[32:47], v[220:223], v[204:207], 0
s_nop 11
v_max3_f32 v80, v80, v32, v33
v_max3_f32 v80, v80, v34, v35
v_max3_f32 v80, v80, v36, v37
v_max3_f32 v80, v80, v38, v39
v_max3_f32 v80, v80, v40, v41
v_max3_f32 v80, v80, v42, v43
v_max3_f32 v80, v80, v44, v45
v_max3_f32 v80, v80, v46, v47
L_skip_4099:
s_cmp_lt_u32 s36, 6
s_cbranch_scc1 L_skip_4100
v_mfma_f32_32x32x16_bf16 v[48:63], v[216:219], v[204:207], 0
s_nop 11
v_max3_f32 v80, v80, v48, v49
v_max3_f32 v80, v80, v50, v51
v_max3_f32 v80, v80, v52, v53
v_max3_f32 v80, v80, v54, v55
v_max3_f32 v80, v80, v56, v57
v_max3_f32 v80, v80, v58, v59
v_max3_f32 v80, v80, v60, v61
v_max3_f32 v80, v80, v62, v63
L_skip_4100:
v_mov_b32 v81, v80
s_nop 1
v_permlane32_swap_b32 v80, v81
v_max_f32 v80, v80, v81
v_sub_f32 v80, 0, v80
v_mov_b32 v81, v80
v_mov_b32 v82, v80
v_mov_b32 v83, v80
v_mov_b32 v84, v80
v_mov_b32 v85, v80
v_mov_b32 v86, v80
v_mov_b32 v87, v80
v_mov_b32 v88, v80
v_mov_b32 v89, v80
v_mov_b32 v90, v80
v_mov_b32 v91, v80
v_mov_b32 v92, v80
v_mov_b32 v93, v80
v_mov_b32 v94, v80
v_mov_b32 v95, v80
v_add_f32 v64, v64, v80
v_add_f32 v65, v65, v80
v_add_f32 v66, v66, v80
v_add_f32 v67, v67, v80
v_add_f32 v68, v68, v80
v_add_f32 v69, v69, v80
v_add_f32 v70, v70, v80
v_add_f32 v71, v71, v80
v_add_f32 v72, v72, v80
v_add_f32 v73, v73, v80
v_add_f32 v74, v74, v80
v_add_f32 v75, v75, v80
v_add_f32 v76, v76, v80
v_add_f32 v77, v77, v80
v_add_f32 v78, v78, v80
v_add_f32 v79, v79, v80
v_exp_f32 v64, v64
v_exp_f32 v65, v65
v_exp_f32 v66, v66
v_exp_f32 v67, v67
v_exp_f32 v68, v68
v_exp_f32 v69, v69
v_exp_f32 v70, v70
v_exp_f32 v71, v71
v_exp_f32 v72, v72
v_exp_f32 v73, v73
v_exp_f32 v74, v74
v_exp_f32 v75, v75
v_exp_f32 v76, v76
v_exp_f32 v77, v77
v_exp_f32 v78, v78
v_exp_f32 v79, v79
v_cvt_pk_bf16_f32 v112, v64, v65
v_cvt_pk_bf16_f32 v113, v66, v67
v_cvt_pk_bf16_f32 v114, v68, v69
v_cvt_pk_bf16_f32 v115, v70, v71
v_cvt_pk_bf16_f32 v116, v72, v73
v_cvt_pk_bf16_f32 v117, v74, v75
v_cvt_pk_bf16_f32 v118, v76, v77
v_cvt_pk_bf16_f32 v119, v78, v79
v_and_b32 v120, v112, v248
v_and_b32 v121, v113, v249
v_and_b32 v122, v114, v250
v_and_b32 v123, v115, v251
v_and_b32 v124, v116, v252
v_and_b32 v125, v117, v253
v_and_b32 v126, v118, v254
v_and_b32 v127, v119, v255
v_xor_b32 v112, v112, v120
v_xor_b32 v113, v113, v121
v_xor_b32 v114, v114, v122
v_xor_b32 v115, v115, v123
v_xor_b32 v116, v116, v124
v_xor_b32 v117, v117, v125
v_xor_b32 v118, v118, v126
v_xor_b32 v119, v119, v127
v_mfma_f32_32x32x16_bf16 v[96:111], v[192:195], v[120:123], 0
v_mfma_f32_32x32x16_bf16 v[96:111], v[196:199], v[124:127], v[96:111]
v_mfma_f32_32x32x16_bf16 v[96:111], a[200:203], v[112:115], v[96:111]
v_mfma_f32_32x32x16_bf16 v[96:111], a[204:207], v[116:119], v[96:111]
v_mfma_f32_32x32x16_bf16 v[48:63], v[176:179], v[204:207], v[80:95]
s_nop 11
v_exp_f32 v48, v48
v_exp_f32 v49, v49
v_exp_f32 v50, v50
v_exp_f32 v51, v51
v_exp_f32 v52, v52
v_exp_f32 v53, v53
v_exp_f32 v54, v54
v_exp_f32 v55, v55
v_exp_f32 v56, v56
v_exp_f32 v57, v57
v_exp_f32 v58, v58
v_exp_f32 v59, v59
v_exp_f32 v60, v60
v_exp_f32 v61, v61
v_exp_f32 v62, v62
v_exp_f32 v63, v63
v_cvt_pk_bf16_f32 v120, v48, v49
v_cvt_pk_bf16_f32 v121, v50, v51
v_cvt_pk_bf16_f32 v122, v52, v53
v_cvt_pk_bf16_f32 v123, v54, v55
v_cvt_pk_bf16_f32 v124, v56, v57
v_cvt_pk_bf16_f32 v125, v58, v59
v_cvt_pk_bf16_f32 v126, v60, v61
v_cvt_pk_bf16_f32 v127, v62, v63
v_mfma_f32_32x32x16_bf16 v[96:111], v[184:187], v[120:123], v[96:111]
s_nop 0
v_mfma_f32_32x32x16_bf16 v[96:111], v[188:191], v[124:127], v[96:111]
s_cmp_lt_u32 s36, 1
s_cbranch_scc1 L_skip_4101
v_mfma_f32_32x32x16_bf16 v[32:47], v[236:239], v[204:207], v[80:95]
s_nop 11
v_exp_f32 v32, v32
v_exp_f32 v33, v33
v_exp_f32 v34, v34
v_exp_f32 v35, v35
v_exp_f32 v36, v36
v_exp_f32 v37, v37
v_exp_f32 v38, v38
v_exp_f32 v39, v39
v_exp_f32 v40, v40
v_exp_f32 v41, v41
v_exp_f32 v42, v42
v_exp_f32 v43, v43
v_exp_f32 v44, v44
v_exp_f32 v45, v45
v_exp_f32 v46, v46
v_exp_f32 v47, v47
v_cvt_pk_bf16_f32 v128, v32, v33
v_cvt_pk_bf16_f32 v129, v34, v35
v_cvt_pk_bf16_f32 v130, v36, v37
v_cvt_pk_bf16_f32 v131, v38, v39
v_cvt_pk_bf16_f32 v132, v40, v41
v_cvt_pk_bf16_f32 v133, v42, v43
v_cvt_pk_bf16_f32 v134, v44, v45
v_cvt_pk_bf16_f32 v135, v46, v47
v_mfma_f32_32x32x16_bf16 v[96:111], a[248:251], v[128:131], v[96:111]
s_nop 0
v_mfma_f32_32x32x16_bf16 v[96:111], a[252:255], v[132:135], v[96:111]
L_skip_4101:
s_cmp_lt_u32 s36, 2
s_cbranch_scc1 L_skip_4102
v_mfma_f32_32x32x16_bf16 v[48:63], v[232:235], v[204:207], v[80:95]
s_nop 11
v_exp_f32 v48, v48
v_exp_f32 v49, v49
v_exp_f32 v50, v50
v_exp_f32 v51, v51
v_exp_f32 v52, v52
v_exp_f32 v53, v53
v_exp_f32 v54, v54
v_exp_f32 v55, v55
v_exp_f32 v56, v56
v_exp_f32 v57, v57
v_exp_f32 v58, v58
v_exp_f32 v59, v59
v_exp_f32 v60, v60
v_exp_f32 v61, v61
v_exp_f32 v62, v62
v_exp_f32 v63, v63
v_cvt_pk_bf16_f32 v120, v48, v49
v_cvt_pk_bf16_f32 v121, v50, v51
v_cvt_pk_bf16_f32 v122, v52, v53
v_cvt_pk_bf16_f32 v123, v54, v55
v_cvt_pk_bf16_f32 v124, v56, v57
v_cvt_pk_bf16_f32 v125, v58, v59
v_cvt_pk_bf16_f32 v126, v60, v61
v_cvt_pk_bf16_f32 v127, v62, v63
v_mfma_f32_32x32x16_bf16 v[96:111], a[240:243], v[120:123], v[96:111]
s_nop 0
v_mfma_f32_32x32x16_bf16 v[96:111], a[244:247], v[124:127], v[96:111]
L_skip_4102:
s_cmp_lt_u32 s36, 3
s_cbranch_scc1 L_skip_4103
v_mfma_f32_32x32x16_bf16 v[32:47], v[228:231], v[204:207], v[80:95]
s_nop 11
v_exp_f32 v32, v32
v_exp_f32 v33, v33
v_exp_f32 v34, v34
v_exp_f32 v35, v35
v_exp_f32 v36, v36
v_exp_f32 v37, v37
v_exp_f32 v38, v38
v_exp_f32 v39, v39
v_exp_f32 v40, v40
v_exp_f32 v41, v41
v_exp_f32 v42, v42
v_exp_f32 v43, v43
v_exp_f32 v44, v44
v_exp_f32 v45, v45
v_exp_f32 v46, v46
v_exp_f32 v47, v47
v_cvt_pk_bf16_f32 v128, v32, v33
v_cvt_pk_bf16_f32 v129, v34, v35
v_cvt_pk_bf16_f32 v130, v36, v37
v_cvt_pk_bf16_f32 v131, v38, v39
v_cvt_pk_bf16_f32 v132, v40, v41
v_cvt_pk_bf16_f32 v133, v42, v43
v_cvt_pk_bf16_f32 v134, v44, v45
v_cvt_pk_bf16_f32 v135, v46, v47
v_mfma_f32_32x32x16_bf16 v[96:111], a[232:235], v[128:131], v[96:111]
s_nop 0
v_mfma_f32_32x32x16_bf16 v[96:111], a[236:239], v[132:135], v[96:111]
L_skip_4103:
s_cmp_lt_u32 s36, 4
s_cbranch_scc1 L_skip_4104
v_mfma_f32_32x32x16_bf16 v[48:63], v[224:227], v[204:207], v[80:95]
s_nop 11
v_exp_f32 v48, v48
v_exp_f32 v49, v49
v_exp_f32 v50, v50
v_exp_f32 v51, v51
v_exp_f32 v52, v52
v_exp_f32 v53, v53
v_exp_f32 v54, v54
v_exp_f32 v55, v55
v_exp_f32 v56, v56
v_exp_f32 v57, v57
v_exp_f32 v58, v58
v_exp_f32 v59, v59
v_exp_f32 v60, v60
v_exp_f32 v61, v61
v_exp_f32 v62, v62
v_exp_f32 v63, v63
v_cvt_pk_bf16_f32 v120, v48, v49
v_cvt_pk_bf16_f32 v121, v50, v51
v_cvt_pk_bf16_f32 v122, v52, v53
v_cvt_pk_bf16_f32 v123, v54, v55
v_cvt_pk_bf16_f32 v124, v56, v57
v_cvt_pk_bf16_f32 v125, v58, v59
v_cvt_pk_bf16_f32 v126, v60, v61
v_cvt_pk_bf16_f32 v127, v62, v63
v_mfma_f32_32x32x16_bf16 v[96:111], a[224:227], v[120:123], v[96:111]
s_nop 0
v_mfma_f32_32x32x16_bf16 v[96:111], a[228:231], v[124:127], v[96:111]
L_skip_4104:
s_cmp_lt_u32 s36, 5
s_cbranch_scc1 L_skip_4105
v_mfma_f32_32x32x16_bf16 v[32:47], v[220:223], v[204:207], v[80:95]
s_nop 11
v_exp_f32 v32, v32
v_exp_f32 v33, v33
v_exp_f32 v34, v34
v_exp_f32 v35, v35
v_exp_f32 v36, v36
v_exp_f32 v37, v37
v_exp_f32 v38, v38
v_exp_f32 v39, v39
v_exp_f32 v40, v40
v_exp_f32 v41, v41
v_exp_f32 v42, v42
v_exp_f32 v43, v43
v_exp_f32 v44, v44
v_exp_f32 v45, v45
v_exp_f32 v46, v46
v_exp_f32 v47, v47
v_cvt_pk_bf16_f32 v128, v32, v33
v_cvt_pk_bf16_f32 v129, v34, v35
v_cvt_pk_bf16_f32 v130, v36, v37
v_cvt_pk_bf16_f32 v131, v38, v39
v_cvt_pk_bf16_f32 v132, v40, v41
v_cvt_pk_bf16_f32 v133, v42, v43
v_cvt_pk_bf16_f32 v134, v44, v45
v_cvt_pk_bf16_f32 v135, v46, v47
v_mfma_f32_32x32x16_bf16 v[96:111], a[216:219], v[128:131], v[96:111]
s_nop 0
v_mfma_f32_32x32x16_bf16 v[96:111], a[220:223], v[132:135], v[96:111]
L_skip_4105:
s_cmp_lt_u32 s36, 6
s_cbranch_scc1 L_skip_4106
v_mfma_f32_32x32x16_bf16 v[48:63], v[216:219], v[204:207], v[80:95]
s_nop 11
v_exp_f32 v48, v48
v_exp_f32 v49, v49
v_exp_f32 v50, v50
v_exp_f32 v51, v51
v_exp_f32 v52, v52
v_exp_f32 v53, v53
v_exp_f32 v54, v54
v_exp_f32 v55, v55
v_exp_f32 v56, v56
v_exp_f32 v57, v57
v_exp_f32 v58, v58
v_exp_f32 v59, v59
v_exp_f32 v60, v60
v_exp_f32 v61, v61
v_exp_f32 v62, v62
v_exp_f32 v63, v63
v_cvt_pk_bf16_f32 v120, v48, v49
v_cvt_pk_bf16_f32 v121, v50, v51
v_cvt_pk_bf16_f32 v122, v52, v53
v_cvt_pk_bf16_f32 v123, v54, v55
v_cvt_pk_bf16_f32 v124, v56, v57
v_cvt_pk_bf16_f32 v125, v58, v59
v_cvt_pk_bf16_f32 v126, v60, v61
v_cvt_pk_bf16_f32 v127, v62, v63
v_mfma_f32_32x32x16_bf16 v[96:111], a[208:211], v[120:123], v[96:111]
s_nop 0
v_mfma_f32_32x32x16_bf16 v[96:111], a[212:215], v[124:127], v[96:111]
L_skip_4106:
s_nop 7
s_nop 7
s_branch L_fbret_3093
L_poll_4107:
s_mov_b32 s84, 0
L_poll_4107_l:
buffer_load_dword v4, v13, s[24:27], s20 offen offset:128 sc1
s_waitcnt vmcnt(0)
v_cmp_ne_u32 vcc, s72, v4
s_nop 1
s_cbranch_vccz L_ret_4108
s_add_u32 s84, s84, 1
s_cmp_lt_u32 s84, 0x40000
s_cbranch_scc1 L_poll_4107_l
s_endpgm
L_poll_4110:
s_mov_b32 s84, 0
L_poll_4110_l:
s_sleep 2
buffer_load_dwordx4 v[240:243], v11, s[24:27], s23 offen offset:0 sc1
buffer_load_dwordx4 v[244:247], v11, s[24:27], s23 offen offset:1024 sc1
buffer_load_dwordx4 v[248:251], v11, s[24:27], s23 offen offset:2048 sc1
buffer_load_dwordx4 v[252:255], v11, s[24:27], s23 offen offset:3072 sc1
s_waitcnt vmcnt(0)
v_cmp_ne_u32 vcc, s72, v242
v_cmp_ne_u32 s[86:87], s72, v246
s_nop 0
s_or_b64 vcc, vcc, s[86:87]
v_cmp_ne_u32 s[86:87], s72, v250
s_nop 0
s_or_b64 vcc, vcc, s[86:87]
v_cmp_ne_u32 s[86:87], s72, v254
s_nop 0
s_or_b64 vcc, vcc, s[86:87]
s_nop 1
s_cbranch_vccz L_ret_4111
s_add_u32 s84, s84, 1
s_cmp_lt_u32 s84, 0x40000
s_cbranch_scc1 L_poll_4110_l
s_endpgm
L_poll_4112:
s_mov_b32 s84, 0
L_poll_4112_l:
buffer_load_dword v8, v13, s[24:27], s20 offen offset:256 sc1
s_waitcnt vmcnt(0)
v_cmp_ne_u32 vcc, s72, v8
s_nop 1
s_cbranch_vccz L_ret_4113
s_add_u32 s84, s84, 1
s_cmp_lt_u32 s84, 0x40000
s_cbranch_scc1 L_poll_4112_l
s_endpgm
L_poll_4115:
s_mov_b32 s84, 0
L_poll_4115_l:
s_sleep 2
buffer_load_dwordx4 v[240:243], v11, s[24:27], s23 offen offset:512 sc1
buffer_load_dwordx4 v[244:247], v11, s[24:27], s23 offen offset:1536 sc1
buffer_load_dwordx4 v[248:251], v11, s[24:27], s23 offen offset:2560 sc1
buffer_load_dwordx4 v[252:255], v11, s[24:27], s23 offen offset:3584 sc1
s_waitcnt vmcnt(0)
v_cmp_ne_u32 vcc, s72, v242
v_cmp_ne_u32 s[86:87], s72, v246
s_nop 0
s_or_b64 vcc, vcc, s[86:87]
v_cmp_ne_u32 s[86:87], s72, v250
s_nop 0
s_or_b64 vcc, vcc, s[86:87]
v_cmp_ne_u32 s[86:87], s72, v254
s_nop 0
s_or_b64 vcc, vcc, s[86:87]
s_nop 1
s_cbranch_vccz L_ret_4116
s_add_u32 s84, s84, 1
s_cmp_lt_u32 s84, 0x40000
s_cbranch_scc1 L_poll_4115_l
s_endpgm
L_poll_4117:
s_mov_b32 s84, 0
L_poll_4117_l:
buffer_load_dword v4, v13, s[24:27], s20 offen offset:384 sc1
s_waitcnt vmcnt(0)
v_cmp_ne_u32 vcc, s72, v4
s_nop 1
s_cbranch_vccz L_ret_4118
s_add_u32 s84, s84, 1
s_cmp_lt_u32 s84, 0x40000
s_cbranch_scc1 L_poll_4117_l
s_endpgm
L_poll_4119:
s_mov_b32 s84, 0
L_poll_4119_l:
buffer_load_dword v8, v10, s[24:27], s21 offen offset:512 sc1
s_waitcnt vmcnt(0)
v_cmp_ne_u32 vcc, s72, v8
s_nop 1
s_cbranch_vccz L_ret_4120
s_add_u32 s84, s84, 1
s_cmp_lt_u32 s84, 0x40000
s_cbranch_scc1 L_poll_4119_l
s_endpgm
L_poll_4121:
s_mov_b32 s84, 0
L_poll_4121_l:
buffer_load_dword v4, v10, s[24:27], s21 offen offset:640 sc1
s_waitcnt vmcnt(0)
v_cmp_ne_u32 vcc, s72, v4
s_nop 1
s_cbranch_vccz L_ret_4122
s_add_u32 s84, s84, 1
s_cmp_lt_u32 s84, 0x40000
s_cbranch_scc1 L_poll_4121_l
s_endpgm
.section .rodata,"a"
.p2align 6
.amdhsa_kernel adaLN_cond__sliding_block__dense_activation_silu__prompt_kernel
  .amdhsa_next_free_vgpr 512
  .amdhsa_next_free_sgpr 102
  .amdhsa_accum_offset 256
  .amdhsa_group_segment_fixed_size 0
  .amdhsa_kernarg_size 88
  .amdhsa_user_sgpr_count 2
  .amdhsa_user_sgpr_kernarg_segment_ptr 1
  .amdhsa_system_sgpr_workgroup_id_x 1
  .amdhsa_float_denorm_mode_32 3
.end_amdhsa_kernel
```
